```python
import torch

def _softmax(x, axis=-1):
    return torch.softmax(x, dim=axis)

def _gelu(x):
    return torch.nn.functional.gelu(x, approximate='tanh')

def _silu(x):
    return torch.nn.functional.silu(x)

def _sigmoid(x):
    return torch.sigmoid(x)

def _layernorm(x, axis=-1, eps=1e-05):
    m = x.mean(dim=axis, keepdim=True)
    v = x.var(dim=axis, keepdim=True, unbiased=False)
    return (x - m) / torch.sqrt(v + eps)

def _scatter_add(tgt, idx, src, axis=0):
    return tgt.clone().index_add_(axis, idx, src)

def _segment_sum(src, seg, n):
    out = torch.zeros((n,) + src.shape[1:], dtype=src.dtype)
    return out.index_add_(0, seg, src)

def _pad(x, pw):
    flat = tuple((v for pair in reversed(pw) for v in pair))
    return torch.nn.functional.pad(x, flat)
kernel_name = 'adaLN_cond__spectral_fnet__geglu_ffn__prompt'

def setup_inputs():

    _w = lambda a: (lambda t: t.to(torch.bfloat16) if t.is_floating_point() else t)(torch.as_tensor(a))

    def _A_setup():
        B, S, D = (1, 2048, 1024)
        ns = torch.arange(S)[:, None] * torch.arange(S)[None, :]
        nd = torch.arange(D)[:, None] * torch.arange(D)[None, :]
        Ws_re = torch.cos(-2.0 * torch.pi * ns / S).to(float)
        Ws_im = torch.sin(-2.0 * torch.pi * ns / S).to(float)
        Wd_re = torch.cos(-2.0 * torch.pi * nd / D).to(float)
        Wd_im = torch.sin(-2.0 * torch.pi * nd / D).to(float)
        return {'x': _w((lambda *s: torch.randn(*s, dtype=torch.bfloat16) * 0.05)(B, S, D)), 'dft_seq_re': _w(Ws_re), 'dft_seq_im': _w(Ws_im), 'dft_hid_re': _w(Wd_re), 'dft_hid_im': _w(Wd_im)}
    _A_in = _A_setup()

    def _B_setup():
        B, S, D, F = (1, 2048, 1024, 3584)
        return {'x': _w((lambda *s: torch.randn(*s, dtype=torch.bfloat16) * 0.05)(B, S, D)), 'w_gate': _w((lambda *s: torch.randn(*s, dtype=torch.bfloat16) * 0.4)(D, F)), 'w_up': _w((lambda *s: torch.randn(*s, dtype=torch.bfloat16) * 0.4)(D, F)), 'w_down': _w((lambda *s: torch.randn(*s, dtype=torch.bfloat16) * 0.4)(F, D))}
    _B_in = _B_setup()
    return {'A_x': _A_in['x'], 'A_dft_seq_re': _A_in['dft_seq_re'], 'A_dft_seq_im': _A_in['dft_seq_im'], 'A_dft_hid_re': _A_in['dft_hid_re'], 'A_dft_hid_im': _A_in['dft_hid_im'], 'B_x': _B_in['x'], 'B_w_gate': _B_in['w_gate'], 'B_w_up': _B_in['w_up'], 'B_w_down': _B_in['w_down'], 'c': _w((lambda *s: torch.randn(*s, dtype=torch.bfloat16) * 0.1)(1, 1024) * 8.0), 'w_mod': _w((lambda *s: torch.randn(*s, dtype=torch.bfloat16) * 0.1)(1024, 6 * 1024) * 1024 ** (-0.5) * 8.0)}

def reference(A_x, A_dft_seq_re, A_dft_seq_im, A_dft_hid_re, A_dft_hid_im, B_x, B_w_gate, B_w_up, B_w_down, c, w_mod):

    def _A_ref(x, dft_seq_re, dft_seq_im, dft_hid_re, dft_hid_im):
        a = torch.einsum('bsd,ed->bse', x, dft_hid_re)
        b = torch.einsum('bsd,ed->bse', x, dft_hid_im)
        y = torch.einsum('ts,bse->bte', dft_seq_re, a) - torch.einsum('ts,bse->bte', dft_seq_im, b)
        return y

    def _B_ref(x, w_gate, w_up, w_down):
        return _gelu(x @ w_gate) * (x @ w_up) @ w_down
    x = A_x
    mod = (_silu(c) @ w_mod).reshape(c.shape[0], 6, 1, -1)
    sa, ca, ga, sb, cb, gb = (mod[:, 0].clone(), mod[:, 1].clone(), mod[:, 2].clone(), mod[:, 3].clone(), mod[:, 4].clone(), mod[:, 5].clone())
    h = _layernorm(x, axis=-1) * (1 + ca) + sa
    x = x + ga * _A_ref(h, A_dft_seq_re, A_dft_seq_im, A_dft_hid_re, A_dft_hid_im)
    h = _layernorm(x, axis=-1) * (1 + cb) + sb
    x = x + gb * _B_ref(h, B_w_gate, B_w_up, B_w_down)
    return x
```

```asm
; @launch kernel=l1_kernel grid=(512,1,1) block=(512,1,1) lds=18688
; @launch kernel=l2_kernel grid=(512,1,1) block=(512,1,1) lds=55296
; @launch kernel=l3_kernel grid=(256,1,1) block=(576,1,1) lds=82432
; @launch kernel=gemm3_kernel grid=(256,1,1) block=(256,1,1) lds=131072
; @launch kernel=gemm4_kernel grid=(256,1,1) block=(256,1,1) lds=66048
.amdgcn_target "amdgcn-amd-amdhsa--gfx950"
.text
.globl l1_kernel
.p2align 8
.type l1_kernel,@function
l1_kernel:
    s_cmp_ge_u32 s2, 512
    s_cbranch_scc1 l1_kernel_end
    s_load_dwordx2 s[26:27], s[0:1], 64
    s_load_dwordx2 s[4:5], s[0:1], 0
    s_load_dwordx4 s[8:11], s[0:1], 72
    s_load_dwordx2 s[6:7], s[0:1], 104
    v_lshrrev_b32 v1, 6, v0
    v_and_b32 v2, 63, v0
    v_readfirstlane_b32 s12, v1
    s_and_b32 s13, s2, 7
    s_cmp_ge_u32 s2, 256
    s_cbranch_scc1 l1_kernel_gemv
    s_lshr_b32 s14, s2, 3
    s_and_b32 s15, s14, 7
    s_lshl_b32 s16, s13, 3
    s_add_u32 s15, s15, s16
    s_lshr_b32 s16, s14, 3
    s_lshl_b32 s17, s16, 3
    s_add_u32 s17, s17, s12
    s_lshl_b32 s17, s17, 6
    s_add_u32 s17, s17, s15
    s_lshl_b32 s17, s17, 11
    v_lshlrev_b32 v3, 4, v2
    v_add_u32 v4, s17, v3
    s_waitcnt lgkmcnt(0)
    global_load_dwordx4 v[8:11], v4, s[4:5]
    global_load_dwordx4 v[12:15], v4, s[4:5] offset:1024
    s_mul_i32 s18, s12, 2080
    v_add_u32 v5, s18, v3
    v_bfe_u32 v6, v2, 4, 1
    v_lshlrev_b32 v6, 1, v6
    v_lshrrev_b32 v7, 5, v2
    v_add_u32 v6, v6, v7
    v_bfe_u32 v7, v2, 2, 2
    v_mul_u32_u24 v7, 2080, v7
    v_lshl_add_u32 v7, v6, 6, v7
    v_and_b32 v3, 3, v2
    v_lshl_add_u32 v7, v3, 3, v7
    s_lshl_b32 s18, s12, 8
    v_add_u32 v7, s18, v7
    v_and_b32 v3, 15, v2
    v_lshlrev_b32 v3, 14, v3
    v_lshl_add_u32 v3, v6, 4, v3
    s_lshl_b32 s18, s12, 19
    s_lshr_b32 s20, s15, 3
    s_lshl_b32 s20, s20, 11
    s_add_u32 s18, s18, s20
    s_lshr_b32 s20, s16, 1
    s_lshl_b32 s20, s20, 10
    s_add_u32 s18, s18, s20
    s_and_b32 s20, s16, 1
    s_lshl_b32 s20, s20, 9
    s_add_u32 s18, s18, s20
    s_and_b32 s20, s15, 7
    s_lshl_b32 s20, s20, 6
    s_add_u32 s18, s18, s20
    s_add_u32 s18, s18, 1048576
    v_add_u32 v3, s18, v3
    s_waitcnt vmcnt(0)
    v_lshlrev_b32 v16, 16, v8
    s_nop 0
    v_readfirstlane_b32 s21, v16
    v_and_b32 v17, 0xffff0000, v8
    v_lshlrev_b32 v18, 16, v9
    v_and_b32 v19, 0xffff0000, v9
    v_lshlrev_b32 v20, 16, v10
    v_and_b32 v21, 0xffff0000, v10
    v_lshlrev_b32 v22, 16, v11
    v_and_b32 v23, 0xffff0000, v11
    v_lshlrev_b32 v24, 16, v12
    v_and_b32 v25, 0xffff0000, v12
    v_lshlrev_b32 v26, 16, v13
    v_and_b32 v27, 0xffff0000, v13
    v_lshlrev_b32 v28, 16, v14
    v_and_b32 v29, 0xffff0000, v14
    v_lshlrev_b32 v30, 16, v15
    v_and_b32 v31, 0xffff0000, v15
    v_subrev_f32 v16, s21, v16
    v_subrev_f32 v17, s21, v17
    v_subrev_f32 v18, s21, v18
    v_subrev_f32 v19, s21, v19
    v_subrev_f32 v20, s21, v20
    v_subrev_f32 v21, s21, v21
    v_subrev_f32 v22, s21, v22
    v_subrev_f32 v23, s21, v23
    v_subrev_f32 v24, s21, v24
    v_subrev_f32 v25, s21, v25
    v_subrev_f32 v26, s21, v26
    v_subrev_f32 v27, s21, v27
    v_subrev_f32 v28, s21, v28
    v_subrev_f32 v29, s21, v29
    v_subrev_f32 v30, s21, v30
    v_subrev_f32 v31, s21, v31
    v_pk_add_f32 v[32:33], v[16:17], v[18:19]
    v_pk_mul_f32 v[34:35], v[16:17], v[16:17]
    v_pk_fma_f32 v[34:35], v[18:19], v[18:19], v[34:35]
    v_pk_add_f32 v[32:33], v[32:33], v[20:21]
    v_pk_fma_f32 v[34:35], v[20:21], v[20:21], v[34:35]
    v_pk_add_f32 v[32:33], v[32:33], v[22:23]
    v_pk_fma_f32 v[34:35], v[22:23], v[22:23], v[34:35]
    v_pk_add_f32 v[32:33], v[32:33], v[24:25]
    v_pk_fma_f32 v[34:35], v[24:25], v[24:25], v[34:35]
    v_pk_add_f32 v[32:33], v[32:33], v[26:27]
    v_pk_fma_f32 v[34:35], v[26:27], v[26:27], v[34:35]
    v_pk_add_f32 v[32:33], v[32:33], v[28:29]
    v_pk_fma_f32 v[34:35], v[28:29], v[28:29], v[34:35]
    v_pk_add_f32 v[32:33], v[32:33], v[30:31]
    v_pk_fma_f32 v[34:35], v[30:31], v[30:31], v[34:35]
    v_add_f32 v32, v32, v33
    v_add_f32 v33, v34, v35
    s_nop 0
    v_add_f32_dpp v32, v32, v32 quad_perm:[1,0,3,2] row_mask:0xf bank_mask:0xf
    v_add_f32_dpp v33, v33, v33 quad_perm:[1,0,3,2] row_mask:0xf bank_mask:0xf
    s_nop 0
    v_add_f32_dpp v32, v32, v32 quad_perm:[2,3,0,1] row_mask:0xf bank_mask:0xf
    v_add_f32_dpp v33, v33, v33 quad_perm:[2,3,0,1] row_mask:0xf bank_mask:0xf
    s_nop 0
    v_add_f32_dpp v32, v32, v32 row_half_mirror row_mask:0xf bank_mask:0xf
    v_add_f32_dpp v33, v33, v33 row_half_mirror row_mask:0xf bank_mask:0xf
    s_nop 0
    v_add_f32_dpp v32, v32, v32 row_mirror row_mask:0xf bank_mask:0xf
    v_add_f32_dpp v33, v33, v33 row_mirror row_mask:0xf bank_mask:0xf
    s_nop 0
    v_mov_b32 v34, v32
    v_mov_b32 v35, v33
    s_nop 0
    v_permlane16_swap_b32 v32, v34
    v_permlane16_swap_b32 v33, v35
    v_add_f32 v32, v32, v34
    v_add_f32 v33, v33, v35
    s_nop 0
    v_mov_b32 v34, v32
    v_mov_b32 v35, v33
    s_nop 0
    v_permlane32_swap_b32 v32, v34
    v_permlane32_swap_b32 v33, v35
    v_add_f32 v32, v32, v34
    v_add_f32 v33, v33, v35
    s_nop 0
    v_mul_f32 v32, 0x3a800000, v32
    v_mul_f32 v33, 0x3a800000, v33
    v_fma_f32 v33, -v32, v32, v33
    v_max_f32 v33, 0, v33
    v_add_f32 v32, s21, v32
    v_cvt_pk_bf16_f32 v33, v33, v33
    v_and_b32 v33, 0xffff0000, v33
    v_cvt_pk_bf16_f32 v32, v32, v32
    v_and_b32 v32, 0xffff0000, v32
    v_add_f32 v33, 0x3727c5ac, v33
    v_sub_f32 v32, s21, v32
    v_cvt_pk_bf16_f32 v33, v33, v33
    v_and_b32 v33, 0xffff0000, v33
    v_sqrt_f32 v33, v33
    v_mov_b32 v34, v32
    v_cvt_pk_bf16_f32 v33, v33, v33
    v_and_b32 v33, 0xffff0000, v33
    v_rcp_f32 v36, v33
    v_mov_b32 v35, v32
    v_mov_b32 v37, v36
    v_pk_add_f32 v[16:17], v[16:17], v[34:35]
    v_pk_add_f32 v[18:19], v[18:19], v[34:35]
    v_pk_add_f32 v[20:21], v[20:21], v[34:35]
    v_pk_add_f32 v[22:23], v[22:23], v[34:35]
    v_pk_add_f32 v[24:25], v[24:25], v[34:35]
    v_pk_add_f32 v[26:27], v[26:27], v[34:35]
    v_pk_add_f32 v[28:29], v[28:29], v[34:35]
    v_pk_add_f32 v[30:31], v[30:31], v[34:35]
    v_cvt_pk_bf16_f32 v40, v16, v17
    v_cvt_pk_bf16_f32 v41, v18, v19
    v_cvt_pk_bf16_f32 v42, v20, v21
    v_cvt_pk_bf16_f32 v43, v22, v23
    v_cvt_pk_bf16_f32 v44, v24, v25
    v_cvt_pk_bf16_f32 v45, v26, v27
    v_cvt_pk_bf16_f32 v46, v28, v29
    v_cvt_pk_bf16_f32 v47, v30, v31
    v_lshlrev_b32 v16, 16, v40
    v_and_b32 v17, 0xffff0000, v40
    v_lshlrev_b32 v18, 16, v41
    v_and_b32 v19, 0xffff0000, v41
    v_lshlrev_b32 v20, 16, v42
    v_and_b32 v21, 0xffff0000, v42
    v_lshlrev_b32 v22, 16, v43
    v_and_b32 v23, 0xffff0000, v43
    v_lshlrev_b32 v24, 16, v44
    v_and_b32 v25, 0xffff0000, v44
    v_lshlrev_b32 v26, 16, v45
    v_and_b32 v27, 0xffff0000, v45
    v_lshlrev_b32 v28, 16, v46
    v_and_b32 v29, 0xffff0000, v46
    v_lshlrev_b32 v30, 16, v47
    v_and_b32 v31, 0xffff0000, v47
    v_pk_mul_f32 v[16:17], v[16:17], v[36:37]
    v_pk_mul_f32 v[18:19], v[18:19], v[36:37]
    v_pk_mul_f32 v[20:21], v[20:21], v[36:37]
    v_pk_mul_f32 v[22:23], v[22:23], v[36:37]
    v_pk_mul_f32 v[24:25], v[24:25], v[36:37]
    v_pk_mul_f32 v[26:27], v[26:27], v[36:37]
    v_pk_mul_f32 v[28:29], v[28:29], v[36:37]
    v_pk_mul_f32 v[30:31], v[30:31], v[36:37]
    v_cvt_pk_bf16_f32 v40, v16, v17
    v_cvt_pk_bf16_f32 v41, v18, v19
    v_cvt_pk_bf16_f32 v42, v20, v21
    v_cvt_pk_bf16_f32 v43, v22, v23
    v_cvt_pk_bf16_f32 v44, v24, v25
    v_cvt_pk_bf16_f32 v45, v26, v27
    v_cvt_pk_bf16_f32 v46, v28, v29
    v_cvt_pk_bf16_f32 v47, v30, v31
    ds_write_b128 v5, v[40:43] offset:0
    ds_write_b128 v5, v[44:47] offset:1024
    s_waitcnt lgkmcnt(0)
    s_barrier
    ds_read_b64_tr_b16 v[16:17], v7 offset:0
    ds_read_b64_tr_b16 v[18:19], v7 offset:8320
    ds_read_b64_tr_b16 v[20:21], v7 offset:32
    ds_read_b64_tr_b16 v[22:23], v7 offset:8352
    s_waitcnt lgkmcnt(2)
    global_store_dwordx4 v3, v[16:19], s[6:7]
    v_add_u32 v3, 262144, v3
    s_waitcnt lgkmcnt(0)
    global_store_dwordx4 v3, v[20:23], s[6:7]
    s_branch l1_kernel_fin
l1_kernel_gemv:
    s_and_b32 s18, s2, 31
    s_lshr_b32 s19, s2, 5
    s_and_b32 s19, s19, 7
    v_and_b32 v2, 63, v0
    v_lshrrev_b32 v4, 3, v0
    s_lshl_b32 s20, s19, 7
    v_add_u32 v4, s20, v4
    v_lshlrev_b32 v5, 1, v4
    v_mul_u32_u24 v4, 12288, v4
    v_and_b32 v6, 7, v0
    v_lshl_add_u32 v4, v6, 4, v4
    s_lshl_b32 s20, s18, 7
    s_add_u32 s20, s20, 0
    v_add_u32 v4, s20, v4
    v_add_u32 v7, 786432, v4
    s_waitcnt lgkmcnt(0)
    global_load_dwordx4 v[16:19], v4, s[10:11]
    global_load_dwordx4 v[20:23], v7, s[10:11]
    global_load_ushort v24, v5, s[8:9]
    global_load_ushort v25, v5, s[8:9] offset:128
    s_getpc_b64 s[22:23]
l1_kernel_pc:
    s_add_u32 s22, s22, l2_kernel-l1_kernel_pc
    s_addc_u32 s23, s23, 0
    s_lshr_b32 s20, s2, 3
    s_and_b32 s20, s20, 31
    s_lshl_b32 s20, s20, 5
    v_add_u32 v8, s20, v0
    v_lshlrev_b32 v8, 6, v8
    v_mov_b32 v9, code_end-l2_kernel
    v_cmp_lt_u32 vcc, v8, v9
    v_cmp_gt_u32 s[24:25], 32, v0
    s_nop 1
    s_and_b64 vcc, vcc, s[24:25]
    s_and_saveexec_b64 s[24:25], vcc
    s_cbranch_execz l1_kernel_nopf
    global_load_dword v10, v8, s[22:23]
l1_kernel_nopf:
    s_mov_b64 exec, s[24:25]
    s_sub_u32 s20, s2, 256
    s_cmp_lt_u32 s20, 8
    s_cbranch_scc0 l1_kernel_noz
    s_lshl_b32 s20, s20, 11
    s_add_u32 s20, s20, 196608
    v_lshlrev_b32 v8, 2, v0
    v_add_u32 v8, s20, v8
    v_mov_b32 v9, 0
    global_store_dword v8, v9, s[6:7]
l1_kernel_noz:
    s_waitcnt vmcnt(0)
    v_lshlrev_b32 v24, 16, v24
    v_mul_f32 v5, 0xbfb8aa3b, v24
    v_exp_f32 v5, v5
    s_nop 0
    v_add_f32 v5, 1.0, v5
    v_rcp_f32 v5, v5
    s_nop 0
    v_mul_f32 v24, v24, v5
    v_cvt_pk_bf16_f32 v24, v24, v24
    v_and_b32 v24, 0xffff0000, v24
    v_lshlrev_b32 v25, 16, v25
    v_mul_f32 v5, 0xbfb8aa3b, v25
    v_exp_f32 v5, v5
    s_nop 0
    v_add_f32 v5, 1.0, v5
    v_rcp_f32 v5, v5
    s_nop 0
    v_mul_f32 v25, v25, v5
    v_cvt_pk_bf16_f32 v25, v25, v25
    v_and_b32 v25, 0xffff0000, v25
    v_lshlrev_b32 v5, 16, v16
    v_and_b32 v16, 0xffff0000, v16
    v_mul_f32 v32, v24, v5
    v_mul_f32 v33, v24, v16
    v_lshlrev_b32 v5, 16, v17
    v_and_b32 v17, 0xffff0000, v17
    v_mul_f32 v34, v24, v5
    v_mul_f32 v35, v24, v17
    v_lshlrev_b32 v5, 16, v18
    v_and_b32 v18, 0xffff0000, v18
    v_mul_f32 v36, v24, v5
    v_mul_f32 v37, v24, v18
    v_lshlrev_b32 v5, 16, v19
    v_and_b32 v19, 0xffff0000, v19
    v_mul_f32 v38, v24, v5
    v_mul_f32 v39, v24, v19
    v_lshlrev_b32 v5, 16, v20
    v_and_b32 v20, 0xffff0000, v20
    v_fmac_f32 v32, v25, v5
    v_fmac_f32 v33, v25, v20
    v_lshlrev_b32 v5, 16, v21
    v_and_b32 v21, 0xffff0000, v21
    v_fmac_f32 v34, v25, v5
    v_fmac_f32 v35, v25, v21
    v_lshlrev_b32 v5, 16, v22
    v_and_b32 v22, 0xffff0000, v22
    v_fmac_f32 v36, v25, v5
    v_fmac_f32 v37, v25, v22
    v_lshlrev_b32 v5, 16, v23
    v_and_b32 v23, 0xffff0000, v23
    v_fmac_f32 v38, v25, v5
    v_fmac_f32 v39, v25, v23
    v_lshlrev_b32 v5, 5, v0
    v_add_u32 v5, 0, v5
    ds_write_b128 v5, v[32:35]
    ds_write_b128 v5, v[36:39] offset:16
    s_lshl_b32 s20, s12, 11
    s_add_u32 s20, s20, 0
    v_lshlrev_b32 v5, 2, v2
    v_add_u32 v5, s20, v5
    s_waitcnt lgkmcnt(0)
    ds_read_b32 v32, v5 offset:0
    ds_read_b32 v33, v5 offset:256
    ds_read_b32 v34, v5 offset:512
    ds_read_b32 v35, v5 offset:768
    ds_read_b32 v36, v5 offset:1024
    ds_read_b32 v37, v5 offset:1280
    ds_read_b32 v38, v5 offset:1536
    ds_read_b32 v39, v5 offset:1792
    s_waitcnt lgkmcnt(0)
    v_add_f32 v32, v32, v33
    v_add_f32 v34, v34, v35
    v_add_f32 v36, v36, v37
    v_add_f32 v38, v38, v39
    v_add_f32 v32, v32, v34
    v_add_f32 v36, v36, v38
    v_add_f32 v32, v32, v36
    v_lshlrev_b32 v5, 2, v0
    v_add_u32 v5, 16384, v5
    ds_write_b32 v5, v32
    s_waitcnt lgkmcnt(0)
    s_barrier
    s_cmp_eq_u32 s12, 0
    s_cbranch_scc0 l1_kernel_fin
    ds_read_b32 v32, v5 offset:0
    ds_read_b32 v33, v5 offset:256
    ds_read_b32 v34, v5 offset:512
    ds_read_b32 v35, v5 offset:768
    ds_read_b32 v36, v5 offset:1024
    ds_read_b32 v37, v5 offset:1280
    ds_read_b32 v38, v5 offset:1536
    ds_read_b32 v39, v5 offset:1792
    s_waitcnt lgkmcnt(0)
    v_add_f32 v32, v32, v33
    v_add_f32 v34, v34, v35
    v_add_f32 v36, v36, v37
    v_add_f32 v38, v38, v39
    v_add_f32 v32, v32, v34
    v_add_f32 v36, v36, v38
    v_add_f32 v32, v32, v36
    s_lshl_b32 s20, s18, 11
    s_lshl_b32 s21, s19, 2
    s_add_u32 s20, s20, s21
    s_add_u32 s20, s20, 0
    v_lshlrev_b32 v5, 5, v2
    v_add_u32 v5, s20, v5
    global_store_dword v5, v32, s[6:7]
l1_kernel_fin:
l1_kernel_end:
    s_endpgm

.globl l2_kernel
.p2align 8
.type l2_kernel,@function
l2_kernel:
    s_cmp_ge_u32 s2, 512
    s_cbranch_scc1 l2_kernel_end
    s_load_dwordx4 s[8:11], s[0:1], 72
    s_load_dwordx2 s[6:7], s[0:1], 104
    s_load_dwordx4 s[28:31], s[0:1], 48
    v_lshrrev_b32 v1, 6, v0
    v_and_b32 v2, 63, v0
    v_readfirstlane_b32 s12, v1
    s_and_b32 s13, s2, 7
    s_lshr_b32 s14, s2, 3
    v_lshlrev_b32 v3, 4, v2
    s_cmp_ge_u32 s2, 256
    s_cbranch_scc1 l2_kernel_gemv
    s_getpc_b64 s[4:5]
l2_kernel_pc:
    s_add_u32 s4, s4, tab_W1-l2_kernel_pc
    s_addc_u32 s5, s5, 0
    s_add_u32 s44, s12, 0
    s_min_u32 s44, s44, 19
    s_lshl_b32 s44, s44, 10
    s_add_u32 m0, s44, 34816
    v_add_u32 v4, s44, v3
    global_load_lds_dwordx4 v4, s[4:5]
    s_add_u32 s44, s12, 8
    s_min_u32 s44, s44, 19
    s_lshl_b32 s44, s44, 10
    s_add_u32 m0, s44, 34816
    v_add_u32 v4, s44, v3
    global_load_lds_dwordx4 v4, s[4:5]
    s_add_u32 s44, s12, 16
    s_min_u32 s44, s44, 19
    s_lshl_b32 s44, s44, 10
    s_add_u32 m0, s44, 34816
    v_add_u32 v4, s44, v3
    global_load_lds_dwordx4 v4, s[4:5]
    s_and_b32 s15, s12, 1
    s_lshl_b32 s16, s13, 5
    s_add_u32 s16, s16, s14
    s_lshl_b32 s16, s16, 14
    s_lshl_b32 s17, s12, 11
    s_add_u32 s16, s16, s17
    s_add_u32 s16, s16, 1048576
    v_add_u32 v5, s16, v3
    v_lshrrev_b32 v6, 5, v2
    v_lshlrev_b32 v7, 10, v6
    v_bfe_u32 v1, v2, 3, 2
    v_lshl_add_u32 v7, v1, 5, v7
    s_lshl_b32 s16, s13, 7
    s_add_u32 s16, s16, s14
    v_add_u32 v7, s16, v7
    v_lshlrev_b32 v7, 3, v7
    v_and_b32 v1, 7, v2
    v_add_u32 v7, v7, v1
    v_lshlrev_b32 v7, 2, v7
    v_add_u32 v7, 0, v7
    s_waitcnt lgkmcnt(0)
    global_load_dwordx4 v[8:11], v5, s[6:7]
    global_load_dwordx4 v[12:15], v5, s[6:7] offset:1024
    global_load_dword v0, v7, s[6:7]
    v_bfe_u32 v4, v2, 2, 3
    s_lshl_b32 s16, s12, 3
    v_add_u32 v4, s16, v4
    v_cvt_f32_u32 v5, v4
    v_mul_f32 v5, 0x3a000000, v5
    v_cvt_f32_u32 v7, v6
    v_mul_f32 v7, v7, v5
    v_mul_f32 v7, 0x41000000, v7
    v_fmamk_f32 v96, v5, 0x0, v7
    v_fmamk_f32 v98, v5, 0x3f800000, v7
    v_fmamk_f32 v100, v5, 0x40000000, v7
    v_fmamk_f32 v102, v5, 0x40400000, v7
    v_fmamk_f32 v104, v5, 0x40800000, v7
    v_fmamk_f32 v106, v5, 0x40a00000, v7
    v_fmamk_f32 v108, v5, 0x40c00000, v7
    v_fmamk_f32 v110, v5, 0x40e00000, v7
    v_fmamk_f32 v112, v5, 0x41800000, v7
    v_fmamk_f32 v114, v5, 0x41880000, v7
    v_fmamk_f32 v116, v5, 0x41900000, v7
    v_fmamk_f32 v118, v5, 0x41980000, v7
    v_fmamk_f32 v120, v5, 0x41a00000, v7
    v_fmamk_f32 v122, v5, 0x41a80000, v7
    v_fmamk_f32 v124, v5, 0x41b00000, v7
    v_fmamk_f32 v126, v5, 0x41b80000, v7
    v_sin_f32 v97, v96
    v_cos_f32 v96, v96
    v_sin_f32 v99, v98
    v_cos_f32 v98, v98
    v_sin_f32 v101, v100
    v_cos_f32 v100, v100
    v_sin_f32 v103, v102
    v_cos_f32 v102, v102
    v_sin_f32 v105, v104
    v_cos_f32 v104, v104
    v_sin_f32 v107, v106
    v_cos_f32 v106, v106
    v_sin_f32 v109, v108
    v_cos_f32 v108, v108
    v_sin_f32 v111, v110
    v_cos_f32 v110, v110
    v_sin_f32 v113, v112
    v_cos_f32 v112, v112
    v_sin_f32 v115, v114
    v_cos_f32 v114, v114
    v_sin_f32 v117, v116
    v_cos_f32 v116, v116
    v_sin_f32 v119, v118
    v_cos_f32 v118, v118
    v_sin_f32 v121, v120
    v_cos_f32 v120, v120
    v_sin_f32 v123, v122
    v_cos_f32 v122, v122
    v_sin_f32 v125, v124
    v_cos_f32 v124, v124
    v_sin_f32 v127, v126
    v_cos_f32 v126, v126
    v_and_b32 v7, 3, v2
    v_lshl_add_u32 v7, v6, 5, v7
    v_mul_u32_u24 v7, 68, v7
    v_add_u32 v7, v7, v4
    v_lshlrev_b32 v7, 2, v7
    v_and_b32 v5, 31, v2
    s_lshr_b32 s16, s12, 1
    s_lshl_b32 s17, s16, 5
    v_add_u32 v5, s17, v5
    v_mul_u32_u24 v5, 272, v5
    v_lshl_add_u32 v5, v6, 4, v5
    s_lshl_b32 s17, s13, 5
    s_add_u32 s17, s17, s14
    s_mul_i32 s17, s17, 16448
    s_add_u32 s17, s17, 5242880
    s_lshr_b32 s16, s12, 1
    s_lshl_b32 s16, s16, 7
    s_lshl_b32 s20, s15, 13
    s_add_u32 s16, s16, s20
    s_add_u32 s16, s16, s17
    v_and_b32 v4, 15, v2
    v_lshlrev_b32 v4, 9, v4
    v_bfe_u32 v1, v2, 4, 1
    v_lshl_add_u32 v4, v1, 5, v4
    v_lshl_add_u32 v4, v6, 4, v4
    v_add_u32 v4, s16, v4
    s_lshl_b32 s16, s15, 13
    s_add_u32 s16, s16, 38912
    v_add_u32 v1, s16, v3
    s_waitcnt vmcnt(3)
    s_barrier
    ds_read_b128 v[16:19], v3 offset:34816
    ds_read_b128 v[20:23], v3 offset:35840
    ds_read_b128 v[24:27], v3 offset:36864
    ds_read_b128 v[28:31], v3 offset:37888
    ds_read_b128 v[32:35], v1 offset:0
    ds_read_b128 v[36:39], v1 offset:1024
    ds_read_b128 v[40:43], v1 offset:2048
    ds_read_b128 v[44:47], v1 offset:3072
    ds_read_b128 v[48:51], v1 offset:4096
    ds_read_b128 v[52:55], v1 offset:5120
    ds_read_b128 v[56:59], v1 offset:6144
    ds_read_b128 v[60:63], v1 offset:7168
    s_waitcnt vmcnt(0)
    s_waitcnt lgkmcnt(8)
    v_mfma_f32_32x32x16_bf16 v[64:79], v[16:19], v[8:11], 0
    v_mfma_f32_32x32x16_bf16 v[80:95], v[24:27], v[8:11], 0
    v_mfma_f32_32x32x16_bf16 v[64:79], v[20:23], v[12:15], v[64:79]
    v_mfma_f32_32x32x16_bf16 v[80:95], v[28:31], v[12:15], v[80:95]
    v_add_f32_dpp v0, v0, v0 quad_perm:[1,0,3,2] row_mask:0xf bank_mask:0xf
    s_nop 1
    v_add_f32_dpp v0, v0, v0 quad_perm:[2,3,0,1] row_mask:0xf bank_mask:0xf
    s_nop 1
    v_add_f32_dpp v0, v0, v0 row_half_mirror row_mask:0xf bank_mask:0xf
    s_nop 1
    v_cvt_pk_bf16_f32 v0, v0, v0
    v_and_b32 v0, 0xffff0000, v0
    v_add_f32 v1, 1.0, v0
    v_cvt_pk_bf16_f32 v1, v1, v1
    v_and_b32 v1, 0xffff0000, v1
    v_mul_f32 v0, 0x45000000, v0
    s_nop 0
    v_readlane_b32 s24, v0, 0
    v_readlane_b32 s32, v1, 32
    v_readlane_b32 s25, v0, 8
    v_readlane_b32 s33, v1, 40
    v_readlane_b32 s26, v0, 16
    v_readlane_b32 s34, v1, 48
    v_readlane_b32 s27, v0, 24
    v_readlane_b32 s35, v1, 56
    v_pk_mul_f32 v[8:9], v[64:65], v[96:97] op_sel:[0,0] op_sel_hi:[1,0]
    v_pk_fma_f32 v[8:9], v[64:65], v[96:97], v[8:9] op_sel:[1,1,0] op_sel_hi:[0,1,1] neg_hi:[1,0,0]
    v_cvt_pk_bf16_f32 v8, v8, v9
    ds_write_b32 v7, v8 offset:0
    v_pk_mul_f32 v[10:11], v[66:67], v[98:99] op_sel:[0,0] op_sel_hi:[1,0]
    v_pk_fma_f32 v[10:11], v[66:67], v[98:99], v[10:11] op_sel:[1,1,0] op_sel_hi:[0,1,1] neg_hi:[1,0,0]
    v_cvt_pk_bf16_f32 v10, v10, v11
    ds_write_b32 v7, v10 offset:1088
    v_pk_mul_f32 v[12:13], v[68:69], v[100:101] op_sel:[0,0] op_sel_hi:[1,0]
    v_pk_fma_f32 v[12:13], v[68:69], v[100:101], v[12:13] op_sel:[1,1,0] op_sel_hi:[0,1,1] neg_hi:[1,0,0]
    v_cvt_pk_bf16_f32 v12, v12, v13
    ds_write_b32 v7, v12 offset:2176
    v_pk_mul_f32 v[14:15], v[70:71], v[102:103] op_sel:[0,0] op_sel_hi:[1,0]
    v_pk_fma_f32 v[14:15], v[70:71], v[102:103], v[14:15] op_sel:[1,1,0] op_sel_hi:[0,1,1] neg_hi:[1,0,0]
    v_cvt_pk_bf16_f32 v14, v14, v15
    ds_write_b32 v7, v14 offset:3264
    v_pk_mul_f32 v[8:9], v[72:73], v[104:105] op_sel:[0,0] op_sel_hi:[1,0]
    v_pk_fma_f32 v[8:9], v[72:73], v[104:105], v[8:9] op_sel:[1,1,0] op_sel_hi:[0,1,1] neg_hi:[1,0,0]
    v_cvt_pk_bf16_f32 v8, v8, v9
    ds_write_b32 v7, v8 offset:4352
    v_pk_mul_f32 v[10:11], v[74:75], v[106:107] op_sel:[0,0] op_sel_hi:[1,0]
    v_pk_fma_f32 v[10:11], v[74:75], v[106:107], v[10:11] op_sel:[1,1,0] op_sel_hi:[0,1,1] neg_hi:[1,0,0]
    v_cvt_pk_bf16_f32 v10, v10, v11
    ds_write_b32 v7, v10 offset:5440
    v_pk_mul_f32 v[12:13], v[76:77], v[108:109] op_sel:[0,0] op_sel_hi:[1,0]
    v_pk_fma_f32 v[12:13], v[76:77], v[108:109], v[12:13] op_sel:[1,1,0] op_sel_hi:[0,1,1] neg_hi:[1,0,0]
    v_cvt_pk_bf16_f32 v12, v12, v13
    ds_write_b32 v7, v12 offset:6528
    v_pk_mul_f32 v[14:15], v[78:79], v[110:111] op_sel:[0,0] op_sel_hi:[1,0]
    v_pk_fma_f32 v[14:15], v[78:79], v[110:111], v[14:15] op_sel:[1,1,0] op_sel_hi:[0,1,1] neg_hi:[1,0,0]
    v_cvt_pk_bf16_f32 v14, v14, v15
    ds_write_b32 v7, v14 offset:7616
    v_pk_mul_f32 v[8:9], v[80:81], v[112:113] op_sel:[0,0] op_sel_hi:[1,0]
    v_pk_fma_f32 v[8:9], v[80:81], v[112:113], v[8:9] op_sel:[1,1,0] op_sel_hi:[0,1,1] neg_hi:[1,0,0]
    v_cvt_pk_bf16_f32 v8, v8, v9
    ds_write_b32 v7, v8 offset:17408
    v_pk_mul_f32 v[10:11], v[82:83], v[114:115] op_sel:[0,0] op_sel_hi:[1,0]
    v_pk_fma_f32 v[10:11], v[82:83], v[114:115], v[10:11] op_sel:[1,1,0] op_sel_hi:[0,1,1] neg_hi:[1,0,0]
    v_cvt_pk_bf16_f32 v10, v10, v11
    ds_write_b32 v7, v10 offset:18496
    v_pk_mul_f32 v[12:13], v[84:85], v[116:117] op_sel:[0,0] op_sel_hi:[1,0]
    v_pk_fma_f32 v[12:13], v[84:85], v[116:117], v[12:13] op_sel:[1,1,0] op_sel_hi:[0,1,1] neg_hi:[1,0,0]
    v_cvt_pk_bf16_f32 v12, v12, v13
    ds_write_b32 v7, v12 offset:19584
    v_pk_mul_f32 v[14:15], v[86:87], v[118:119] op_sel:[0,0] op_sel_hi:[1,0]
    v_pk_fma_f32 v[14:15], v[86:87], v[118:119], v[14:15] op_sel:[1,1,0] op_sel_hi:[0,1,1] neg_hi:[1,0,0]
    v_cvt_pk_bf16_f32 v14, v14, v15
    ds_write_b32 v7, v14 offset:20672
    v_pk_mul_f32 v[8:9], v[88:89], v[120:121] op_sel:[0,0] op_sel_hi:[1,0]
    v_pk_fma_f32 v[8:9], v[88:89], v[120:121], v[8:9] op_sel:[1,1,0] op_sel_hi:[0,1,1] neg_hi:[1,0,0]
    v_cvt_pk_bf16_f32 v8, v8, v9
    ds_write_b32 v7, v8 offset:21760
    v_pk_mul_f32 v[10:11], v[90:91], v[122:123] op_sel:[0,0] op_sel_hi:[1,0]
    v_pk_fma_f32 v[10:11], v[90:91], v[122:123], v[10:11] op_sel:[1,1,0] op_sel_hi:[0,1,1] neg_hi:[1,0,0]
    v_cvt_pk_bf16_f32 v10, v10, v11
    ds_write_b32 v7, v10 offset:22848
    v_pk_mul_f32 v[12:13], v[92:93], v[124:125] op_sel:[0,0] op_sel_hi:[1,0]
    v_pk_fma_f32 v[12:13], v[92:93], v[124:125], v[12:13] op_sel:[1,1,0] op_sel_hi:[0,1,1] neg_hi:[1,0,0]
    v_cvt_pk_bf16_f32 v12, v12, v13
    ds_write_b32 v7, v12 offset:23936
    v_pk_mul_f32 v[14:15], v[94:95], v[126:127] op_sel:[0,0] op_sel_hi:[1,0]
    v_pk_fma_f32 v[14:15], v[94:95], v[126:127], v[14:15] op_sel:[1,1,0] op_sel_hi:[0,1,1] neg_hi:[1,0,0]
    v_cvt_pk_bf16_f32 v14, v14, v15
    ds_write_b32 v7, v14 offset:25024
    v_mov_b32 v16, 0x00003f80
    v_mov_b32 v17, 0x0000bf80
    v_mov_b32 v18, 0x00003f80
    v_mov_b32 v19, 0x0000bf80
    s_waitcnt lgkmcnt(0)
    s_barrier
    ds_read_b128 v[96:99], v5 offset:0
    ds_read_b128 v[100:103], v5 offset:32
    ds_read_b128 v[104:107], v5 offset:64
    ds_read_b128 v[108:111], v5 offset:96
    ds_read_b128 v[112:115], v5 offset:128
    ds_read_b128 v[116:119], v5 offset:160
    ds_read_b128 v[120:123], v5 offset:192
    ds_read_b128 v[124:127], v5 offset:224
    s_waitcnt lgkmcnt(7)
    v_mfma_f32_32x32x16_bf16 v[64:79], v[96:99], v[32:35], 0
    s_waitcnt lgkmcnt(6)
    v_mfma_f32_32x32x16_bf16 v[64:79], v[100:103], v[36:39], v[64:79]
    s_waitcnt lgkmcnt(5)
    v_mfma_f32_32x32x16_bf16 v[64:79], v[104:107], v[40:43], v[64:79]
    s_waitcnt lgkmcnt(4)
    v_mfma_f32_32x32x16_bf16 v[64:79], v[108:111], v[44:47], v[64:79]
    s_waitcnt lgkmcnt(3)
    v_mfma_f32_32x32x16_bf16 v[64:79], v[112:115], v[48:51], v[64:79]
    s_waitcnt lgkmcnt(2)
    v_mfma_f32_32x32x16_bf16 v[64:79], v[116:119], v[52:55], v[64:79]
    s_waitcnt lgkmcnt(1)
    v_mfma_f32_32x32x16_bf16 v[64:79], v[120:123], v[56:59], v[64:79]
    s_waitcnt lgkmcnt(0)
    v_mfma_f32_32x32x16_bf16 v[64:79], v[124:127], v[60:63], v[64:79]
    s_cmp_eq_u32 s12, 0
    s_cbranch_scc0 l2_kernel_no1024
    v_mfma_f32_32x32x16_bf16 v[80:95], v[96:99], v[16:19], 0
    v_mfma_f32_32x32x16_bf16 v[80:95], v[100:103], v[16:19], v[80:95]
    v_mfma_f32_32x32x16_bf16 v[80:95], v[104:107], v[16:19], v[80:95]
    v_mfma_f32_32x32x16_bf16 v[80:95], v[108:111], v[16:19], v[80:95]
    v_mfma_f32_32x32x16_bf16 v[80:95], v[112:115], v[16:19], v[80:95]
    v_mfma_f32_32x32x16_bf16 v[80:95], v[116:119], v[16:19], v[80:95]
    v_mfma_f32_32x32x16_bf16 v[80:95], v[120:123], v[16:19], v[80:95]
    v_mfma_f32_32x32x16_bf16 v[80:95], v[124:127], v[16:19], v[80:95]
l2_kernel_no1024:
    s_cmp_eq_u32 s12, 0
    s_cselect_b32 s20, 1, 0
    s_mov_b32 s21, 0
    s_mov_b64 vcc, s[20:21]
    v_mov_b32 v8, s24
    v_cndmask_b32 v8, 0, v8, vcc
    v_mov_b32 v9, s25
    v_cndmask_b32 v9, 0, v9, vcc
    v_mov_b32 v10, s26
    v_cndmask_b32 v10, 0, v10, vcc
    v_mov_b32 v11, s27
    v_cndmask_b32 v11, 0, v11, vcc
    s_nop 3
    v_fma_f32 v64, v64, s32, v8
    v_fma_f32 v65, v65, s33, v9
    v_fma_f32 v66, v66, s34, v10
    v_fma_f32 v67, v67, s35, v11
    v_mul_f32 v68, s32, v68
    v_mul_f32 v69, s33, v69
    v_mul_f32 v70, s34, v70
    v_mul_f32 v71, s35, v71
    v_mul_f32 v72, s32, v72
    v_mul_f32 v73, s33, v73
    v_mul_f32 v74, s34, v74
    v_mul_f32 v75, s35, v75
    v_mul_f32 v76, s32, v76
    v_mul_f32 v77, s33, v77
    v_mul_f32 v78, s34, v78
    v_mul_f32 v79, s35, v79
    v_cvt_pk_bf16_f32 v8, v64, v65
    v_cvt_pk_bf16_f32 v9, v66, v67
    v_cvt_pk_bf16_f32 v10, v68, v69
    v_cvt_pk_bf16_f32 v11, v70, v71
    v_cvt_pk_bf16_f32 v12, v72, v73
    v_cvt_pk_bf16_f32 v13, v74, v75
    v_cvt_pk_bf16_f32 v14, v76, v77
    v_cvt_pk_bf16_f32 v15, v78, v79
    s_nop 0
    v_permlane16_swap_b32 v8, v10
    v_permlane16_swap_b32 v9, v11
    global_store_dwordx4 v4, v[8:11], s[6:7] offset:0
    v_permlane16_swap_b32 v12, v14
    v_permlane16_swap_b32 v13, v15
    global_store_dwordx4 v4, v[12:15], s[6:7] offset:64
    s_cmp_eq_u32 s12, 0
    s_cbranch_scc0 l2_kernel_fin
    v_mul_f32 v80, s32, v80
    v_mul_f32 v81, s33, v81
    v_mul_f32 v82, s34, v82
    v_mul_f32 v83, s35, v83
    v_cvt_pk_bf16_f32 v80, v80, v81
    v_cvt_pk_bf16_f32 v81, v82, v83
    v_mov_b32 v82, 0
    v_mov_b32 v83, 0
    s_lshr_b32 s16, s13, 1
    s_lshl_b32 s16, s16, 10
    s_and_b32 s20, s13, 1
    s_lshl_b32 s20, s20, 5
    s_add_u32 s20, s20, s14
    s_lshl_b32 s20, s20, 4
    s_add_u32 s16, s16, s20
    s_add_u32 s16, s16, 327680
    v_mov_b32 v4, s16
    s_mov_b64 exec, 1
    global_store_dwordx4 v4, v[80:83], s[6:7]
    s_mov_b64 exec, -1
    s_branch l2_kernel_fin
l2_kernel_gemv:
    s_and_b32 s18, s14, 7
    s_lshl_b32 s20, s13, 3
    s_add_u32 s18, s18, s20
    s_lshr_b32 s19, s2, 6
    s_and_b32 s19, s19, 3
    v_lshrrev_b32 v4, 3, v0
    s_lshl_b32 s20, s19, 8
    v_add_u32 v4, s20, v4
    v_lshlrev_b32 v5, 1, v4
    v_mul_u32_u24 v4, 12288, v4
    v_and_b32 v6, 7, v0
    v_lshl_add_u32 v4, v6, 4, v4
    s_lshl_b32 s20, s18, 7
    s_add_u32 s20, s20, 4096
    v_add_u32 v4, s20, v4
    s_waitcnt lgkmcnt(0)
    global_load_ushort v32, v5, s[8:9] offset:0
    global_load_ushort v33, v5, s[8:9] offset:128
    global_load_ushort v34, v5, s[8:9] offset:256
    global_load_ushort v35, v5, s[8:9] offset:384
    global_load_dwordx4 v[16:19], v4, s[10:11]
    v_add_u32 v4, 786432, v4
    global_load_dwordx4 v[20:23], v4, s[10:11]
    v_add_u32 v4, 786432, v4
    global_load_dwordx4 v[24:27], v4, s[10:11]
    v_add_u32 v4, 786432, v4
    global_load_dwordx4 v[28:31], v4, s[10:11]
    s_waitcnt vmcnt(4)
    v_lshlrev_b32 v32, 16, v32
    v_mul_f32 v5, 0xbfb8aa3b, v32
    v_exp_f32 v5, v5
    s_nop 0
    v_add_f32 v5, 1.0, v5
    v_rcp_f32 v5, v5
    s_nop 0
    v_mul_f32 v32, v32, v5
    v_cvt_pk_bf16_f32 v32, v32, v32
    v_and_b32 v32, 0xffff0000, v32
    v_lshlrev_b32 v33, 16, v33
    v_mul_f32 v5, 0xbfb8aa3b, v33
    v_exp_f32 v5, v5
    s_nop 0
    v_add_f32 v5, 1.0, v5
    v_rcp_f32 v5, v5
    s_nop 0
    v_mul_f32 v33, v33, v5
    v_cvt_pk_bf16_f32 v33, v33, v33
    v_and_b32 v33, 0xffff0000, v33
    v_lshlrev_b32 v34, 16, v34
    v_mul_f32 v5, 0xbfb8aa3b, v34
    v_exp_f32 v5, v5
    s_nop 0
    v_add_f32 v5, 1.0, v5
    v_rcp_f32 v5, v5
    s_nop 0
    v_mul_f32 v34, v34, v5
    v_cvt_pk_bf16_f32 v34, v34, v34
    v_and_b32 v34, 0xffff0000, v34
    v_lshlrev_b32 v35, 16, v35
    v_mul_f32 v5, 0xbfb8aa3b, v35
    v_exp_f32 v5, v5
    s_nop 0
    v_add_f32 v5, 1.0, v5
    v_rcp_f32 v5, v5
    s_nop 0
    v_mul_f32 v35, v35, v5
    v_cvt_pk_bf16_f32 v35, v35, v35
    v_and_b32 v35, 0xffff0000, v35
    s_waitcnt vmcnt(0)
    v_lshlrev_b32 v5, 16, v16
    v_and_b32 v16, 0xffff0000, v16
    v_mul_f32 v36, v32, v5
    v_mul_f32 v37, v32, v16
    v_lshlrev_b32 v5, 16, v17
    v_and_b32 v17, 0xffff0000, v17
    v_mul_f32 v38, v32, v5
    v_mul_f32 v39, v32, v17
    v_lshlrev_b32 v5, 16, v18
    v_and_b32 v18, 0xffff0000, v18
    v_mul_f32 v40, v32, v5
    v_mul_f32 v41, v32, v18
    v_lshlrev_b32 v5, 16, v19
    v_and_b32 v19, 0xffff0000, v19
    v_mul_f32 v42, v32, v5
    v_mul_f32 v43, v32, v19
    v_lshlrev_b32 v5, 16, v20
    v_and_b32 v20, 0xffff0000, v20
    v_fmac_f32 v36, v33, v5
    v_fmac_f32 v37, v33, v20
    v_lshlrev_b32 v5, 16, v21
    v_and_b32 v21, 0xffff0000, v21
    v_fmac_f32 v38, v33, v5
    v_fmac_f32 v39, v33, v21
    v_lshlrev_b32 v5, 16, v22
    v_and_b32 v22, 0xffff0000, v22
    v_fmac_f32 v40, v33, v5
    v_fmac_f32 v41, v33, v22
    v_lshlrev_b32 v5, 16, v23
    v_and_b32 v23, 0xffff0000, v23
    v_fmac_f32 v42, v33, v5
    v_fmac_f32 v43, v33, v23
    v_lshlrev_b32 v5, 16, v24
    v_and_b32 v24, 0xffff0000, v24
    v_fmac_f32 v36, v34, v5
    v_fmac_f32 v37, v34, v24
    v_lshlrev_b32 v5, 16, v25
    v_and_b32 v25, 0xffff0000, v25
    v_fmac_f32 v38, v34, v5
    v_fmac_f32 v39, v34, v25
    v_lshlrev_b32 v5, 16, v26
    v_and_b32 v26, 0xffff0000, v26
    v_fmac_f32 v40, v34, v5
    v_fmac_f32 v41, v34, v26
    v_lshlrev_b32 v5, 16, v27
    v_and_b32 v27, 0xffff0000, v27
    v_fmac_f32 v42, v34, v5
    v_fmac_f32 v43, v34, v27
    v_lshlrev_b32 v5, 16, v28
    v_and_b32 v28, 0xffff0000, v28
    v_fmac_f32 v36, v35, v5
    v_fmac_f32 v37, v35, v28
    v_lshlrev_b32 v5, 16, v29
    v_and_b32 v29, 0xffff0000, v29
    v_fmac_f32 v38, v35, v5
    v_fmac_f32 v39, v35, v29
    v_lshlrev_b32 v5, 16, v30
    v_and_b32 v30, 0xffff0000, v30
    v_fmac_f32 v40, v35, v5
    v_fmac_f32 v41, v35, v30
    v_lshlrev_b32 v5, 16, v31
    v_and_b32 v31, 0xffff0000, v31
    v_fmac_f32 v42, v35, v5
    v_fmac_f32 v43, v35, v31
    v_lshlrev_b32 v5, 5, v0
    v_add_u32 v5, 0, v5
    ds_write_b128 v5, v[36:39]
    ds_write_b128 v5, v[40:43] offset:16
    s_lshl_b32 s20, s12, 11
    s_add_u32 s20, s20, 0
    v_lshlrev_b32 v5, 2, v2
    v_add_u32 v5, s20, v5
    s_waitcnt lgkmcnt(0)
    ds_read_b32 v36, v5 offset:0
    ds_read_b32 v37, v5 offset:256
    ds_read_b32 v38, v5 offset:512
    ds_read_b32 v39, v5 offset:768
    ds_read_b32 v40, v5 offset:1024
    ds_read_b32 v41, v5 offset:1280
    ds_read_b32 v42, v5 offset:1536
    ds_read_b32 v43, v5 offset:1792
    s_waitcnt lgkmcnt(0)
    v_add_f32 v36, v36, v37
    v_add_f32 v38, v38, v39
    v_add_f32 v40, v40, v41
    v_add_f32 v42, v42, v43
    v_add_f32 v36, v36, v38
    v_add_f32 v40, v40, v42
    v_add_f32 v36, v36, v40
    v_lshlrev_b32 v5, 2, v0
    v_add_u32 v5, 16384, v5
    ds_write_b32 v5, v36
    s_waitcnt lgkmcnt(0)
    s_barrier
    s_cmp_eq_u32 s12, 0
    s_cbranch_scc0 l2_kernel_fin
    ds_read_b32 v36, v5 offset:0
    ds_read_b32 v37, v5 offset:256
    ds_read_b32 v38, v5 offset:512
    ds_read_b32 v39, v5 offset:768
    ds_read_b32 v40, v5 offset:1024
    ds_read_b32 v41, v5 offset:1280
    ds_read_b32 v42, v5 offset:1536
    ds_read_b32 v43, v5 offset:1792
    s_waitcnt lgkmcnt(0)
    v_add_f32 v36, v36, v37
    v_add_f32 v38, v38, v39
    v_add_f32 v40, v40, v41
    v_add_f32 v42, v42, v43
    v_add_f32 v36, v36, v38
    v_add_f32 v40, v40, v42
    v_add_f32 v36, v36, v40
    s_lshl_b32 s20, s18, 8
    s_add_u32 s20, s20, 196608
    v_lshlrev_b32 v5, 2, v2
    v_add_u32 v5, s20, v5
    global_atomic_add_f32 v5, v36, s[6:7]
l2_kernel_fin:
l2_kernel_end:
    s_endpgm

.globl l3_kernel
.p2align 8
.type l3_kernel,@function
l3_kernel:
    s_cmp_ge_u32 s2, 256
    s_cbranch_scc1 l3_kernel_end
    s_load_dwordx2 s[6:7], s[0:1], 104
    s_load_dwordx2 s[4:5], s[0:1], 0
    s_load_dwordx4 s[28:31], s[0:1], 48
    s_getpc_b64 s[24:25]
l3_kernel_pc:
    s_add_u32 s24, s24, tab_W4-l3_kernel_pc
    s_addc_u32 s25, s25, 0
    v_lshrrev_b32 v1, 6, v0
    v_and_b32 v2, 63, v0
    v_readfirstlane_b32 s12, v1
    v_lshlrev_b32 v3, 4, v2
    s_cmp_eq_u32 s12, 8
    s_cbranch_scc0 l3_kernel_notw8
    s_cmp_eq_u32 s2, 0
    s_cbranch_scc0 l3_kernel_end
    v_lshrrev_b32 v6, 5, v2
    v_and_b32 v7, 31, v2
    v_lshlrev_b32 v5, 6, v7
    v_lshl_add_u32 v5, v6, 5, v5
    s_mov_b32 s13, 1024
    s_mov_b32 s14, 1
    s_mov_b32 s45, 0
    v_add_u32 v4, 327680, v3
    s_waitcnt lgkmcnt(0)
    global_load_dwordx4 v[8:11], v4, s[6:7] offset:0
    global_load_dwordx4 v[12:15], v4, s[6:7] offset:1024
    global_load_dwordx4 v[16:19], v4, s[6:7] offset:2048
    global_load_dwordx4 v[20:23], v4, s[6:7] offset:3072
    s_mov_b32 s47, 4
    s_branch l3_kernel_rolea
l3_kernel_notw8:
    s_add_u32 s44, s12, 0
    s_min_u32 s44, s44, 11
    s_lshl_b32 s44, s44, 10
    s_add_u32 m0, s44, 0
    v_add_u32 v4, s44, v3
    global_load_lds_dwordx4 v4, s[24:25]
    s_add_u32 s44, s12, 8
    s_min_u32 s44, s44, 11
    s_lshl_b32 s44, s44, 10
    s_add_u32 m0, s44, 0
    v_add_u32 v4, s44, v3
    global_load_lds_dwordx4 v4, s[24:25]
    v_lshrrev_b32 v6, 5, v2
    v_and_b32 v7, 31, v2
    v_lshlrev_b32 v5, 6, v7
    v_lshl_add_u32 v5, v6, 5, v5
    s_and_b32 s13, s2, 7
    s_lshl_b32 s13, s13, 5
    s_lshr_b32 s14, s2, 3
    s_add_u32 s13, s13, s14
    s_cmp_eq_u32 s2, 256
    s_cselect_b32 s13, 256, s13
    s_lshl_b32 s13, s13, 2
    s_mov_b32 s45, s13
    s_and_b32 s17, s12, 3
    s_add_u32 s13, s13, s17
    s_cmp_le_u32 s13, 1024
    s_cselect_b32 s14, 1, 0
    s_min_u32 s13, s13, 1024
    v_lshrrev_b32 v4, 2, v2
    s_lshl_b32 s18, s12, 5
    v_add_u32 v4, s18, v4
    v_mul_u32_u24 v4, 16448, v4
    v_lshrrev_b32 v1, 2, v2
    v_xor_b32 v1, v1, v2
    v_and_b32 v1, 3, v1
    v_lshl_add_u32 v4, v1, 4, v4
    s_and_b32 s17, s12, 3
    s_lshl_b32 s18, s45, 4
    s_add_u32 s18, s18, 5242880
    v_add_u32 v4, s18, v4
    s_lshl_b32 s18, s12, 11
    s_waitcnt lgkmcnt(0)
    s_add_u32 m0, s18, 66048
    s_nop 0
    global_load_lds_dwordx4 v4, s[6:7]
    s_add_u32 m0, s18, 67072
    v_add_u32 v4, 263168, v4
    global_load_lds_dwordx4 v4, s[6:7]
    s_mov_b32 s47, s12
    s_cmp_ge_u32 s12, 4
    s_cbranch_scc1 l3_kernel_roleb
l3_kernel_rolea:
    s_lshl_b32 s17, s13, 11
    v_add_u32 v59, s17, v5
    v_mov_b32 v0, v3
    global_load_dwordx4 v[120:123], v59, s[4:5]
    global_load_dwordx4 v[124:127], v59, s[4:5] offset:16
    v_cvt_f32_u32 v56, v7
    v_mul_f32 v56, 0x3a800000, v56
    v_cvt_f32_u32 v57, v6
    v_mul_f32 v57, v57, v56
    v_mul_f32 v57, 0x41000000, v57
    v_fmamk_f32 v88, v56, 0x0, v57
    v_fmamk_f32 v90, v56, 0x3f800000, v57
    v_fmamk_f32 v92, v56, 0x40000000, v57
    v_fmamk_f32 v94, v56, 0x40400000, v57
    v_fmamk_f32 v96, v56, 0x40800000, v57
    v_fmamk_f32 v98, v56, 0x40a00000, v57
    v_fmamk_f32 v100, v56, 0x40c00000, v57
    v_fmamk_f32 v102, v56, 0x40e00000, v57
    v_fmamk_f32 v104, v56, 0x41800000, v57
    v_fmamk_f32 v106, v56, 0x41880000, v57
    v_fmamk_f32 v108, v56, 0x41900000, v57
    v_fmamk_f32 v110, v56, 0x41980000, v57
    v_fmamk_f32 v112, v56, 0x41a00000, v57
    v_fmamk_f32 v114, v56, 0x41a80000, v57
    v_fmamk_f32 v116, v56, 0x41b00000, v57
    v_fmamk_f32 v118, v56, 0x41b80000, v57
    v_sin_f32 v89, v88
    v_cos_f32 v88, v88
    v_sin_f32 v91, v90
    v_cos_f32 v90, v90
    v_sin_f32 v93, v92
    v_cos_f32 v92, v92
    v_sin_f32 v95, v94
    v_cos_f32 v94, v94
    v_sin_f32 v97, v96
    v_cos_f32 v96, v96
    v_sin_f32 v99, v98
    v_cos_f32 v98, v98
    v_sin_f32 v101, v100
    v_cos_f32 v100, v100
    v_sin_f32 v103, v102
    v_cos_f32 v102, v102
    v_sin_f32 v105, v104
    v_cos_f32 v104, v104
    v_sin_f32 v107, v106
    v_cos_f32 v106, v106
    v_sin_f32 v109, v108
    v_cos_f32 v108, v108
    v_sin_f32 v111, v110
    v_cos_f32 v110, v110
    v_sin_f32 v113, v112
    v_cos_f32 v112, v112
    v_sin_f32 v115, v114
    v_cos_f32 v114, v114
    v_sin_f32 v117, v116
    v_cos_f32 v116, v116
    v_sin_f32 v119, v118
    v_cos_f32 v118, v118
    s_mul_i32 s17, s47, 4608
    s_add_u32 s17, s17, 27648
    v_mul_u32_u24 v56, 1152, v6
    v_lshl_add_u32 v56, v7, 2, v56
    v_add_u32 v3, s17, v56
    v_bfe_u32 v56, v7, 2, 1
    v_lshlrev_b32 v56, 4, v56
    v_lshrrev_b32 v57, 3, v7
    v_lshl_add_u32 v56, v57, 2, v56
    v_and_b32 v57, 3, v7
    v_add_u32 v56, v56, v57
    v_mul_u32_u24 v56, 144, v56
    v_lshl_add_u32 v56, v6, 4, v56
    v_add_u32 v4, s17, v56
    v_lshl_add_u32 v1, v7, 1, v6
    v_mul_u32_u24 v1, 80, v1
    s_and_b32 s17, s12, 3
    v_xor_b32 v56, s17, v2
    v_and_b32 v56, 3, v56
    v_lshlrev_b32 v56, 4, v56
    v_lshl_add_u32 v56, v2, 6, v56
    v_add_u32 v56, 66048, v56
    s_waitcnt vmcnt(2)
    s_barrier
    s_cmp_eq_u32 s12, 8
    s_cbranch_scc1 l3_kernel_nozr
    ds_read_b128 v[8:11], v56 offset:0
    ds_read_b128 v[12:15], v56 offset:4096
    ds_read_b128 v[16:19], v56 offset:8192
    ds_read_b128 v[20:23], v56 offset:12288
l3_kernel_nozr:
    ds_read_b128 v[24:27], v0 offset:0
    ds_read_b128 v[28:31], v0 offset:1024
    ds_read_b128 v[32:35], v0 offset:2048
    ds_read_b128 v[36:39], v0 offset:3072
    ds_read_b128 v[40:43], v0 offset:4096
    ds_read_b128 v[44:47], v0 offset:5120
    ds_read_b128 v[48:51], v0 offset:6144
    ds_read_b128 v[52:55], v0 offset:7168
    s_waitcnt lgkmcnt(0)
    v_mfma_f32_32x32x16_bf16 v[56:71], v[24:27], v[8:11], 0
    v_mfma_f32_32x32x16_bf16 v[72:87], v[40:43], v[8:11], 0
    v_mfma_f32_32x32x16_bf16 v[56:71], v[28:31], v[12:15], v[56:71]
    v_mfma_f32_32x32x16_bf16 v[72:87], v[44:47], v[12:15], v[72:87]
    v_mfma_f32_32x32x16_bf16 v[56:71], v[32:35], v[16:19], v[56:71]
    v_mfma_f32_32x32x16_bf16 v[72:87], v[48:51], v[16:19], v[72:87]
    v_mfma_f32_32x32x16_bf16 v[56:71], v[36:39], v[20:23], v[56:71]
    v_mfma_f32_32x32x16_bf16 v[72:87], v[52:55], v[20:23], v[72:87]
    s_nop 5
    ds_read_b128 v[24:27], v0 offset:8192
    ds_read_b128 v[28:31], v0 offset:9216
    ds_read_b128 v[32:35], v0 offset:10240
    ds_read_b128 v[36:39], v0 offset:11264
    s_nop 1
    v_pk_mul_f32 v[8:9], v[56:57], v[88:89] op_sel:[0,0] op_sel_hi:[1,0]
    v_pk_fma_f32 v[8:9], v[56:57], v[88:89], v[8:9] op_sel:[1,1,0] op_sel_hi:[0,1,1] neg_hi:[1,0,0]
    v_cvt_pk_bf16_f32 v8, v8, v9
    ds_write_b32 v3, v8 offset:0
    v_pk_mul_f32 v[10:11], v[58:59], v[90:91] op_sel:[0,0] op_sel_hi:[1,0]
    v_pk_fma_f32 v[10:11], v[58:59], v[90:91], v[10:11] op_sel:[1,1,0] op_sel_hi:[0,1,1] neg_hi:[1,0,0]
    v_cvt_pk_bf16_f32 v10, v10, v11
    ds_write_b32 v3, v10 offset:144
    v_pk_mul_f32 v[12:13], v[60:61], v[92:93] op_sel:[0,0] op_sel_hi:[1,0]
    v_pk_fma_f32 v[12:13], v[60:61], v[92:93], v[12:13] op_sel:[1,1,0] op_sel_hi:[0,1,1] neg_hi:[1,0,0]
    v_cvt_pk_bf16_f32 v12, v12, v13
    ds_write_b32 v3, v12 offset:288
    v_pk_mul_f32 v[14:15], v[62:63], v[94:95] op_sel:[0,0] op_sel_hi:[1,0]
    v_pk_fma_f32 v[14:15], v[62:63], v[94:95], v[14:15] op_sel:[1,1,0] op_sel_hi:[0,1,1] neg_hi:[1,0,0]
    v_cvt_pk_bf16_f32 v14, v14, v15
    ds_write_b32 v3, v14 offset:432
    v_pk_mul_f32 v[8:9], v[64:65], v[96:97] op_sel:[0,0] op_sel_hi:[1,0]
    v_pk_fma_f32 v[8:9], v[64:65], v[96:97], v[8:9] op_sel:[1,1,0] op_sel_hi:[0,1,1] neg_hi:[1,0,0]
    v_cvt_pk_bf16_f32 v8, v8, v9
    ds_write_b32 v3, v8 offset:576
    v_pk_mul_f32 v[10:11], v[66:67], v[98:99] op_sel:[0,0] op_sel_hi:[1,0]
    v_pk_fma_f32 v[10:11], v[66:67], v[98:99], v[10:11] op_sel:[1,1,0] op_sel_hi:[0,1,1] neg_hi:[1,0,0]
    v_cvt_pk_bf16_f32 v10, v10, v11
    ds_write_b32 v3, v10 offset:720
    v_pk_mul_f32 v[12:13], v[68:69], v[100:101] op_sel:[0,0] op_sel_hi:[1,0]
    v_pk_fma_f32 v[12:13], v[68:69], v[100:101], v[12:13] op_sel:[1,1,0] op_sel_hi:[0,1,1] neg_hi:[1,0,0]
    v_cvt_pk_bf16_f32 v12, v12, v13
    ds_write_b32 v3, v12 offset:864
    v_pk_mul_f32 v[14:15], v[70:71], v[102:103] op_sel:[0,0] op_sel_hi:[1,0]
    v_pk_fma_f32 v[14:15], v[70:71], v[102:103], v[14:15] op_sel:[1,1,0] op_sel_hi:[0,1,1] neg_hi:[1,0,0]
    v_cvt_pk_bf16_f32 v14, v14, v15
    ds_write_b32 v3, v14 offset:1008
    v_pk_mul_f32 v[8:9], v[72:73], v[104:105] op_sel:[0,0] op_sel_hi:[1,0]
    v_pk_fma_f32 v[8:9], v[72:73], v[104:105], v[8:9] op_sel:[1,1,0] op_sel_hi:[0,1,1] neg_hi:[1,0,0]
    v_cvt_pk_bf16_f32 v8, v8, v9
    ds_write_b32 v3, v8 offset:2304
    v_pk_mul_f32 v[10:11], v[74:75], v[106:107] op_sel:[0,0] op_sel_hi:[1,0]
    v_pk_fma_f32 v[10:11], v[74:75], v[106:107], v[10:11] op_sel:[1,1,0] op_sel_hi:[0,1,1] neg_hi:[1,0,0]
    v_cvt_pk_bf16_f32 v10, v10, v11
    ds_write_b32 v3, v10 offset:2448
    v_pk_mul_f32 v[12:13], v[76:77], v[108:109] op_sel:[0,0] op_sel_hi:[1,0]
    v_pk_fma_f32 v[12:13], v[76:77], v[108:109], v[12:13] op_sel:[1,1,0] op_sel_hi:[0,1,1] neg_hi:[1,0,0]
    v_cvt_pk_bf16_f32 v12, v12, v13
    ds_write_b32 v3, v12 offset:2592
    v_pk_mul_f32 v[14:15], v[78:79], v[110:111] op_sel:[0,0] op_sel_hi:[1,0]
    v_pk_fma_f32 v[14:15], v[78:79], v[110:111], v[14:15] op_sel:[1,1,0] op_sel_hi:[0,1,1] neg_hi:[1,0,0]
    v_cvt_pk_bf16_f32 v14, v14, v15
    ds_write_b32 v3, v14 offset:2736
    v_pk_mul_f32 v[8:9], v[80:81], v[112:113] op_sel:[0,0] op_sel_hi:[1,0]
    v_pk_fma_f32 v[8:9], v[80:81], v[112:113], v[8:9] op_sel:[1,1,0] op_sel_hi:[0,1,1] neg_hi:[1,0,0]
    v_cvt_pk_bf16_f32 v8, v8, v9
    ds_write_b32 v3, v8 offset:2880
    v_pk_mul_f32 v[10:11], v[82:83], v[114:115] op_sel:[0,0] op_sel_hi:[1,0]
    v_pk_fma_f32 v[10:11], v[82:83], v[114:115], v[10:11] op_sel:[1,1,0] op_sel_hi:[0,1,1] neg_hi:[1,0,0]
    v_cvt_pk_bf16_f32 v10, v10, v11
    ds_write_b32 v3, v10 offset:3024
    v_pk_mul_f32 v[12:13], v[84:85], v[116:117] op_sel:[0,0] op_sel_hi:[1,0]
    v_pk_fma_f32 v[12:13], v[84:85], v[116:117], v[12:13] op_sel:[1,1,0] op_sel_hi:[0,1,1] neg_hi:[1,0,0]
    v_cvt_pk_bf16_f32 v12, v12, v13
    ds_write_b32 v3, v12 offset:3168
    v_pk_mul_f32 v[14:15], v[86:87], v[118:119] op_sel:[0,0] op_sel_hi:[1,0]
    v_pk_fma_f32 v[14:15], v[86:87], v[118:119], v[14:15] op_sel:[1,1,0] op_sel_hi:[0,1,1] neg_hi:[1,0,0]
    v_cvt_pk_bf16_f32 v14, v14, v15
    ds_write_b32 v3, v14 offset:3312
    s_waitcnt lgkmcnt(0)
    ds_read_b128 v[88:91], v4 offset:0
    ds_read_b128 v[92:95], v4 offset:32
    ds_read_b128 v[96:99], v4 offset:64
    ds_read_b128 v[100:103], v4 offset:96
    s_waitcnt lgkmcnt(3)
    v_mfma_f32_32x32x16_bf16 v[56:71], v[88:91], v[24:27], 0
    s_waitcnt lgkmcnt(2)
    v_mfma_f32_32x32x16_bf16 v[56:71], v[92:95], v[28:31], v[56:71]
    s_waitcnt lgkmcnt(1)
    v_mfma_f32_32x32x16_bf16 v[56:71], v[96:99], v[32:35], v[56:71]
    s_waitcnt lgkmcnt(0)
    v_mfma_f32_32x32x16_bf16 v[56:71], v[100:103], v[36:39], v[56:71]
    s_mul_i32 s17, s47, 3072
    s_add_u32 s17, s17, 50688
    v_lshl_add_u32 v3, v7, 1, v6
    v_mul_u32_u24 v3, 48, v3
    v_add_u32 v3, s17, v3
    s_nop 9
    v_cvt_pk_bf16_f32 v40, v56, v57
    v_cvt_pk_bf16_f32 v41, v58, v59
    v_cvt_pk_bf16_f32 v42, v60, v61
    v_cvt_pk_bf16_f32 v43, v62, v63
    v_cvt_pk_bf16_f32 v44, v64, v65
    v_cvt_pk_bf16_f32 v45, v66, v67
    v_cvt_pk_bf16_f32 v46, v68, v69
    v_cvt_pk_bf16_f32 v47, v70, v71
    ds_write_b128 v3, v[40:43]
    ds_write_b128 v3, v[44:47] offset:16
    v_lshlrev_b32 v56, 16, v40
    v_and_b32 v57, 0xffff0000, v40
    v_lshlrev_b32 v58, 16, v41
    v_and_b32 v59, 0xffff0000, v41
    v_lshlrev_b32 v60, 16, v42
    v_and_b32 v61, 0xffff0000, v42
    v_lshlrev_b32 v62, 16, v43
    v_and_b32 v63, 0xffff0000, v43
    v_lshlrev_b32 v64, 16, v44
    v_and_b32 v65, 0xffff0000, v44
    v_lshlrev_b32 v66, 16, v45
    v_and_b32 v67, 0xffff0000, v45
    v_lshlrev_b32 v68, 16, v46
    v_and_b32 v69, 0xffff0000, v46
    v_lshlrev_b32 v70, 16, v47
    v_and_b32 v71, 0xffff0000, v47
    s_waitcnt lgkmcnt(0)
    s_barrier
    s_mov_b32 s15, s13
    s_mov_b32 s16, s14
    s_waitcnt vmcnt(0)
    s_branch l3_kernel_row
l3_kernel_roleb:
    v_subrev_u32 v3, 256, v0
    v_lshlrev_b32 v4, 4, v3
    v_add_u32 v4, 196608, v4
    s_sub_u32 s15, 2048, s13
    s_and_b32 s15, s15, 2047
    s_and_b32 s16, s13, 1023
    s_cmp_lg_u32 s16, 0
    s_cselect_b32 s16, s14, 0
    s_lshl_b32 s17, s15, 11
    v_add_u32 v1, s17, v5
    v_add_u32 v40, 0, v4
    global_load_dwordx4 v[56:59], v40, s[6:7]
    v_add_u32 v40, 4096, v4
    global_load_dwordx4 v[60:63], v40, s[6:7]
    v_add_u32 v40, 8192, v4
    global_load_dwordx4 v[64:67], v40, s[6:7]
    global_load_dwordx4 v[120:123], v1, s[4:5]
    global_load_dwordx4 v[124:127], v1, s[4:5] offset:16
    s_waitcnt vmcnt(5)
    s_barrier
    s_and_b32 s40, s2, 7
    s_mul_i32 s40, s40, 896
    s_lshr_b32 s41, s2, 3
    s_min_u32 s41, s41, 31
    s_lshl_b32 s41, s41, 1
    s_and_b32 s42, s12, 1
    s_add_u32 s41, s41, s42
    s_mul_i32 s41, s41, 28672
    s_add_u32 s40, s40, s41
    s_bitcmp1_b32 s12, 1
    s_cselect_b32 s42, s30, s28
    s_cselect_b32 s43, s31, s29
    v_lshrrev_b32 v40, 3, v2
    v_min_u32 v40, 3, v40
    v_mul_u32_u24 v40, 7168, v40
    v_and_b32 v41, 7, v2
    v_min_u32 v41, 6, v41
    v_lshl_add_u32 v40, v41, 7, v40
    v_add_u32 v40, s40, v40
    global_load_dword v55, v40, s[42:43]
    s_waitcnt vmcnt(3)
    v_cvt_pk_bf16_f32 v56, v56, v56
    v_and_b32 v56, 0xffff0000, v56
    v_cvt_pk_bf16_f32 v57, v57, v57
    v_and_b32 v57, 0xffff0000, v57
    v_cvt_pk_bf16_f32 v58, v58, v58
    v_and_b32 v58, 0xffff0000, v58
    v_cvt_pk_bf16_f32 v59, v59, v59
    v_and_b32 v59, 0xffff0000, v59
    v_cvt_pk_bf16_f32 v60, v60, v60
    v_and_b32 v60, 0xffff0000, v60
    v_cvt_pk_bf16_f32 v61, v61, v61
    v_and_b32 v61, 0xffff0000, v61
    v_cvt_pk_bf16_f32 v62, v62, v62
    v_and_b32 v62, 0xffff0000, v62
    v_cvt_pk_bf16_f32 v63, v63, v63
    v_and_b32 v63, 0xffff0000, v63
    v_cvt_pk_bf16_f32 v64, v64, v64
    v_and_b32 v64, 0xffff0000, v64
    v_cvt_pk_bf16_f32 v65, v65, v65
    v_and_b32 v65, 0xffff0000, v65
    v_cvt_pk_bf16_f32 v66, v66, v66
    v_and_b32 v66, 0xffff0000, v66
    v_cvt_pk_bf16_f32 v67, v67, v67
    v_and_b32 v67, 0xffff0000, v67
    v_add_f32 v64, 1.0, v64
    v_cvt_pk_bf16_f32 v64, v64, v64
    v_and_b32 v64, 0xffff0000, v64
    v_add_f32 v65, 1.0, v65
    v_cvt_pk_bf16_f32 v65, v65, v65
    v_and_b32 v65, 0xffff0000, v65
    v_add_f32 v66, 1.0, v66
    v_cvt_pk_bf16_f32 v66, v66, v66
    v_and_b32 v66, 0xffff0000, v66
    v_add_f32 v67, 1.0, v67
    v_cvt_pk_bf16_f32 v67, v67, v67
    v_and_b32 v67, 0xffff0000, v67
    v_lshrrev_b32 v4, 2, v3
    v_mul_u32_u24 v4, 80, v4
    v_and_b32 v41, 3, v3
    v_lshl_add_u32 v4, v41, 4, v4
    ds_write_b128 v4, v[56:59] offset:12288
    ds_write_b128 v4, v[60:63] offset:17408
    ds_write_b128 v4, v[64:67] offset:22528
    v_lshl_add_u32 v1, v7, 1, v6
    s_and_b32 s17, s12, 3
    s_mul_i32 s17, s17, 3072
    s_add_u32 s17, s17, 50688
    v_sub_u32 v3, 63, v1
    v_mul_u32_u24 v3, 48, v3
    v_add_u32 v3, s17, v3
    v_sub_u32 v4, 64, v1
    v_and_b32 v4, 63, v4
    v_mul_u32_u24 v4, 48, v4
    v_add_u32 v4, s17, v4
    v_mul_u32_u24 v1, 80, v1
    s_waitcnt lgkmcnt(0)
    s_barrier
    ds_read_b128 v[72:75], v3
    ds_read_b128 v[76:79], v3 offset:16
    ds_read_b32 v56, v4
    s_waitcnt vmcnt(1) lgkmcnt(0)
    v_lshlrev_b32 v56, 16, v56
    v_and_b32 v71, 0xffff0000, v72
    v_lshlrev_b32 v70, 16, v73
    v_and_b32 v69, 0xffff0000, v73
    v_lshlrev_b32 v68, 16, v74
    v_and_b32 v67, 0xffff0000, v74
    v_lshlrev_b32 v66, 16, v75
    v_and_b32 v65, 0xffff0000, v75
    v_lshlrev_b32 v64, 16, v76
    v_and_b32 v63, 0xffff0000, v76
    v_lshlrev_b32 v62, 16, v77
    v_and_b32 v61, 0xffff0000, v77
    v_lshlrev_b32 v60, 16, v78
    v_and_b32 v59, 0xffff0000, v78
    v_lshlrev_b32 v58, 16, v79
    v_and_b32 v57, 0xffff0000, v79
l3_kernel_row:
    s_lshl_b32 s46, s45, 1
    s_add_u32 s46, s46, s47
    s_cmp_eq_u32 s16, 0
    s_cbranch_scc1 l3_kernel_stage
    ds_read_b128 v[88:91], v1 offset:12288
    ds_read_b128 v[92:95], v1 offset:12304
    ds_read_b128 v[96:99], v1 offset:12320
    ds_read_b128 v[100:103], v1 offset:12336
    ds_read_b128 v[104:107], v1 offset:22528
    ds_read_b128 v[108:111], v1 offset:22544
    ds_read_b128 v[112:115], v1 offset:22560
    ds_read_b128 v[116:119], v1 offset:22576
    ds_read_b128 v[8:11], v1 offset:17408
    ds_read_b128 v[12:15], v1 offset:17424
    ds_read_b128 v[16:19], v1 offset:17440
    ds_read_b128 v[20:23], v1 offset:17456
    v_lshlrev_b32 v72, 16, v120
    v_and_b32 v73, 0xffff0000, v120
    v_lshlrev_b32 v74, 16, v121
    v_and_b32 v75, 0xffff0000, v121
    v_lshlrev_b32 v76, 16, v122
    v_and_b32 v77, 0xffff0000, v122
    v_lshlrev_b32 v78, 16, v123
    v_and_b32 v79, 0xffff0000, v123
    v_lshlrev_b32 v80, 16, v124
    v_and_b32 v81, 0xffff0000, v124
    v_lshlrev_b32 v82, 16, v125
    v_and_b32 v83, 0xffff0000, v125
    v_lshlrev_b32 v84, 16, v126
    v_and_b32 v85, 0xffff0000, v126
    v_lshlrev_b32 v86, 16, v127
    v_and_b32 v87, 0xffff0000, v127
    s_waitcnt lgkmcnt(8)
    v_pk_fma_f32 v[56:57], v[56:57], v[88:89], v[72:73]
    v_pk_fma_f32 v[58:59], v[58:59], v[90:91], v[74:75]
    v_pk_fma_f32 v[60:61], v[60:61], v[92:93], v[76:77]
    v_pk_fma_f32 v[62:63], v[62:63], v[94:95], v[78:79]
    v_pk_fma_f32 v[64:65], v[64:65], v[96:97], v[80:81]
    v_pk_fma_f32 v[66:67], v[66:67], v[98:99], v[82:83]
    v_pk_fma_f32 v[68:69], v[68:69], v[100:101], v[84:85]
    v_pk_fma_f32 v[70:71], v[70:71], v[102:103], v[86:87]
    v_cvt_pk_bf16_f32 v120, v56, v57
    v_cvt_pk_bf16_f32 v121, v58, v59
    v_cvt_pk_bf16_f32 v122, v60, v61
    v_cvt_pk_bf16_f32 v123, v62, v63
    v_cvt_pk_bf16_f32 v124, v64, v65
    v_cvt_pk_bf16_f32 v125, v66, v67
    v_cvt_pk_bf16_f32 v126, v68, v69
    v_cvt_pk_bf16_f32 v127, v70, v71
    v_lshlrev_b32 v56, 16, v120
    v_and_b32 v57, 0xffff0000, v120
    v_lshlrev_b32 v58, 16, v121
    v_and_b32 v59, 0xffff0000, v121
    v_lshlrev_b32 v60, 16, v122
    v_and_b32 v61, 0xffff0000, v122
    v_lshlrev_b32 v62, 16, v123
    v_and_b32 v63, 0xffff0000, v123
    v_lshlrev_b32 v64, 16, v124
    v_and_b32 v65, 0xffff0000, v124
    v_lshlrev_b32 v66, 16, v125
    v_and_b32 v67, 0xffff0000, v125
    v_lshlrev_b32 v68, 16, v126
    v_and_b32 v69, 0xffff0000, v126
    v_lshlrev_b32 v70, 16, v127
    v_and_b32 v71, 0xffff0000, v127
    v_permlane16_swap_b32 v120, v124
    v_permlane16_swap_b32 v121, v125
    v_permlane16_swap_b32 v122, v126
    v_permlane16_swap_b32 v123, v127
    s_lshl_b32 s17, s46, 11
    s_add_u32 s17, s17, 10485760
    v_and_b32 v3, 15, v2
    v_lshlrev_b32 v3, 6, v3
    v_lshrrev_b32 v4, 4, v2
    v_lshl_add_u32 v3, v4, 4, v3
    v_add_u32 v3, s17, v3
    global_store_dwordx4 v3, v[120:123], s[6:7]
    global_store_dwordx4 v3, v[124:127], s[6:7] offset:1024
    v_readfirstlane_b32 s21, v56
    s_nop 1
    v_subrev_f32 v56, s21, v56
    v_subrev_f32 v57, s21, v57
    v_subrev_f32 v58, s21, v58
    v_subrev_f32 v59, s21, v59
    v_subrev_f32 v60, s21, v60
    v_subrev_f32 v61, s21, v61
    v_subrev_f32 v62, s21, v62
    v_subrev_f32 v63, s21, v63
    v_subrev_f32 v64, s21, v64
    v_subrev_f32 v65, s21, v65
    v_subrev_f32 v66, s21, v66
    v_subrev_f32 v67, s21, v67
    v_subrev_f32 v68, s21, v68
    v_subrev_f32 v69, s21, v69
    v_subrev_f32 v70, s21, v70
    v_subrev_f32 v71, s21, v71
    v_pk_add_f32 v[48:49], v[56:57], v[58:59]
    v_pk_mul_f32 v[50:51], v[56:57], v[56:57]
    v_pk_fma_f32 v[50:51], v[58:59], v[58:59], v[50:51]
    v_pk_add_f32 v[48:49], v[48:49], v[60:61]
    v_pk_fma_f32 v[50:51], v[60:61], v[60:61], v[50:51]
    v_pk_add_f32 v[48:49], v[48:49], v[62:63]
    v_pk_fma_f32 v[50:51], v[62:63], v[62:63], v[50:51]
    v_pk_add_f32 v[48:49], v[48:49], v[64:65]
    v_pk_fma_f32 v[50:51], v[64:65], v[64:65], v[50:51]
    v_pk_add_f32 v[48:49], v[48:49], v[66:67]
    v_pk_fma_f32 v[50:51], v[66:67], v[66:67], v[50:51]
    v_pk_add_f32 v[48:49], v[48:49], v[68:69]
    v_pk_fma_f32 v[50:51], v[68:69], v[68:69], v[50:51]
    v_pk_add_f32 v[48:49], v[48:49], v[70:71]
    v_pk_fma_f32 v[50:51], v[70:71], v[70:71], v[50:51]
    v_add_f32 v48, v48, v49
    v_add_f32 v49, v50, v51
    s_nop 0
    v_add_f32_dpp v48, v48, v48 quad_perm:[1,0,3,2] row_mask:0xf bank_mask:0xf
    v_add_f32_dpp v49, v49, v49 quad_perm:[1,0,3,2] row_mask:0xf bank_mask:0xf
    s_nop 0
    v_add_f32_dpp v48, v48, v48 quad_perm:[2,3,0,1] row_mask:0xf bank_mask:0xf
    v_add_f32_dpp v49, v49, v49 quad_perm:[2,3,0,1] row_mask:0xf bank_mask:0xf
    s_nop 0
    v_add_f32_dpp v48, v48, v48 row_half_mirror row_mask:0xf bank_mask:0xf
    v_add_f32_dpp v49, v49, v49 row_half_mirror row_mask:0xf bank_mask:0xf
    s_nop 0
    v_add_f32_dpp v48, v48, v48 row_mirror row_mask:0xf bank_mask:0xf
    v_add_f32_dpp v49, v49, v49 row_mirror row_mask:0xf bank_mask:0xf
    s_nop 0
    v_mov_b32 v50, v48
    v_mov_b32 v51, v49
    s_nop 0
    v_permlane16_swap_b32 v48, v50
    v_permlane16_swap_b32 v49, v51
    v_add_f32 v48, v48, v50
    v_add_f32 v49, v49, v51
    s_nop 0
    v_mov_b32 v50, v48
    v_mov_b32 v51, v49
    s_nop 0
    v_permlane32_swap_b32 v48, v50
    v_permlane32_swap_b32 v49, v51
    v_add_f32 v48, v48, v50
    v_add_f32 v49, v49, v51
    s_nop 0
    v_mul_f32 v48, 0x3a800000, v48
    v_mul_f32 v49, 0x3a800000, v49
    v_fma_f32 v49, -v48, v48, v49
    v_max_f32 v49, 0, v49
    v_add_f32 v48, s21, v48
    v_cvt_pk_bf16_f32 v49, v49, v49
    v_and_b32 v49, 0xffff0000, v49
    v_cvt_pk_bf16_f32 v48, v48, v48
    v_and_b32 v48, 0xffff0000, v48
    v_add_f32 v49, 0x3727c5ac, v49
    v_sub_f32 v48, s21, v48
    v_cvt_pk_bf16_f32 v49, v49, v49
    v_and_b32 v49, 0xffff0000, v49
    v_sqrt_f32 v49, v49
    v_mov_b32 v50, v48
    v_cvt_pk_bf16_f32 v49, v49, v49
    v_and_b32 v49, 0xffff0000, v49
    v_rcp_f32 v52, v49
    v_mov_b32 v51, v48
    v_mov_b32 v53, v52
    v_pk_add_f32 v[56:57], v[56:57], v[50:51]
    v_pk_add_f32 v[58:59], v[58:59], v[50:51]
    v_pk_add_f32 v[60:61], v[60:61], v[50:51]
    v_pk_add_f32 v[62:63], v[62:63], v[50:51]
    v_pk_add_f32 v[64:65], v[64:65], v[50:51]
    v_pk_add_f32 v[66:67], v[66:67], v[50:51]
    v_pk_add_f32 v[68:69], v[68:69], v[50:51]
    v_pk_add_f32 v[70:71], v[70:71], v[50:51]
    s_waitcnt lgkmcnt(0)
    v_pk_mul_f32 v[104:105], v[104:105], v[52:53]
    v_pk_mul_f32 v[106:107], v[106:107], v[52:53]
    v_pk_mul_f32 v[108:109], v[108:109], v[52:53]
    v_pk_mul_f32 v[110:111], v[110:111], v[52:53]
    v_pk_mul_f32 v[112:113], v[112:113], v[52:53]
    v_pk_mul_f32 v[114:115], v[114:115], v[52:53]
    v_pk_mul_f32 v[116:117], v[116:117], v[52:53]
    v_pk_mul_f32 v[118:119], v[118:119], v[52:53]
    v_pk_fma_f32 v[56:57], v[56:57], v[104:105], v[8:9]
    v_pk_fma_f32 v[58:59], v[58:59], v[106:107], v[10:11]
    v_pk_fma_f32 v[60:61], v[60:61], v[108:109], v[12:13]
    v_pk_fma_f32 v[62:63], v[62:63], v[110:111], v[14:15]
    v_pk_fma_f32 v[64:65], v[64:65], v[112:113], v[16:17]
    v_pk_fma_f32 v[66:67], v[66:67], v[114:115], v[18:19]
    v_pk_fma_f32 v[68:69], v[68:69], v[116:117], v[20:21]
    v_pk_fma_f32 v[70:71], v[70:71], v[118:119], v[22:23]
    v_cvt_pk_bf16_f32 v40, v56, v57
    v_cvt_pk_bf16_f32 v41, v58, v59
    v_cvt_pk_bf16_f32 v42, v60, v61
    v_cvt_pk_bf16_f32 v43, v62, v63
    v_cvt_pk_bf16_f32 v44, v64, v65
    v_cvt_pk_bf16_f32 v45, v66, v67
    v_cvt_pk_bf16_f32 v46, v68, v69
    v_cvt_pk_bf16_f32 v47, v70, v71
    s_mul_i32 s17, s47, 2080
    s_add_u32 s17, s17, 27648
    v_add_u32 v3, s17, v5
    ds_write_b128 v3, v[40:43]
    ds_write_b128 v3, v[44:47] offset:16
l3_kernel_stage:
    s_waitcnt lgkmcnt(0)
    s_barrier
    s_cmp_eq_u32 s12, 8
    s_cbranch_scc1 l3_kernel_fin
    v_and_b32 v3, 7, v2
    v_mul_u32_u24 v4, 2080, v3
    v_lshrrev_b32 v5, 3, v2
    s_lshl_b32 s17, s12, 4
    v_add_u32 v5, s17, v5
    v_lshl_add_u32 v4, v5, 4, v4
    v_add_u32 v4, 27648, v4
    ds_read_b128 v[56:59], v4
    ds_read_b128 v[60:63], v4 offset:128
    s_lshl_b32 s17, s45, 1
    v_add_u32 v6, s17, v3
    v_lshrrev_b32 v7, 4, v6
    v_lshlrev_b32 v7, 15, v7
    v_and_b32 v6, 15, v6
    v_lshl_add_u32 v7, v6, 4, v7
    v_lshl_add_u32 v7, v5, 8, v7
    v_add_u32 v7, 14680064, v7
    s_waitcnt lgkmcnt(0)
    global_store_dwordx4 v7, v[56:59], s[6:7]
    global_store_dwordx4 v7, v[60:63], s[6:7] offset:2048
l3_kernel_fin:
l3_kernel_end:
    s_endpgm

.globl gemm3_kernel
.p2align 8
.type gemm3_kernel,@function
gemm3_kernel:
    s_cmp_ge_u32 s2, 256
    s_cbranch_scc1 gemm3_kernel_end
    s_load_dwordx4 s[4:7], s[0:1], 48
    s_load_dwordx2 s[8:9], s[0:1], 104
    s_load_dwordx2 s[72:73], s[0:1], 64
    v_lshrrev_b32 v1, 6, v0
    v_and_b32 v20, 63, v0
    v_readfirstlane_b32 s33, v1
    s_and_b32 s11, s2, 7
    s_lshr_b32 s12, s2, 3
    s_and_b32 s13, s12, 3
    s_lshl_b32 s11, s11, 2
    s_add_u32 s13, s13, s11
    s_lshr_b32 s14, s2, 5
    s_lshr_b32 s15, s33, 1
    v_lshrrev_b32 v2, 4, v20
    v_bfe_u32 v3, v20, 1, 3
    v_mul_u32_u24 v5, 7168, v2
    v_and_b32 v6, 1, v20
    v_lshlrev_b32 v6, 4, v6
    v_add_u32 v5, v5, v6
    v_mov_b32 v7, 0x40000000
    v_add_u32 v4, 0, v2
    v_xor_b32 v4, v3, v4
    v_lshlrev_b32 v6, 5, v4
    v_add_u32 v6, v5, v6
    v_cmp_eq_u32 vcc, 7, v4
    s_nop 1
    v_cndmask_b32 v16, v6, v7, vcc
    v_add_u32 v4, 4, v2
    v_xor_b32 v4, v3, v4
    v_lshlrev_b32 v6, 5, v4
    v_add_u32 v6, v5, v6
    v_cmp_eq_u32 vcc, 7, v4
    s_nop 1
    v_cndmask_b32 v18, v6, v7, vcc
    v_lshlrev_b32 v17, 4, v20
    v_mov_b32 v19, v17
    v_lshrrev_b32 v22, 4, v20
    v_bfe_u32 v24, v20, 2, 2
    v_and_b32 v25, 3, v20
    v_lshl_add_u32 v27, v22, 3, v24
    v_lshlrev_b32 v26, 8, v27
    v_lshl_add_u32 v26, v25, 3, v26
    v_and_b32 v23, 1, v22
    v_lshl_add_u32 v27, v23, 2, v24
    v_xor_b32 v28, 0, v27
    v_lshl_add_u32 v2, v28, 5, v26
    v_add_u32 v9, 0x10000, v2
    v_xor_b32 v28, 1, v27
    v_lshl_add_u32 v3, v28, 5, v26
    v_add_u32 v10, 0x10000, v3
    v_xor_b32 v28, 2, v27
    v_lshl_add_u32 v4, v28, 5, v26
    v_add_u32 v11, 0x10000, v4
    v_xor_b32 v28, 3, v27
    v_lshl_add_u32 v5, v28, 5, v26
    v_add_u32 v12, 0x10000, v5
    v_xor_b32 v28, 4, v27
    v_lshl_add_u32 v6, v28, 5, v26
    v_add_u32 v13, 0x10000, v6
    v_xor_b32 v28, 5, v27
    v_lshl_add_u32 v7, v28, 5, v26
    v_add_u32 v14, 0x10000, v7
    v_xor_b32 v28, 6, v27
    v_lshl_add_u32 v8, v28, 5, v26
    v_add_u32 v15, 0x10000, v8
    v_mov_b32 v32, 0
    v_mov_b32 v33, 0
    v_mov_b32 v34, 0
    v_mov_b32 v35, 0
    v_mov_b32 v36, 0
    v_mov_b32 v37, 0
    v_mov_b32 v38, 0
    v_mov_b32 v39, 0
    v_mov_b32 v40, 0
    v_mov_b32 v41, 0
    v_mov_b32 v42, 0
    v_mov_b32 v43, 0
    v_mov_b32 v44, 0
    v_mov_b32 v45, 0
    v_mov_b32 v46, 0
    v_mov_b32 v47, 0
    v_mov_b32 v48, 0
    v_mov_b32 v49, 0
    v_mov_b32 v50, 0
    v_mov_b32 v51, 0
    v_mov_b32 v52, 0
    v_mov_b32 v53, 0
    v_mov_b32 v54, 0
    v_mov_b32 v55, 0
    v_mov_b32 v56, 0
    v_mov_b32 v57, 0
    v_mov_b32 v58, 0
    v_mov_b32 v59, 0
    v_mov_b32 v60, 0
    v_mov_b32 v61, 0
    v_mov_b32 v62, 0
    v_mov_b32 v63, 0
    v_mov_b32 v64, 0
    v_mov_b32 v65, 0
    v_mov_b32 v66, 0
    v_mov_b32 v67, 0
    v_mov_b32 v68, 0
    v_mov_b32 v69, 0
    v_mov_b32 v70, 0
    v_mov_b32 v71, 0
    v_mov_b32 v72, 0
    v_mov_b32 v73, 0
    v_mov_b32 v74, 0
    v_mov_b32 v75, 0
    v_mov_b32 v76, 0
    v_mov_b32 v77, 0
    v_mov_b32 v78, 0
    v_mov_b32 v79, 0
    v_mov_b32 v80, 0
    v_mov_b32 v81, 0
    v_mov_b32 v82, 0
    v_mov_b32 v83, 0
    v_mov_b32 v84, 0
    v_mov_b32 v85, 0
    v_mov_b32 v86, 0
    v_mov_b32 v87, 0
    v_mov_b32 v88, 0
    v_mov_b32 v89, 0
    v_mov_b32 v90, 0
    v_mov_b32 v91, 0
    v_mov_b32 v92, 0
    v_mov_b32 v93, 0
    v_mov_b32 v94, 0
    v_mov_b32 v95, 0
    v_mov_b32 v96, 0
    v_mov_b32 v97, 0
    v_mov_b32 v98, 0
    v_mov_b32 v99, 0
    v_mov_b32 v100, 0
    v_mov_b32 v101, 0
    v_mov_b32 v102, 0
    v_mov_b32 v103, 0
    v_mov_b32 v104, 0
    v_mov_b32 v105, 0
    v_mov_b32 v106, 0
    v_mov_b32 v107, 0
    v_mov_b32 v108, 0
    v_mov_b32 v109, 0
    v_mov_b32 v110, 0
    v_mov_b32 v111, 0
    v_mov_b32 v112, 0
    v_mov_b32 v113, 0
    v_mov_b32 v114, 0
    v_mov_b32 v115, 0
    v_mov_b32 v116, 0
    v_mov_b32 v117, 0
    v_mov_b32 v118, 0
    v_mov_b32 v119, 0
    v_mov_b32 v120, 0
    v_mov_b32 v121, 0
    v_mov_b32 v122, 0
    v_mov_b32 v123, 0
    v_mov_b32 v124, 0
    v_mov_b32 v125, 0
    v_mov_b32 v126, 0
    v_mov_b32 v127, 0
    v_mov_b32 v128, 0
    v_mov_b32 v129, 0
    v_mov_b32 v130, 0
    v_mov_b32 v131, 0
    v_mov_b32 v132, 0
    v_mov_b32 v133, 0
    v_mov_b32 v134, 0
    v_mov_b32 v135, 0
    v_mov_b32 v136, 0
    v_mov_b32 v137, 0
    v_mov_b32 v138, 0
    v_mov_b32 v139, 0
    v_mov_b32 v140, 0
    v_mov_b32 v141, 0
    v_mov_b32 v142, 0
    v_mov_b32 v143, 0
    v_mov_b32 v144, 0
    v_mov_b32 v145, 0
    v_mov_b32 v146, 0
    v_mov_b32 v147, 0
    v_mov_b32 v148, 0
    v_mov_b32 v149, 0
    v_mov_b32 v150, 0
    v_mov_b32 v151, 0
    v_mov_b32 v152, 0
    v_mov_b32 v153, 0
    v_mov_b32 v154, 0
    v_mov_b32 v155, 0
    v_mov_b32 v156, 0
    v_mov_b32 v157, 0
    v_mov_b32 v158, 0
    v_mov_b32 v159, 0
    v_mov_b32 v160, 0
    v_mov_b32 v161, 0
    v_mov_b32 v162, 0
    v_mov_b32 v163, 0
    v_mov_b32 v164, 0
    v_mov_b32 v165, 0
    v_mov_b32 v166, 0
    v_mov_b32 v167, 0
    v_mov_b32 v168, 0
    v_mov_b32 v169, 0
    v_mov_b32 v170, 0
    v_mov_b32 v171, 0
    v_mov_b32 v172, 0
    v_mov_b32 v173, 0
    v_mov_b32 v174, 0
    v_mov_b32 v175, 0
    v_mov_b32 v176, 0
    v_mov_b32 v177, 0
    v_mov_b32 v178, 0
    v_mov_b32 v179, 0
    v_mov_b32 v180, 0
    v_mov_b32 v181, 0
    v_mov_b32 v182, 0
    v_mov_b32 v183, 0
    v_mov_b32 v184, 0
    v_mov_b32 v185, 0
    v_mov_b32 v186, 0
    v_mov_b32 v187, 0
    v_mov_b32 v188, 0
    v_mov_b32 v189, 0
    v_mov_b32 v190, 0
    v_mov_b32 v191, 0
    v_mov_b32 v192, 0
    v_mov_b32 v193, 0
    v_mov_b32 v194, 0
    v_mov_b32 v195, 0
    v_mov_b32 v196, 0
    v_mov_b32 v197, 0
    v_mov_b32 v198, 0
    v_mov_b32 v199, 0
    v_mov_b32 v200, 0
    v_mov_b32 v201, 0
    v_mov_b32 v202, 0
    v_mov_b32 v203, 0
    v_mov_b32 v204, 0
    v_mov_b32 v205, 0
    v_mov_b32 v206, 0
    v_mov_b32 v207, 0
    v_mov_b32 v208, 0
    v_mov_b32 v209, 0
    v_mov_b32 v210, 0
    v_mov_b32 v211, 0
    v_mov_b32 v212, 0
    v_mov_b32 v213, 0
    v_mov_b32 v214, 0
    v_mov_b32 v215, 0
    v_mov_b32 v216, 0
    v_mov_b32 v217, 0
    v_mov_b32 v218, 0
    v_mov_b32 v219, 0
    v_mov_b32 v220, 0
    v_mov_b32 v221, 0
    v_mov_b32 v222, 0
    v_mov_b32 v223, 0
    v_mov_b32 v224, 0
    v_mov_b32 v225, 0
    v_mov_b32 v226, 0
    v_mov_b32 v227, 0
    v_mov_b32 v228, 0
    v_mov_b32 v229, 0
    v_mov_b32 v230, 0
    v_mov_b32 v231, 0
    v_mov_b32 v232, 0
    v_mov_b32 v233, 0
    v_mov_b32 v234, 0
    v_mov_b32 v235, 0
    v_mov_b32 v236, 0
    v_mov_b32 v237, 0
    v_mov_b32 v238, 0
    v_mov_b32 v239, 0
    v_mov_b32 v240, 0
    v_mov_b32 v241, 0
    v_mov_b32 v242, 0
    v_mov_b32 v243, 0
    v_mov_b32 v244, 0
    v_mov_b32 v245, 0
    v_mov_b32 v246, 0
    v_mov_b32 v247, 0
    v_mov_b32 v248, 0
    v_mov_b32 v249, 0
    v_mov_b32 v250, 0
    v_mov_b32 v251, 0
    v_mov_b32 v252, 0
    v_mov_b32 v253, 0
    v_mov_b32 v254, 0
    v_mov_b32 v255, 0
    s_waitcnt lgkmcnt(0)
    s_cmp_eq_u32 s15, 0
    s_cselect_b32 s16, s4, s6
    s_cselect_b32 s17, s5, s7
    s_and_b32 s35, s33, 1
    s_mul_i32 s36, s35, 229376
    s_mul_i32 s37, s13, 224
    s_add_u32 s36, s36, s37
    s_add_u32 s16, s16, s36
    s_addc_u32 s17, s17, 0
    s_sub_u32 s18, 7340032, s36
    s_mov_b32 s19, 0x20000
    s_lshl_b32 s30, s15, 14
    s_mul_i32 s35, s35, 8192
    s_add_u32 s30, s30, s35
    s_lshl_b32 s35, s14, 4
    s_lshl_b32 s36, s33, 2
    s_add_u32 s35, s35, s36
    s_lshl_b32 s36, s35, 15
    s_add_u32 s36, s36, 14680064
    s_add_u32 s20, s8, s36
    s_addc_u32 s21, s9, 0
    s_mov_b32 s22, 131072
    s_mov_b32 s23, 0x20000
    s_lshr_b32 s36, s35, 1
    s_mul_i32 s36, s36, 224
    s_mul_i32 s37, s13, 7
    s_add_u32 s36, s36, s37
    s_lshl_b32 s36, s36, 10
    s_add_u32 s36, s36, 18874368
    s_add_u32 s24, s8, s36
    s_addc_u32 s25, s9, 0
    s_mov_b32 s26, 236544
    s_mov_b32 s27, 0x20000
    s_mul_i32 s74, s2, 28672
    s_add_u32 s72, s72, s74
    s_addc_u32 s73, s73, 0
    s_mov_b32 s74, 28672
    s_mov_b32 s75, 0x20000
    s_mul_i32 s76, s33, 7168
    v_lshlrev_b32 v21, 4, v20
    v_add_u32 v21, s76, v21
    v_lshrrev_b32 v28, 3, v20
    s_mov_b32 s77, 458752
    v_mul_lo_u32 v28, v28, s77
    v_and_b32 v31, 7, v20
    v_lshl_add_u32 v28, v31, 4, v28
    s_mul_i32 s76, s2, 1792
    v_add_u32 v1, s76, v28
    s_add_u32 s40, s8, 34603008
    s_addc_u32 s41, s9, 0
    s_mov_b32 s42, 7340032
    s_mov_b32 s43, 0x20000
    s_mul_i32 s76, s33, 7
    s_add_u32 s76, s76, 0
    s_and_b32 s77, s76, 1
    s_mul_i32 s77, s77, 3670016
    s_lshr_b32 s76, s76, 1
    s_lshl_b32 s76, s76, 7
    s_add_u32 s64, s76, s77
    s_mul_i32 s76, s33, 7
    s_add_u32 s76, s76, 1
    s_and_b32 s77, s76, 1
    s_mul_i32 s77, s77, 3670016
    s_lshr_b32 s76, s76, 1
    s_lshl_b32 s76, s76, 7
    s_add_u32 s65, s76, s77
    s_mul_i32 s76, s33, 7
    s_add_u32 s76, s76, 2
    s_and_b32 s77, s76, 1
    s_mul_i32 s77, s77, 3670016
    s_lshr_b32 s76, s76, 1
    s_lshl_b32 s76, s76, 7
    s_add_u32 s66, s76, s77
    s_mul_i32 s76, s33, 7
    s_add_u32 s76, s76, 3
    s_and_b32 s77, s76, 1
    s_mul_i32 s77, s77, 3670016
    s_lshr_b32 s76, s76, 1
    s_lshl_b32 s76, s76, 7
    s_add_u32 s67, s76, s77
    s_mul_i32 s76, s33, 7
    s_add_u32 s76, s76, 4
    s_and_b32 s77, s76, 1
    s_mul_i32 s77, s77, 3670016
    s_lshr_b32 s76, s76, 1
    s_lshl_b32 s76, s76, 7
    s_add_u32 s68, s76, s77
    s_mul_i32 s76, s33, 7
    s_add_u32 s76, s76, 5
    s_and_b32 s77, s76, 1
    s_mul_i32 s77, s77, 3670016
    s_lshr_b32 s76, s76, 1
    s_lshl_b32 s76, s76, 7
    s_add_u32 s69, s76, s77
    s_mul_i32 s76, s33, 7
    s_add_u32 s76, s76, 6
    s_and_b32 s77, s76, 1
    s_mul_i32 s77, s77, 3670016
    s_lshr_b32 s76, s76, 1
    s_lshl_b32 s76, s76, 7
    s_add_u32 s70, s76, s77
    s_and_b32 s77, s33, 1
    s_lshl_b32 s76, s14, 1
    s_add_u32 s76, s76, s77
    s_mul_i32 s76, s76, 6
    s_add_u32 s76, s76, 256
    s_lshl_b32 s77, s77, 5
    s_sub_u32 s76, s76, s77
    v_lshrrev_b32 v29, 2, v20
    v_add_u32 v29, s76, v29
    v_mul_u32_u24 v29, 7168, v29
    v_and_b32 v28, 1, v20
    v_mul_u32_u24 v28, 92, v28
    v_add_u32 v29, v29, v28
    v_bfe_u32 v28, v20, 1, 1
    v_lshl_add_u32 v29, v28, 7, v29
    v_mov_b32 v28, 0x40000000
    v_cmp_gt_u32 vcc, 24, v20
    s_nop 1
    v_cndmask_b32 v29, v28, v29, vcc
    v_lshlrev_b32 v0, 7, v20
    s_mul_i32 s76, s33, 7168
    v_add_u32 v0, s76, v0
    v_cmp_gt_u32 vcc, 7, v20
    s_nop 1
    v_cndmask_b32 v0, v28, v0, vcc
    s_mov_b32 s62, 0
    s_mov_b32 s63, 0
    s_mov_b32 s28, 0
    s_add_u32 m0, s30, 0
    s_add_u32 s31, s28, 0
    buffer_load_dwordx4 v16, s[16:19], s31 offen lds
    s_add_u32 m0, s30, 1024
    s_add_u32 s31, s28, 28672
    buffer_load_dwordx4 v16, s[16:19], s31 offen lds
    s_add_u32 m0, s30, 2048
    s_add_u32 s31, s28, 57344
    buffer_load_dwordx4 v18, s[16:19], s31 offen lds
    s_add_u32 m0, s30, 3072
    s_add_u32 s31, s28, 86016
    buffer_load_dwordx4 v18, s[16:19], s31 offen lds
    s_add_u32 m0, s30, 4096
    s_add_u32 s31, s28, 114688
    buffer_load_dwordx4 v16, s[16:19], s31 offen lds
    s_add_u32 m0, s30, 5120
    s_add_u32 s31, s28, 143360
    buffer_load_dwordx4 v16, s[16:19], s31 offen lds
    s_add_u32 m0, s30, 6144
    s_add_u32 s31, s28, 172032
    buffer_load_dwordx4 v18, s[16:19], s31 offen lds
    s_add_u32 m0, s30, 7168
    s_add_u32 s31, s28, 200704
    buffer_load_dwordx4 v18, s[16:19], s31 offen lds
    s_mov_b32 s56, 0
    s_mov_b32 s57, 32768
    s_mov_b32 s58, 65536
    s_mov_b32 s59, 98304
    buffer_load_dwordx4 a[112:115], v17, s[20:23], s56 offen offset:0
    buffer_load_dwordx4 a[116:119], v17, s[20:23], s57 offen offset:0
    buffer_load_dwordx4 a[120:123], v17, s[20:23], s58 offen offset:0
    buffer_load_dwordx4 a[124:127], v17, s[20:23], s59 offen offset:0
    buffer_load_dwordx4 a[128:131], v17, s[20:23], s56 offen offset:1024
    buffer_load_dwordx4 a[132:135], v17, s[20:23], s57 offen offset:1024
    buffer_load_dwordx4 a[136:139], v17, s[20:23], s58 offen offset:1024
    buffer_load_dwordx4 a[140:143], v17, s[20:23], s59 offen offset:1024
    s_add_u32 s28, s28, 458752
    s_add_u32 m0, s30, 32768
    s_add_u32 s31, s28, 0
    buffer_load_dwordx4 v16, s[16:19], s31 offen lds
    s_add_u32 m0, s30, 33792
    s_add_u32 s31, s28, 28672
    buffer_load_dwordx4 v16, s[16:19], s31 offen lds
    s_add_u32 m0, s30, 34816
    s_add_u32 s31, s28, 57344
    buffer_load_dwordx4 v18, s[16:19], s31 offen lds
    s_add_u32 m0, s30, 35840
    s_add_u32 s31, s28, 86016
    buffer_load_dwordx4 v18, s[16:19], s31 offen lds
    s_add_u32 m0, s30, 36864
    s_add_u32 s31, s28, 114688
    buffer_load_dwordx4 v16, s[16:19], s31 offen lds
    s_add_u32 m0, s30, 37888
    s_add_u32 s31, s28, 143360
    buffer_load_dwordx4 v16, s[16:19], s31 offen lds
    s_add_u32 m0, s30, 38912
    s_add_u32 s31, s28, 172032
    buffer_load_dwordx4 v18, s[16:19], s31 offen lds
    s_add_u32 m0, s30, 39936
    s_add_u32 s31, s28, 200704
    buffer_load_dwordx4 v18, s[16:19], s31 offen lds
    s_add_u32 s28, s28, 458752
    s_mov_b32 s32, 0
    s_waitcnt vmcnt(16)
    s_barrier
    ds_read_b64_tr_b16 a[0:1], v2 offset:0
    ds_read_b64_tr_b16 a[2:3], v2 offset:1024
    ds_read_b64_tr_b16 a[28:29], v2 offset:16384
    ds_read_b64_tr_b16 a[30:31], v2 offset:17408
    ds_read_b64_tr_b16 a[4:5], v3 offset:0
    ds_read_b64_tr_b16 a[6:7], v3 offset:1024
    ds_read_b64_tr_b16 a[32:33], v3 offset:16384
    ds_read_b64_tr_b16 a[34:35], v3 offset:17408
    ds_read_b64_tr_b16 a[8:9], v4 offset:0
    ds_read_b64_tr_b16 a[10:11], v4 offset:1024
    ds_read_b64_tr_b16 a[36:37], v4 offset:16384
    ds_read_b64_tr_b16 a[38:39], v4 offset:17408
    ds_read_b64_tr_b16 a[12:13], v5 offset:0
    ds_read_b64_tr_b16 a[14:15], v5 offset:1024
    ds_read_b64_tr_b16 a[40:41], v5 offset:16384
    ds_read_b64_tr_b16 a[42:43], v5 offset:17408
    ds_read_b64_tr_b16 a[16:17], v6 offset:0
    ds_read_b64_tr_b16 a[18:19], v6 offset:1024
    ds_read_b64_tr_b16 a[44:45], v6 offset:16384
    ds_read_b64_tr_b16 a[46:47], v6 offset:17408
    ds_read_b64_tr_b16 a[20:21], v7 offset:0
    ds_read_b64_tr_b16 a[22:23], v7 offset:1024
    ds_read_b64_tr_b16 a[48:49], v7 offset:16384
    ds_read_b64_tr_b16 a[50:51], v7 offset:17408
    ds_read_b64_tr_b16 a[24:25], v8 offset:0
    ds_read_b64_tr_b16 a[26:27], v8 offset:1024
    ds_read_b64_tr_b16 a[52:53], v8 offset:16384
    ds_read_b64_tr_b16 a[54:55], v8 offset:17408
    s_add_u32 m0, s30, 65536
    s_add_u32 s31, s28, 0
    buffer_load_dwordx4 v16, s[16:19], s31 offen lds
    s_add_u32 m0, s30, 66560
    s_add_u32 s31, s28, 28672
    buffer_load_dwordx4 v16, s[16:19], s31 offen lds
    s_add_u32 m0, s30, 67584
    s_add_u32 s31, s28, 57344
    buffer_load_dwordx4 v18, s[16:19], s31 offen lds
    s_add_u32 m0, s30, 68608
    s_add_u32 s31, s28, 86016
    buffer_load_dwordx4 v18, s[16:19], s31 offen lds
    s_add_u32 m0, s30, 69632
    s_add_u32 s31, s28, 114688
    buffer_load_dwordx4 v16, s[16:19], s31 offen lds
    s_add_u32 m0, s30, 70656
    s_add_u32 s31, s28, 143360
    buffer_load_dwordx4 v16, s[16:19], s31 offen lds
    s_add_u32 m0, s30, 71680
    s_add_u32 s31, s28, 172032
    buffer_load_dwordx4 v18, s[16:19], s31 offen lds
    s_add_u32 m0, s30, 72704
    s_add_u32 s31, s28, 200704
    buffer_load_dwordx4 v18, s[16:19], s31 offen lds
    s_add_u32 s28, s28, 458752
    s_mov_b32 s56, 2048
    s_mov_b32 s57, 34816
    s_mov_b32 s58, 67584
    s_mov_b32 s59, 100352
    buffer_load_dwordx4 a[144:147], v17, s[20:23], s56 offen offset:0
    buffer_load_dwordx4 a[148:151], v17, s[20:23], s57 offen offset:0
    buffer_load_dwordx4 a[152:155], v17, s[20:23], s58 offen offset:0
    buffer_load_dwordx4 a[156:159], v17, s[20:23], s59 offen offset:0
.p2align 6
gemm3_kernel_loop:
    s_waitcnt lgkmcnt(0)
    s_waitcnt vmcnt(20)
    v_mfma_f32_16x16x32_bf16 v[32:35], a[0:3], a[112:115], v[32:35]
    v_mfma_f32_16x16x32_bf16 v[36:39], a[0:3], a[116:119], v[36:39]
    ds_read_b64_tr_b16 a[56:57], v2 offset:8192
    v_mfma_f32_16x16x32_bf16 v[40:43], a[0:3], a[120:123], v[40:43]
    ds_read_b64_tr_b16 a[58:59], v2 offset:9216
    v_mfma_f32_16x16x32_bf16 v[44:47], a[0:3], a[124:127], v[44:47]
    ds_read_b64_tr_b16 a[84:85], v2 offset:24576
    v_mfma_f32_16x16x32_bf16 v[144:147], a[28:31], a[112:115], v[144:147]
    ds_read_b64_tr_b16 a[86:87], v2 offset:25600
    v_mfma_f32_16x16x32_bf16 v[148:151], a[28:31], a[116:119], v[148:151]
    ds_read_b64_tr_b16 a[60:61], v3 offset:8192
    v_mfma_f32_16x16x32_bf16 v[152:155], a[28:31], a[120:123], v[152:155]
    ds_read_b64_tr_b16 a[62:63], v3 offset:9216
    v_mfma_f32_16x16x32_bf16 v[156:159], a[28:31], a[124:127], v[156:159]
    buffer_load_dwordx4 a[160:163], v17, s[20:23], s56 offen offset:1024
    v_mfma_f32_16x16x32_bf16 v[48:51], a[4:7], a[112:115], v[48:51]
    ds_read_b64_tr_b16 a[88:89], v3 offset:24576
    v_mfma_f32_16x16x32_bf16 v[52:55], a[4:7], a[116:119], v[52:55]
    ds_read_b64_tr_b16 a[90:91], v3 offset:25600
    v_mfma_f32_16x16x32_bf16 v[56:59], a[4:7], a[120:123], v[56:59]
    ds_read_b64_tr_b16 a[64:65], v4 offset:8192
    v_mfma_f32_16x16x32_bf16 v[60:63], a[4:7], a[124:127], v[60:63]
    ds_read_b64_tr_b16 a[66:67], v4 offset:9216
    v_mfma_f32_16x16x32_bf16 v[160:163], a[32:35], a[112:115], v[160:163]
    ds_read_b64_tr_b16 a[92:93], v4 offset:24576
    v_mfma_f32_16x16x32_bf16 v[164:167], a[32:35], a[116:119], v[164:167]
    ds_read_b64_tr_b16 a[94:95], v4 offset:25600
    v_mfma_f32_16x16x32_bf16 v[168:171], a[32:35], a[120:123], v[168:171]
    buffer_load_dwordx4 a[164:167], v17, s[20:23], s57 offen offset:1024
    v_mfma_f32_16x16x32_bf16 v[172:175], a[32:35], a[124:127], v[172:175]
    ds_read_b64_tr_b16 a[68:69], v5 offset:8192
    v_mfma_f32_16x16x32_bf16 v[64:67], a[8:11], a[112:115], v[64:67]
    ds_read_b64_tr_b16 a[70:71], v5 offset:9216
    v_mfma_f32_16x16x32_bf16 v[68:71], a[8:11], a[116:119], v[68:71]
    ds_read_b64_tr_b16 a[96:97], v5 offset:24576
    v_mfma_f32_16x16x32_bf16 v[72:75], a[8:11], a[120:123], v[72:75]
    ds_read_b64_tr_b16 a[98:99], v5 offset:25600
    v_mfma_f32_16x16x32_bf16 v[76:79], a[8:11], a[124:127], v[76:79]
    ds_read_b64_tr_b16 a[72:73], v6 offset:8192
    v_mfma_f32_16x16x32_bf16 v[176:179], a[36:39], a[112:115], v[176:179]
    ds_read_b64_tr_b16 a[74:75], v6 offset:9216
    v_mfma_f32_16x16x32_bf16 v[180:183], a[36:39], a[116:119], v[180:183]
    buffer_load_dwordx4 a[168:171], v17, s[20:23], s58 offen offset:1024
    v_mfma_f32_16x16x32_bf16 v[184:187], a[36:39], a[120:123], v[184:187]
    ds_read_b64_tr_b16 a[100:101], v6 offset:24576
    v_mfma_f32_16x16x32_bf16 v[188:191], a[36:39], a[124:127], v[188:191]
    ds_read_b64_tr_b16 a[102:103], v6 offset:25600
    v_mfma_f32_16x16x32_bf16 v[80:83], a[12:15], a[112:115], v[80:83]
    ds_read_b64_tr_b16 a[76:77], v7 offset:8192
    v_mfma_f32_16x16x32_bf16 v[84:87], a[12:15], a[116:119], v[84:87]
    ds_read_b64_tr_b16 a[78:79], v7 offset:9216
    v_mfma_f32_16x16x32_bf16 v[88:91], a[12:15], a[120:123], v[88:91]
    ds_read_b64_tr_b16 a[104:105], v7 offset:24576
    v_mfma_f32_16x16x32_bf16 v[92:95], a[12:15], a[124:127], v[92:95]
    ds_read_b64_tr_b16 a[106:107], v7 offset:25600
    v_mfma_f32_16x16x32_bf16 v[192:195], a[40:43], a[112:115], v[192:195]
    buffer_load_dwordx4 a[172:175], v17, s[20:23], s59 offen offset:1024
    v_mfma_f32_16x16x32_bf16 v[196:199], a[40:43], a[116:119], v[196:199]
    ds_read_b64_tr_b16 a[80:81], v8 offset:8192
    v_mfma_f32_16x16x32_bf16 v[200:203], a[40:43], a[120:123], v[200:203]
    ds_read_b64_tr_b16 a[82:83], v8 offset:9216
    v_mfma_f32_16x16x32_bf16 v[204:207], a[40:43], a[124:127], v[204:207]
    ds_read_b64_tr_b16 a[108:109], v8 offset:24576
    v_mfma_f32_16x16x32_bf16 v[96:99], a[16:19], a[112:115], v[96:99]
    ds_read_b64_tr_b16 a[110:111], v8 offset:25600
    v_mfma_f32_16x16x32_bf16 v[100:103], a[16:19], a[116:119], v[100:103]
    v_mfma_f32_16x16x32_bf16 v[104:107], a[16:19], a[120:123], v[104:107]
    v_mfma_f32_16x16x32_bf16 v[108:111], a[16:19], a[124:127], v[108:111]
    s_add_u32 s56, s56, 2048
    s_add_u32 s57, s57, 2048
    s_add_u32 s58, s58, 2048
    s_add_u32 s59, s59, 2048
    v_mfma_f32_16x16x32_bf16 v[208:211], a[44:47], a[112:115], v[208:211]
    s_add_u32 m0, s30, 98304
    s_add_u32 s31, s28, 0
    buffer_load_dwordx4 v16, s[16:19], s31 offen lds
    v_mfma_f32_16x16x32_bf16 v[212:215], a[44:47], a[116:119], v[212:215]
    v_mfma_f32_16x16x32_bf16 v[216:219], a[44:47], a[120:123], v[216:219]
    s_add_u32 m0, s30, 99328
    s_add_u32 s31, s28, 28672
    buffer_load_dwordx4 v16, s[16:19], s31 offen lds
    v_mfma_f32_16x16x32_bf16 v[220:223], a[44:47], a[124:127], v[220:223]
    v_mfma_f32_16x16x32_bf16 v[112:115], a[20:23], a[112:115], v[112:115]
    s_add_u32 m0, s30, 100352
    s_add_u32 s31, s28, 57344
    buffer_load_dwordx4 v18, s[16:19], s31 offen lds
    v_mfma_f32_16x16x32_bf16 v[116:119], a[20:23], a[116:119], v[116:119]
    v_mfma_f32_16x16x32_bf16 v[120:123], a[20:23], a[120:123], v[120:123]
    s_add_u32 m0, s30, 101376
    s_add_u32 s31, s28, 86016
    buffer_load_dwordx4 v18, s[16:19], s31 offen lds
    v_mfma_f32_16x16x32_bf16 v[124:127], a[20:23], a[124:127], v[124:127]
    v_mfma_f32_16x16x32_bf16 v[224:227], a[48:51], a[112:115], v[224:227]
    v_mfma_f32_16x16x32_bf16 v[228:231], a[48:51], a[116:119], v[228:231]
    v_mfma_f32_16x16x32_bf16 v[232:235], a[48:51], a[120:123], v[232:235]
    v_mfma_f32_16x16x32_bf16 v[236:239], a[48:51], a[124:127], v[236:239]
    v_mfma_f32_16x16x32_bf16 v[128:131], a[24:27], a[112:115], v[128:131]
    v_mfma_f32_16x16x32_bf16 v[132:135], a[24:27], a[116:119], v[132:135]
    v_mfma_f32_16x16x32_bf16 v[136:139], a[24:27], a[120:123], v[136:139]
    v_mfma_f32_16x16x32_bf16 v[140:143], a[24:27], a[124:127], v[140:143]
    v_mfma_f32_16x16x32_bf16 v[240:243], a[52:55], a[112:115], v[240:243]
    s_cmp_lt_u32 s32, 2
    s_cbranch_scc0 gemm3_kernel_o0a
    buffer_load_dword v30, v29, s[16:19], s62 offen
    s_add_u32 s62, s62, 688128
    buffer_load_dword v30, v0, s[72:75], s63 offen
    s_add_u32 s63, s63, 896
    s_branch gemm3_kernel_o0e
gemm3_kernel_o0a:
    s_mov_b32 s76, 0
    buffer_load_dwordx4 a[176:179], v21, s[72:75], s76 offen
    s_mov_b32 s76, 1024
    buffer_load_dwordx4 a[180:183], v21, s[72:75], s76 offen
gemm3_kernel_o0e:
    v_mfma_f32_16x16x32_bf16 v[244:247], a[52:55], a[116:119], v[244:247]
    v_mfma_f32_16x16x32_bf16 v[248:251], a[52:55], a[120:123], v[248:251]
    v_mfma_f32_16x16x32_bf16 v[252:255], a[52:55], a[124:127], v[252:255]
    s_waitcnt lgkmcnt(0)
    s_waitcnt vmcnt(20)
    v_mfma_f32_16x16x32_bf16 v[32:35], a[56:59], a[128:131], v[32:35]
    s_waitcnt vmcnt(20)
    s_barrier
    v_mfma_f32_16x16x32_bf16 v[36:39], a[56:59], a[132:135], v[36:39]
    ds_read_b64_tr_b16 a[0:1], v2 offset:32768
    v_mfma_f32_16x16x32_bf16 v[40:43], a[56:59], a[136:139], v[40:43]
    ds_read_b64_tr_b16 a[2:3], v2 offset:33792
    v_mfma_f32_16x16x32_bf16 v[44:47], a[56:59], a[140:143], v[44:47]
    ds_read_b64_tr_b16 a[28:29], v2 offset:49152
    v_mfma_f32_16x16x32_bf16 v[144:147], a[84:87], a[128:131], v[144:147]
    ds_read_b64_tr_b16 a[30:31], v2 offset:50176
    v_mfma_f32_16x16x32_bf16 v[148:151], a[84:87], a[132:135], v[148:151]
    ds_read_b64_tr_b16 a[4:5], v3 offset:32768
    v_mfma_f32_16x16x32_bf16 v[152:155], a[84:87], a[136:139], v[152:155]
    ds_read_b64_tr_b16 a[6:7], v3 offset:33792
    v_mfma_f32_16x16x32_bf16 v[156:159], a[84:87], a[140:143], v[156:159]
    buffer_load_dwordx4 a[112:115], v17, s[20:23], s56 offen offset:0
    v_mfma_f32_16x16x32_bf16 v[48:51], a[60:63], a[128:131], v[48:51]
    ds_read_b64_tr_b16 a[32:33], v3 offset:49152
    v_mfma_f32_16x16x32_bf16 v[52:55], a[60:63], a[132:135], v[52:55]
    ds_read_b64_tr_b16 a[34:35], v3 offset:50176
    v_mfma_f32_16x16x32_bf16 v[56:59], a[60:63], a[136:139], v[56:59]
    ds_read_b64_tr_b16 a[8:9], v4 offset:32768
    v_mfma_f32_16x16x32_bf16 v[60:63], a[60:63], a[140:143], v[60:63]
    ds_read_b64_tr_b16 a[10:11], v4 offset:33792
    v_mfma_f32_16x16x32_bf16 v[160:163], a[88:91], a[128:131], v[160:163]
    ds_read_b64_tr_b16 a[36:37], v4 offset:49152
    v_mfma_f32_16x16x32_bf16 v[164:167], a[88:91], a[132:135], v[164:167]
    ds_read_b64_tr_b16 a[38:39], v4 offset:50176
    v_mfma_f32_16x16x32_bf16 v[168:171], a[88:91], a[136:139], v[168:171]
    buffer_load_dwordx4 a[116:119], v17, s[20:23], s57 offen offset:0
    v_mfma_f32_16x16x32_bf16 v[172:175], a[88:91], a[140:143], v[172:175]
    ds_read_b64_tr_b16 a[12:13], v5 offset:32768
    v_mfma_f32_16x16x32_bf16 v[64:67], a[64:67], a[128:131], v[64:67]
    ds_read_b64_tr_b16 a[14:15], v5 offset:33792
    v_mfma_f32_16x16x32_bf16 v[68:71], a[64:67], a[132:135], v[68:71]
    ds_read_b64_tr_b16 a[40:41], v5 offset:49152
    v_mfma_f32_16x16x32_bf16 v[72:75], a[64:67], a[136:139], v[72:75]
    ds_read_b64_tr_b16 a[42:43], v5 offset:50176
    v_mfma_f32_16x16x32_bf16 v[76:79], a[64:67], a[140:143], v[76:79]
    ds_read_b64_tr_b16 a[16:17], v6 offset:32768
    v_mfma_f32_16x16x32_bf16 v[176:179], a[92:95], a[128:131], v[176:179]
    ds_read_b64_tr_b16 a[18:19], v6 offset:33792
    v_mfma_f32_16x16x32_bf16 v[180:183], a[92:95], a[132:135], v[180:183]
    buffer_load_dwordx4 a[120:123], v17, s[20:23], s58 offen offset:0
    v_mfma_f32_16x16x32_bf16 v[184:187], a[92:95], a[136:139], v[184:187]
    ds_read_b64_tr_b16 a[44:45], v6 offset:49152
    v_mfma_f32_16x16x32_bf16 v[188:191], a[92:95], a[140:143], v[188:191]
    ds_read_b64_tr_b16 a[46:47], v6 offset:50176
    v_mfma_f32_16x16x32_bf16 v[80:83], a[68:71], a[128:131], v[80:83]
    ds_read_b64_tr_b16 a[20:21], v7 offset:32768
    v_mfma_f32_16x16x32_bf16 v[84:87], a[68:71], a[132:135], v[84:87]
    ds_read_b64_tr_b16 a[22:23], v7 offset:33792
    v_mfma_f32_16x16x32_bf16 v[88:91], a[68:71], a[136:139], v[88:91]
    ds_read_b64_tr_b16 a[48:49], v7 offset:49152
    v_mfma_f32_16x16x32_bf16 v[92:95], a[68:71], a[140:143], v[92:95]
    ds_read_b64_tr_b16 a[50:51], v7 offset:50176
    v_mfma_f32_16x16x32_bf16 v[192:195], a[96:99], a[128:131], v[192:195]
    buffer_load_dwordx4 a[124:127], v17, s[20:23], s59 offen offset:0
    v_mfma_f32_16x16x32_bf16 v[196:199], a[96:99], a[132:135], v[196:199]
    ds_read_b64_tr_b16 a[24:25], v8 offset:32768
    v_mfma_f32_16x16x32_bf16 v[200:203], a[96:99], a[136:139], v[200:203]
    ds_read_b64_tr_b16 a[26:27], v8 offset:33792
    v_mfma_f32_16x16x32_bf16 v[204:207], a[96:99], a[140:143], v[204:207]
    ds_read_b64_tr_b16 a[52:53], v8 offset:49152
    v_mfma_f32_16x16x32_bf16 v[96:99], a[72:75], a[128:131], v[96:99]
    ds_read_b64_tr_b16 a[54:55], v8 offset:50176
    v_mfma_f32_16x16x32_bf16 v[100:103], a[72:75], a[132:135], v[100:103]
    v_mfma_f32_16x16x32_bf16 v[104:107], a[72:75], a[136:139], v[104:107]
    v_mfma_f32_16x16x32_bf16 v[108:111], a[72:75], a[140:143], v[108:111]
    v_mfma_f32_16x16x32_bf16 v[208:211], a[100:103], a[128:131], v[208:211]
    s_add_u32 m0, s30, 102400
    s_add_u32 s31, s28, 114688
    buffer_load_dwordx4 v16, s[16:19], s31 offen lds
    v_mfma_f32_16x16x32_bf16 v[212:215], a[100:103], a[132:135], v[212:215]
    v_mfma_f32_16x16x32_bf16 v[216:219], a[100:103], a[136:139], v[216:219]
    s_add_u32 m0, s30, 103424
    s_add_u32 s31, s28, 143360
    buffer_load_dwordx4 v16, s[16:19], s31 offen lds
    v_mfma_f32_16x16x32_bf16 v[220:223], a[100:103], a[140:143], v[220:223]
    v_mfma_f32_16x16x32_bf16 v[112:115], a[76:79], a[128:131], v[112:115]
    s_add_u32 m0, s30, 104448
    s_add_u32 s31, s28, 172032
    buffer_load_dwordx4 v18, s[16:19], s31 offen lds
    v_mfma_f32_16x16x32_bf16 v[116:119], a[76:79], a[132:135], v[116:119]
    v_mfma_f32_16x16x32_bf16 v[120:123], a[76:79], a[136:139], v[120:123]
    s_add_u32 m0, s30, 105472
    s_add_u32 s31, s28, 200704
    buffer_load_dwordx4 v18, s[16:19], s31 offen lds
    v_mfma_f32_16x16x32_bf16 v[124:127], a[76:79], a[140:143], v[124:127]
    v_mfma_f32_16x16x32_bf16 v[224:227], a[104:107], a[128:131], v[224:227]
    s_add_u32 s28, s28, 458752
    v_mfma_f32_16x16x32_bf16 v[228:231], a[104:107], a[132:135], v[228:231]
    v_mfma_f32_16x16x32_bf16 v[232:235], a[104:107], a[136:139], v[232:235]
    v_mfma_f32_16x16x32_bf16 v[236:239], a[104:107], a[140:143], v[236:239]
    v_mfma_f32_16x16x32_bf16 v[128:131], a[80:83], a[128:131], v[128:131]
    v_mfma_f32_16x16x32_bf16 v[132:135], a[80:83], a[132:135], v[132:135]
    v_mfma_f32_16x16x32_bf16 v[136:139], a[80:83], a[136:139], v[136:139]
    v_mfma_f32_16x16x32_bf16 v[140:143], a[80:83], a[140:143], v[140:143]
    v_mfma_f32_16x16x32_bf16 v[240:243], a[108:111], a[128:131], v[240:243]
    v_mfma_f32_16x16x32_bf16 v[244:247], a[108:111], a[132:135], v[244:247]
    v_mfma_f32_16x16x32_bf16 v[248:251], a[108:111], a[136:139], v[248:251]
    v_mfma_f32_16x16x32_bf16 v[252:255], a[108:111], a[140:143], v[252:255]
    s_waitcnt lgkmcnt(0)
    s_waitcnt vmcnt(16)
    v_mfma_f32_16x16x32_bf16 v[32:35], a[0:3], a[144:147], v[32:35]
    v_mfma_f32_16x16x32_bf16 v[36:39], a[0:3], a[148:151], v[36:39]
    ds_read_b64_tr_b16 a[56:57], v2 offset:40960
    v_mfma_f32_16x16x32_bf16 v[40:43], a[0:3], a[152:155], v[40:43]
    ds_read_b64_tr_b16 a[58:59], v2 offset:41984
    v_mfma_f32_16x16x32_bf16 v[44:47], a[0:3], a[156:159], v[44:47]
    ds_read_b64_tr_b16 a[84:85], v2 offset:57344
    v_mfma_f32_16x16x32_bf16 v[144:147], a[28:31], a[144:147], v[144:147]
    ds_read_b64_tr_b16 a[86:87], v2 offset:58368
    v_mfma_f32_16x16x32_bf16 v[148:151], a[28:31], a[148:151], v[148:151]
    ds_read_b64_tr_b16 a[60:61], v3 offset:40960
    v_mfma_f32_16x16x32_bf16 v[152:155], a[28:31], a[152:155], v[152:155]
    ds_read_b64_tr_b16 a[62:63], v3 offset:41984
    v_mfma_f32_16x16x32_bf16 v[156:159], a[28:31], a[156:159], v[156:159]
    buffer_load_dwordx4 a[128:131], v17, s[20:23], s56 offen offset:1024
    v_mfma_f32_16x16x32_bf16 v[48:51], a[4:7], a[144:147], v[48:51]
    ds_read_b64_tr_b16 a[88:89], v3 offset:57344
    v_mfma_f32_16x16x32_bf16 v[52:55], a[4:7], a[148:151], v[52:55]
    ds_read_b64_tr_b16 a[90:91], v3 offset:58368
    v_mfma_f32_16x16x32_bf16 v[56:59], a[4:7], a[152:155], v[56:59]
    ds_read_b64_tr_b16 a[64:65], v4 offset:40960
    v_mfma_f32_16x16x32_bf16 v[60:63], a[4:7], a[156:159], v[60:63]
    ds_read_b64_tr_b16 a[66:67], v4 offset:41984
    v_mfma_f32_16x16x32_bf16 v[160:163], a[32:35], a[144:147], v[160:163]
    ds_read_b64_tr_b16 a[92:93], v4 offset:57344
    v_mfma_f32_16x16x32_bf16 v[164:167], a[32:35], a[148:151], v[164:167]
    ds_read_b64_tr_b16 a[94:95], v4 offset:58368
    v_mfma_f32_16x16x32_bf16 v[168:171], a[32:35], a[152:155], v[168:171]
    buffer_load_dwordx4 a[132:135], v17, s[20:23], s57 offen offset:1024
    v_mfma_f32_16x16x32_bf16 v[172:175], a[32:35], a[156:159], v[172:175]
    ds_read_b64_tr_b16 a[68:69], v5 offset:40960
    v_mfma_f32_16x16x32_bf16 v[64:67], a[8:11], a[144:147], v[64:67]
    ds_read_b64_tr_b16 a[70:71], v5 offset:41984
    v_mfma_f32_16x16x32_bf16 v[68:71], a[8:11], a[148:151], v[68:71]
    ds_read_b64_tr_b16 a[96:97], v5 offset:57344
    v_mfma_f32_16x16x32_bf16 v[72:75], a[8:11], a[152:155], v[72:75]
    ds_read_b64_tr_b16 a[98:99], v5 offset:58368
    v_mfma_f32_16x16x32_bf16 v[76:79], a[8:11], a[156:159], v[76:79]
    ds_read_b64_tr_b16 a[72:73], v6 offset:40960
    v_mfma_f32_16x16x32_bf16 v[176:179], a[36:39], a[144:147], v[176:179]
    ds_read_b64_tr_b16 a[74:75], v6 offset:41984
    v_mfma_f32_16x16x32_bf16 v[180:183], a[36:39], a[148:151], v[180:183]
    buffer_load_dwordx4 a[136:139], v17, s[20:23], s58 offen offset:1024
    v_mfma_f32_16x16x32_bf16 v[184:187], a[36:39], a[152:155], v[184:187]
    ds_read_b64_tr_b16 a[100:101], v6 offset:57344
    v_mfma_f32_16x16x32_bf16 v[188:191], a[36:39], a[156:159], v[188:191]
    ds_read_b64_tr_b16 a[102:103], v6 offset:58368
    v_mfma_f32_16x16x32_bf16 v[80:83], a[12:15], a[144:147], v[80:83]
    ds_read_b64_tr_b16 a[76:77], v7 offset:40960
    v_mfma_f32_16x16x32_bf16 v[84:87], a[12:15], a[148:151], v[84:87]
    ds_read_b64_tr_b16 a[78:79], v7 offset:41984
    v_mfma_f32_16x16x32_bf16 v[88:91], a[12:15], a[152:155], v[88:91]
    ds_read_b64_tr_b16 a[104:105], v7 offset:57344
    v_mfma_f32_16x16x32_bf16 v[92:95], a[12:15], a[156:159], v[92:95]
    ds_read_b64_tr_b16 a[106:107], v7 offset:58368
    v_mfma_f32_16x16x32_bf16 v[192:195], a[40:43], a[144:147], v[192:195]
    buffer_load_dwordx4 a[140:143], v17, s[20:23], s59 offen offset:1024
    v_mfma_f32_16x16x32_bf16 v[196:199], a[40:43], a[148:151], v[196:199]
    ds_read_b64_tr_b16 a[80:81], v8 offset:40960
    v_mfma_f32_16x16x32_bf16 v[200:203], a[40:43], a[152:155], v[200:203]
    ds_read_b64_tr_b16 a[82:83], v8 offset:41984
    v_mfma_f32_16x16x32_bf16 v[204:207], a[40:43], a[156:159], v[204:207]
    ds_read_b64_tr_b16 a[108:109], v8 offset:57344
    v_mfma_f32_16x16x32_bf16 v[96:99], a[16:19], a[144:147], v[96:99]
    ds_read_b64_tr_b16 a[110:111], v8 offset:58368
    v_mfma_f32_16x16x32_bf16 v[100:103], a[16:19], a[148:151], v[100:103]
    v_mfma_f32_16x16x32_bf16 v[104:107], a[16:19], a[152:155], v[104:107]
    v_mfma_f32_16x16x32_bf16 v[108:111], a[16:19], a[156:159], v[108:111]
    s_add_u32 s56, s56, 2048
    s_add_u32 s57, s57, 2048
    s_add_u32 s58, s58, 2048
    s_add_u32 s59, s59, 2048
    v_mfma_f32_16x16x32_bf16 v[208:211], a[44:47], a[144:147], v[208:211]
    s_add_u32 m0, s30, 0
    s_add_u32 s31, s28, 0
    buffer_load_dwordx4 v16, s[16:19], s31 offen lds
    v_mfma_f32_16x16x32_bf16 v[212:215], a[44:47], a[148:151], v[212:215]
    v_mfma_f32_16x16x32_bf16 v[216:219], a[44:47], a[152:155], v[216:219]
    s_add_u32 m0, s30, 1024
    s_add_u32 s31, s28, 28672
    buffer_load_dwordx4 v16, s[16:19], s31 offen lds
    v_mfma_f32_16x16x32_bf16 v[220:223], a[44:47], a[156:159], v[220:223]
    v_mfma_f32_16x16x32_bf16 v[112:115], a[20:23], a[144:147], v[112:115]
    s_add_u32 m0, s30, 2048
    s_add_u32 s31, s28, 57344
    buffer_load_dwordx4 v18, s[16:19], s31 offen lds
    v_mfma_f32_16x16x32_bf16 v[116:119], a[20:23], a[148:151], v[116:119]
    v_mfma_f32_16x16x32_bf16 v[120:123], a[20:23], a[152:155], v[120:123]
    s_add_u32 m0, s30, 3072
    s_add_u32 s31, s28, 86016
    buffer_load_dwordx4 v18, s[16:19], s31 offen lds
    v_mfma_f32_16x16x32_bf16 v[124:127], a[20:23], a[156:159], v[124:127]
    v_mfma_f32_16x16x32_bf16 v[224:227], a[48:51], a[144:147], v[224:227]
    v_mfma_f32_16x16x32_bf16 v[228:231], a[48:51], a[148:151], v[228:231]
    v_mfma_f32_16x16x32_bf16 v[232:235], a[48:51], a[152:155], v[232:235]
    v_mfma_f32_16x16x32_bf16 v[236:239], a[48:51], a[156:159], v[236:239]
    v_mfma_f32_16x16x32_bf16 v[128:131], a[24:27], a[144:147], v[128:131]
    v_mfma_f32_16x16x32_bf16 v[132:135], a[24:27], a[148:151], v[132:135]
    v_mfma_f32_16x16x32_bf16 v[136:139], a[24:27], a[152:155], v[136:139]
    v_mfma_f32_16x16x32_bf16 v[140:143], a[24:27], a[156:159], v[140:143]
    v_mfma_f32_16x16x32_bf16 v[240:243], a[52:55], a[144:147], v[240:243]
    s_cmp_lt_u32 s32, 2
    s_cbranch_scc0 gemm3_kernel_o1a
    buffer_load_dword v30, v29, s[16:19], s62 offen
    s_add_u32 s62, s62, 688128
    buffer_load_dword v30, v0, s[72:75], s63 offen
    s_add_u32 s63, s63, 896
    s_branch gemm3_kernel_o1e
gemm3_kernel_o1a:
    s_mov_b32 s76, 2048
    buffer_load_dwordx4 a[184:187], v21, s[72:75], s76 offen
    s_mov_b32 s76, 3072
    buffer_load_dwordx4 a[188:191], v21, s[72:75], s76 offen
gemm3_kernel_o1e:
    v_mfma_f32_16x16x32_bf16 v[244:247], a[52:55], a[148:151], v[244:247]
    v_mfma_f32_16x16x32_bf16 v[248:251], a[52:55], a[152:155], v[248:251]
    v_mfma_f32_16x16x32_bf16 v[252:255], a[52:55], a[156:159], v[252:255]
    s_waitcnt lgkmcnt(0)
    s_waitcnt vmcnt(20)
    v_mfma_f32_16x16x32_bf16 v[32:35], a[56:59], a[160:163], v[32:35]
    s_waitcnt vmcnt(24)
    s_barrier
    v_mfma_f32_16x16x32_bf16 v[36:39], a[56:59], a[164:167], v[36:39]
    ds_read_b64_tr_b16 a[0:1], v9 offset:0
    v_mfma_f32_16x16x32_bf16 v[40:43], a[56:59], a[168:171], v[40:43]
    ds_read_b64_tr_b16 a[2:3], v9 offset:1024
    v_mfma_f32_16x16x32_bf16 v[44:47], a[56:59], a[172:175], v[44:47]
    ds_read_b64_tr_b16 a[28:29], v9 offset:16384
    v_mfma_f32_16x16x32_bf16 v[144:147], a[84:87], a[160:163], v[144:147]
    ds_read_b64_tr_b16 a[30:31], v9 offset:17408
    v_mfma_f32_16x16x32_bf16 v[148:151], a[84:87], a[164:167], v[148:151]
    ds_read_b64_tr_b16 a[4:5], v10 offset:0
    v_mfma_f32_16x16x32_bf16 v[152:155], a[84:87], a[168:171], v[152:155]
    ds_read_b64_tr_b16 a[6:7], v10 offset:1024
    v_mfma_f32_16x16x32_bf16 v[156:159], a[84:87], a[172:175], v[156:159]
    buffer_load_dwordx4 a[144:147], v17, s[20:23], s56 offen offset:0
    v_mfma_f32_16x16x32_bf16 v[48:51], a[60:63], a[160:163], v[48:51]
    ds_read_b64_tr_b16 a[32:33], v10 offset:16384
    v_mfma_f32_16x16x32_bf16 v[52:55], a[60:63], a[164:167], v[52:55]
    ds_read_b64_tr_b16 a[34:35], v10 offset:17408
    v_mfma_f32_16x16x32_bf16 v[56:59], a[60:63], a[168:171], v[56:59]
    ds_read_b64_tr_b16 a[8:9], v11 offset:0
    v_mfma_f32_16x16x32_bf16 v[60:63], a[60:63], a[172:175], v[60:63]
    ds_read_b64_tr_b16 a[10:11], v11 offset:1024
    v_mfma_f32_16x16x32_bf16 v[160:163], a[88:91], a[160:163], v[160:163]
    ds_read_b64_tr_b16 a[36:37], v11 offset:16384
    v_mfma_f32_16x16x32_bf16 v[164:167], a[88:91], a[164:167], v[164:167]
    ds_read_b64_tr_b16 a[38:39], v11 offset:17408
    v_mfma_f32_16x16x32_bf16 v[168:171], a[88:91], a[168:171], v[168:171]
    buffer_load_dwordx4 a[148:151], v17, s[20:23], s57 offen offset:0
    v_mfma_f32_16x16x32_bf16 v[172:175], a[88:91], a[172:175], v[172:175]
    ds_read_b64_tr_b16 a[12:13], v12 offset:0
    v_mfma_f32_16x16x32_bf16 v[64:67], a[64:67], a[160:163], v[64:67]
    ds_read_b64_tr_b16 a[14:15], v12 offset:1024
    v_mfma_f32_16x16x32_bf16 v[68:71], a[64:67], a[164:167], v[68:71]
    ds_read_b64_tr_b16 a[40:41], v12 offset:16384
    v_mfma_f32_16x16x32_bf16 v[72:75], a[64:67], a[168:171], v[72:75]
    ds_read_b64_tr_b16 a[42:43], v12 offset:17408
    v_mfma_f32_16x16x32_bf16 v[76:79], a[64:67], a[172:175], v[76:79]
    ds_read_b64_tr_b16 a[16:17], v13 offset:0
    v_mfma_f32_16x16x32_bf16 v[176:179], a[92:95], a[160:163], v[176:179]
    ds_read_b64_tr_b16 a[18:19], v13 offset:1024
    v_mfma_f32_16x16x32_bf16 v[180:183], a[92:95], a[164:167], v[180:183]
    buffer_load_dwordx4 a[152:155], v17, s[20:23], s58 offen offset:0
    v_mfma_f32_16x16x32_bf16 v[184:187], a[92:95], a[168:171], v[184:187]
    ds_read_b64_tr_b16 a[44:45], v13 offset:16384
    v_mfma_f32_16x16x32_bf16 v[188:191], a[92:95], a[172:175], v[188:191]
    ds_read_b64_tr_b16 a[46:47], v13 offset:17408
    v_mfma_f32_16x16x32_bf16 v[80:83], a[68:71], a[160:163], v[80:83]
    ds_read_b64_tr_b16 a[20:21], v14 offset:0
    v_mfma_f32_16x16x32_bf16 v[84:87], a[68:71], a[164:167], v[84:87]
    ds_read_b64_tr_b16 a[22:23], v14 offset:1024
    v_mfma_f32_16x16x32_bf16 v[88:91], a[68:71], a[168:171], v[88:91]
    ds_read_b64_tr_b16 a[48:49], v14 offset:16384
    v_mfma_f32_16x16x32_bf16 v[92:95], a[68:71], a[172:175], v[92:95]
    ds_read_b64_tr_b16 a[50:51], v14 offset:17408
    v_mfma_f32_16x16x32_bf16 v[192:195], a[96:99], a[160:163], v[192:195]
    buffer_load_dwordx4 a[156:159], v17, s[20:23], s59 offen offset:0
    v_mfma_f32_16x16x32_bf16 v[196:199], a[96:99], a[164:167], v[196:199]
    ds_read_b64_tr_b16 a[24:25], v15 offset:0
    v_mfma_f32_16x16x32_bf16 v[200:203], a[96:99], a[168:171], v[200:203]
    ds_read_b64_tr_b16 a[26:27], v15 offset:1024
    v_mfma_f32_16x16x32_bf16 v[204:207], a[96:99], a[172:175], v[204:207]
    ds_read_b64_tr_b16 a[52:53], v15 offset:16384
    v_mfma_f32_16x16x32_bf16 v[96:99], a[72:75], a[160:163], v[96:99]
    ds_read_b64_tr_b16 a[54:55], v15 offset:17408
    v_mfma_f32_16x16x32_bf16 v[100:103], a[72:75], a[164:167], v[100:103]
    v_mfma_f32_16x16x32_bf16 v[104:107], a[72:75], a[168:171], v[104:107]
    v_mfma_f32_16x16x32_bf16 v[108:111], a[72:75], a[172:175], v[108:111]
    v_mfma_f32_16x16x32_bf16 v[208:211], a[100:103], a[160:163], v[208:211]
    s_add_u32 m0, s30, 4096
    s_add_u32 s31, s28, 114688
    buffer_load_dwordx4 v16, s[16:19], s31 offen lds
    v_mfma_f32_16x16x32_bf16 v[212:215], a[100:103], a[164:167], v[212:215]
    v_mfma_f32_16x16x32_bf16 v[216:219], a[100:103], a[168:171], v[216:219]
    s_add_u32 m0, s30, 5120
    s_add_u32 s31, s28, 143360
    buffer_load_dwordx4 v16, s[16:19], s31 offen lds
    v_mfma_f32_16x16x32_bf16 v[220:223], a[100:103], a[172:175], v[220:223]
    v_mfma_f32_16x16x32_bf16 v[112:115], a[76:79], a[160:163], v[112:115]
    s_add_u32 m0, s30, 6144
    s_add_u32 s31, s28, 172032
    buffer_load_dwordx4 v18, s[16:19], s31 offen lds
    v_mfma_f32_16x16x32_bf16 v[116:119], a[76:79], a[164:167], v[116:119]
    v_mfma_f32_16x16x32_bf16 v[120:123], a[76:79], a[168:171], v[120:123]
    s_add_u32 m0, s30, 7168
    s_add_u32 s31, s28, 200704
    buffer_load_dwordx4 v18, s[16:19], s31 offen lds
    v_mfma_f32_16x16x32_bf16 v[124:127], a[76:79], a[172:175], v[124:127]
    v_mfma_f32_16x16x32_bf16 v[224:227], a[104:107], a[160:163], v[224:227]
    s_add_u32 s28, s28, 458752
    v_mfma_f32_16x16x32_bf16 v[228:231], a[104:107], a[164:167], v[228:231]
    v_mfma_f32_16x16x32_bf16 v[232:235], a[104:107], a[168:171], v[232:235]
    v_mfma_f32_16x16x32_bf16 v[236:239], a[104:107], a[172:175], v[236:239]
    v_mfma_f32_16x16x32_bf16 v[128:131], a[80:83], a[160:163], v[128:131]
    v_mfma_f32_16x16x32_bf16 v[132:135], a[80:83], a[164:167], v[132:135]
    v_mfma_f32_16x16x32_bf16 v[136:139], a[80:83], a[168:171], v[136:139]
    v_mfma_f32_16x16x32_bf16 v[140:143], a[80:83], a[172:175], v[140:143]
    v_mfma_f32_16x16x32_bf16 v[240:243], a[108:111], a[160:163], v[240:243]
    v_mfma_f32_16x16x32_bf16 v[244:247], a[108:111], a[164:167], v[244:247]
    v_mfma_f32_16x16x32_bf16 v[248:251], a[108:111], a[168:171], v[248:251]
    v_mfma_f32_16x16x32_bf16 v[252:255], a[108:111], a[172:175], v[252:255]
    s_waitcnt lgkmcnt(0)
    s_waitcnt vmcnt(20)
    v_mfma_f32_16x16x32_bf16 v[32:35], a[0:3], a[112:115], v[32:35]
    v_mfma_f32_16x16x32_bf16 v[36:39], a[0:3], a[116:119], v[36:39]
    ds_read_b64_tr_b16 a[56:57], v9 offset:8192
    v_mfma_f32_16x16x32_bf16 v[40:43], a[0:3], a[120:123], v[40:43]
    ds_read_b64_tr_b16 a[58:59], v9 offset:9216
    v_mfma_f32_16x16x32_bf16 v[44:47], a[0:3], a[124:127], v[44:47]
    ds_read_b64_tr_b16 a[84:85], v9 offset:24576
    v_mfma_f32_16x16x32_bf16 v[144:147], a[28:31], a[112:115], v[144:147]
    ds_read_b64_tr_b16 a[86:87], v9 offset:25600
    v_mfma_f32_16x16x32_bf16 v[148:151], a[28:31], a[116:119], v[148:151]
    ds_read_b64_tr_b16 a[60:61], v10 offset:8192
    v_mfma_f32_16x16x32_bf16 v[152:155], a[28:31], a[120:123], v[152:155]
    ds_read_b64_tr_b16 a[62:63], v10 offset:9216
    v_mfma_f32_16x16x32_bf16 v[156:159], a[28:31], a[124:127], v[156:159]
    buffer_load_dwordx4 a[160:163], v17, s[20:23], s56 offen offset:1024
    v_mfma_f32_16x16x32_bf16 v[48:51], a[4:7], a[112:115], v[48:51]
    ds_read_b64_tr_b16 a[88:89], v10 offset:24576
    v_mfma_f32_16x16x32_bf16 v[52:55], a[4:7], a[116:119], v[52:55]
    ds_read_b64_tr_b16 a[90:91], v10 offset:25600
    v_mfma_f32_16x16x32_bf16 v[56:59], a[4:7], a[120:123], v[56:59]
    ds_read_b64_tr_b16 a[64:65], v11 offset:8192
    v_mfma_f32_16x16x32_bf16 v[60:63], a[4:7], a[124:127], v[60:63]
    ds_read_b64_tr_b16 a[66:67], v11 offset:9216
    v_mfma_f32_16x16x32_bf16 v[160:163], a[32:35], a[112:115], v[160:163]
    ds_read_b64_tr_b16 a[92:93], v11 offset:24576
    v_mfma_f32_16x16x32_bf16 v[164:167], a[32:35], a[116:119], v[164:167]
    ds_read_b64_tr_b16 a[94:95], v11 offset:25600
    v_mfma_f32_16x16x32_bf16 v[168:171], a[32:35], a[120:123], v[168:171]
    buffer_load_dwordx4 a[164:167], v17, s[20:23], s57 offen offset:1024
    v_mfma_f32_16x16x32_bf16 v[172:175], a[32:35], a[124:127], v[172:175]
    ds_read_b64_tr_b16 a[68:69], v12 offset:8192
    v_mfma_f32_16x16x32_bf16 v[64:67], a[8:11], a[112:115], v[64:67]
    ds_read_b64_tr_b16 a[70:71], v12 offset:9216
    v_mfma_f32_16x16x32_bf16 v[68:71], a[8:11], a[116:119], v[68:71]
    ds_read_b64_tr_b16 a[96:97], v12 offset:24576
    v_mfma_f32_16x16x32_bf16 v[72:75], a[8:11], a[120:123], v[72:75]
    ds_read_b64_tr_b16 a[98:99], v12 offset:25600
    v_mfma_f32_16x16x32_bf16 v[76:79], a[8:11], a[124:127], v[76:79]
    ds_read_b64_tr_b16 a[72:73], v13 offset:8192
    v_mfma_f32_16x16x32_bf16 v[176:179], a[36:39], a[112:115], v[176:179]
    ds_read_b64_tr_b16 a[74:75], v13 offset:9216
    v_mfma_f32_16x16x32_bf16 v[180:183], a[36:39], a[116:119], v[180:183]
    buffer_load_dwordx4 a[168:171], v17, s[20:23], s58 offen offset:1024
    v_mfma_f32_16x16x32_bf16 v[184:187], a[36:39], a[120:123], v[184:187]
    ds_read_b64_tr_b16 a[100:101], v13 offset:24576
    v_mfma_f32_16x16x32_bf16 v[188:191], a[36:39], a[124:127], v[188:191]
    ds_read_b64_tr_b16 a[102:103], v13 offset:25600
    v_mfma_f32_16x16x32_bf16 v[80:83], a[12:15], a[112:115], v[80:83]
    ds_read_b64_tr_b16 a[76:77], v14 offset:8192
    v_mfma_f32_16x16x32_bf16 v[84:87], a[12:15], a[116:119], v[84:87]
    ds_read_b64_tr_b16 a[78:79], v14 offset:9216
    v_mfma_f32_16x16x32_bf16 v[88:91], a[12:15], a[120:123], v[88:91]
    ds_read_b64_tr_b16 a[104:105], v14 offset:24576
    v_mfma_f32_16x16x32_bf16 v[92:95], a[12:15], a[124:127], v[92:95]
    ds_read_b64_tr_b16 a[106:107], v14 offset:25600
    v_mfma_f32_16x16x32_bf16 v[192:195], a[40:43], a[112:115], v[192:195]
    buffer_load_dwordx4 a[172:175], v17, s[20:23], s59 offen offset:1024
    v_mfma_f32_16x16x32_bf16 v[196:199], a[40:43], a[116:119], v[196:199]
    ds_read_b64_tr_b16 a[80:81], v15 offset:8192
    v_mfma_f32_16x16x32_bf16 v[200:203], a[40:43], a[120:123], v[200:203]
    ds_read_b64_tr_b16 a[82:83], v15 offset:9216
    v_mfma_f32_16x16x32_bf16 v[204:207], a[40:43], a[124:127], v[204:207]
    ds_read_b64_tr_b16 a[108:109], v15 offset:24576
    v_mfma_f32_16x16x32_bf16 v[96:99], a[16:19], a[112:115], v[96:99]
    ds_read_b64_tr_b16 a[110:111], v15 offset:25600
    v_mfma_f32_16x16x32_bf16 v[100:103], a[16:19], a[116:119], v[100:103]
    v_mfma_f32_16x16x32_bf16 v[104:107], a[16:19], a[120:123], v[104:107]
    v_mfma_f32_16x16x32_bf16 v[108:111], a[16:19], a[124:127], v[108:111]
    s_add_u32 s56, s56, 2048
    s_add_u32 s57, s57, 2048
    s_add_u32 s58, s58, 2048
    s_add_u32 s59, s59, 2048
    v_mfma_f32_16x16x32_bf16 v[208:211], a[44:47], a[112:115], v[208:211]
    s_add_u32 m0, s30, 32768
    s_add_u32 s31, s28, 0
    buffer_load_dwordx4 v16, s[16:19], s31 offen lds
    v_mfma_f32_16x16x32_bf16 v[212:215], a[44:47], a[116:119], v[212:215]
    v_mfma_f32_16x16x32_bf16 v[216:219], a[44:47], a[120:123], v[216:219]
    s_add_u32 m0, s30, 33792
    s_add_u32 s31, s28, 28672
    buffer_load_dwordx4 v16, s[16:19], s31 offen lds
    v_mfma_f32_16x16x32_bf16 v[220:223], a[44:47], a[124:127], v[220:223]
    v_mfma_f32_16x16x32_bf16 v[112:115], a[20:23], a[112:115], v[112:115]
    s_add_u32 m0, s30, 34816
    s_add_u32 s31, s28, 57344
    buffer_load_dwordx4 v18, s[16:19], s31 offen lds
    v_mfma_f32_16x16x32_bf16 v[116:119], a[20:23], a[116:119], v[116:119]
    v_mfma_f32_16x16x32_bf16 v[120:123], a[20:23], a[120:123], v[120:123]
    s_add_u32 m0, s30, 35840
    s_add_u32 s31, s28, 86016
    buffer_load_dwordx4 v18, s[16:19], s31 offen lds
    v_mfma_f32_16x16x32_bf16 v[124:127], a[20:23], a[124:127], v[124:127]
    v_mfma_f32_16x16x32_bf16 v[224:227], a[48:51], a[112:115], v[224:227]
    v_mfma_f32_16x16x32_bf16 v[228:231], a[48:51], a[116:119], v[228:231]
    v_mfma_f32_16x16x32_bf16 v[232:235], a[48:51], a[120:123], v[232:235]
    v_mfma_f32_16x16x32_bf16 v[236:239], a[48:51], a[124:127], v[236:239]
    v_mfma_f32_16x16x32_bf16 v[128:131], a[24:27], a[112:115], v[128:131]
    v_mfma_f32_16x16x32_bf16 v[132:135], a[24:27], a[116:119], v[132:135]
    v_mfma_f32_16x16x32_bf16 v[136:139], a[24:27], a[120:123], v[136:139]
    v_mfma_f32_16x16x32_bf16 v[140:143], a[24:27], a[124:127], v[140:143]
    v_mfma_f32_16x16x32_bf16 v[240:243], a[52:55], a[112:115], v[240:243]
    s_cmp_lt_u32 s32, 2
    s_cbranch_scc0 gemm3_kernel_o2a
    buffer_load_dword v30, v29, s[16:19], s62 offen
    s_add_u32 s62, s62, 688128
    buffer_load_dword v30, v0, s[72:75], s63 offen
    s_add_u32 s63, s63, 896
    s_branch gemm3_kernel_o2e
gemm3_kernel_o2a:
    s_mov_b32 s76, 4096
    buffer_load_dwordx4 a[192:195], v21, s[72:75], s76 offen
    s_mov_b32 s76, 5120
    buffer_load_dwordx4 a[196:199], v21, s[72:75], s76 offen
gemm3_kernel_o2e:
    v_mfma_f32_16x16x32_bf16 v[244:247], a[52:55], a[116:119], v[244:247]
    v_mfma_f32_16x16x32_bf16 v[248:251], a[52:55], a[120:123], v[248:251]
    v_mfma_f32_16x16x32_bf16 v[252:255], a[52:55], a[124:127], v[252:255]
    s_waitcnt lgkmcnt(0)
    s_waitcnt vmcnt(20)
    v_mfma_f32_16x16x32_bf16 v[32:35], a[56:59], a[128:131], v[32:35]
    s_waitcnt vmcnt(24)
    s_barrier
    v_mfma_f32_16x16x32_bf16 v[36:39], a[56:59], a[132:135], v[36:39]
    ds_read_b64_tr_b16 a[0:1], v9 offset:32768
    v_mfma_f32_16x16x32_bf16 v[40:43], a[56:59], a[136:139], v[40:43]
    ds_read_b64_tr_b16 a[2:3], v9 offset:33792
    v_mfma_f32_16x16x32_bf16 v[44:47], a[56:59], a[140:143], v[44:47]
    ds_read_b64_tr_b16 a[28:29], v9 offset:49152
    v_mfma_f32_16x16x32_bf16 v[144:147], a[84:87], a[128:131], v[144:147]
    ds_read_b64_tr_b16 a[30:31], v9 offset:50176
    v_mfma_f32_16x16x32_bf16 v[148:151], a[84:87], a[132:135], v[148:151]
    ds_read_b64_tr_b16 a[4:5], v10 offset:32768
    v_mfma_f32_16x16x32_bf16 v[152:155], a[84:87], a[136:139], v[152:155]
    ds_read_b64_tr_b16 a[6:7], v10 offset:33792
    v_mfma_f32_16x16x32_bf16 v[156:159], a[84:87], a[140:143], v[156:159]
    buffer_load_dwordx4 a[112:115], v17, s[20:23], s56 offen offset:0
    v_mfma_f32_16x16x32_bf16 v[48:51], a[60:63], a[128:131], v[48:51]
    ds_read_b64_tr_b16 a[32:33], v10 offset:49152
    v_mfma_f32_16x16x32_bf16 v[52:55], a[60:63], a[132:135], v[52:55]
    ds_read_b64_tr_b16 a[34:35], v10 offset:50176
    v_mfma_f32_16x16x32_bf16 v[56:59], a[60:63], a[136:139], v[56:59]
    ds_read_b64_tr_b16 a[8:9], v11 offset:32768
    v_mfma_f32_16x16x32_bf16 v[60:63], a[60:63], a[140:143], v[60:63]
    ds_read_b64_tr_b16 a[10:11], v11 offset:33792
    v_mfma_f32_16x16x32_bf16 v[160:163], a[88:91], a[128:131], v[160:163]
    ds_read_b64_tr_b16 a[36:37], v11 offset:49152
    v_mfma_f32_16x16x32_bf16 v[164:167], a[88:91], a[132:135], v[164:167]
    ds_read_b64_tr_b16 a[38:39], v11 offset:50176
    v_mfma_f32_16x16x32_bf16 v[168:171], a[88:91], a[136:139], v[168:171]
    buffer_load_dwordx4 a[116:119], v17, s[20:23], s57 offen offset:0
    v_mfma_f32_16x16x32_bf16 v[172:175], a[88:91], a[140:143], v[172:175]
    ds_read_b64_tr_b16 a[12:13], v12 offset:32768
    v_mfma_f32_16x16x32_bf16 v[64:67], a[64:67], a[128:131], v[64:67]
    ds_read_b64_tr_b16 a[14:15], v12 offset:33792
    v_mfma_f32_16x16x32_bf16 v[68:71], a[64:67], a[132:135], v[68:71]
    ds_read_b64_tr_b16 a[40:41], v12 offset:49152
    v_mfma_f32_16x16x32_bf16 v[72:75], a[64:67], a[136:139], v[72:75]
    ds_read_b64_tr_b16 a[42:43], v12 offset:50176
    v_mfma_f32_16x16x32_bf16 v[76:79], a[64:67], a[140:143], v[76:79]
    ds_read_b64_tr_b16 a[16:17], v13 offset:32768
    v_mfma_f32_16x16x32_bf16 v[176:179], a[92:95], a[128:131], v[176:179]
    ds_read_b64_tr_b16 a[18:19], v13 offset:33792
    v_mfma_f32_16x16x32_bf16 v[180:183], a[92:95], a[132:135], v[180:183]
    buffer_load_dwordx4 a[120:123], v17, s[20:23], s58 offen offset:0
    v_mfma_f32_16x16x32_bf16 v[184:187], a[92:95], a[136:139], v[184:187]
    ds_read_b64_tr_b16 a[44:45], v13 offset:49152
    v_mfma_f32_16x16x32_bf16 v[188:191], a[92:95], a[140:143], v[188:191]
    ds_read_b64_tr_b16 a[46:47], v13 offset:50176
    v_mfma_f32_16x16x32_bf16 v[80:83], a[68:71], a[128:131], v[80:83]
    ds_read_b64_tr_b16 a[20:21], v14 offset:32768
    v_mfma_f32_16x16x32_bf16 v[84:87], a[68:71], a[132:135], v[84:87]
    ds_read_b64_tr_b16 a[22:23], v14 offset:33792
    v_mfma_f32_16x16x32_bf16 v[88:91], a[68:71], a[136:139], v[88:91]
    ds_read_b64_tr_b16 a[48:49], v14 offset:49152
    v_mfma_f32_16x16x32_bf16 v[92:95], a[68:71], a[140:143], v[92:95]
    ds_read_b64_tr_b16 a[50:51], v14 offset:50176
    v_mfma_f32_16x16x32_bf16 v[192:195], a[96:99], a[128:131], v[192:195]
    buffer_load_dwordx4 a[124:127], v17, s[20:23], s59 offen offset:0
    v_mfma_f32_16x16x32_bf16 v[196:199], a[96:99], a[132:135], v[196:199]
    ds_read_b64_tr_b16 a[24:25], v15 offset:32768
    v_mfma_f32_16x16x32_bf16 v[200:203], a[96:99], a[136:139], v[200:203]
    ds_read_b64_tr_b16 a[26:27], v15 offset:33792
    v_mfma_f32_16x16x32_bf16 v[204:207], a[96:99], a[140:143], v[204:207]
    ds_read_b64_tr_b16 a[52:53], v15 offset:49152
    v_mfma_f32_16x16x32_bf16 v[96:99], a[72:75], a[128:131], v[96:99]
    ds_read_b64_tr_b16 a[54:55], v15 offset:50176
    v_mfma_f32_16x16x32_bf16 v[100:103], a[72:75], a[132:135], v[100:103]
    v_mfma_f32_16x16x32_bf16 v[104:107], a[72:75], a[136:139], v[104:107]
    v_mfma_f32_16x16x32_bf16 v[108:111], a[72:75], a[140:143], v[108:111]
    v_mfma_f32_16x16x32_bf16 v[208:211], a[100:103], a[128:131], v[208:211]
    s_add_u32 m0, s30, 36864
    s_add_u32 s31, s28, 114688
    buffer_load_dwordx4 v16, s[16:19], s31 offen lds
    v_mfma_f32_16x16x32_bf16 v[212:215], a[100:103], a[132:135], v[212:215]
    v_mfma_f32_16x16x32_bf16 v[216:219], a[100:103], a[136:139], v[216:219]
    s_add_u32 m0, s30, 37888
    s_add_u32 s31, s28, 143360
    buffer_load_dwordx4 v16, s[16:19], s31 offen lds
    v_mfma_f32_16x16x32_bf16 v[220:223], a[100:103], a[140:143], v[220:223]
    v_mfma_f32_16x16x32_bf16 v[112:115], a[76:79], a[128:131], v[112:115]
    s_add_u32 m0, s30, 38912
    s_add_u32 s31, s28, 172032
    buffer_load_dwordx4 v18, s[16:19], s31 offen lds
    v_mfma_f32_16x16x32_bf16 v[116:119], a[76:79], a[132:135], v[116:119]
    v_mfma_f32_16x16x32_bf16 v[120:123], a[76:79], a[136:139], v[120:123]
    s_add_u32 m0, s30, 39936
    s_add_u32 s31, s28, 200704
    buffer_load_dwordx4 v18, s[16:19], s31 offen lds
    v_mfma_f32_16x16x32_bf16 v[124:127], a[76:79], a[140:143], v[124:127]
    v_mfma_f32_16x16x32_bf16 v[224:227], a[104:107], a[128:131], v[224:227]
    s_add_u32 s28, s28, 458752
    v_mfma_f32_16x16x32_bf16 v[228:231], a[104:107], a[132:135], v[228:231]
    v_mfma_f32_16x16x32_bf16 v[232:235], a[104:107], a[136:139], v[232:235]
    v_mfma_f32_16x16x32_bf16 v[236:239], a[104:107], a[140:143], v[236:239]
    v_mfma_f32_16x16x32_bf16 v[128:131], a[80:83], a[128:131], v[128:131]
    v_mfma_f32_16x16x32_bf16 v[132:135], a[80:83], a[132:135], v[132:135]
    v_mfma_f32_16x16x32_bf16 v[136:139], a[80:83], a[136:139], v[136:139]
    v_mfma_f32_16x16x32_bf16 v[140:143], a[80:83], a[140:143], v[140:143]
    v_mfma_f32_16x16x32_bf16 v[240:243], a[108:111], a[128:131], v[240:243]
    v_mfma_f32_16x16x32_bf16 v[244:247], a[108:111], a[132:135], v[244:247]
    v_mfma_f32_16x16x32_bf16 v[248:251], a[108:111], a[136:139], v[248:251]
    v_mfma_f32_16x16x32_bf16 v[252:255], a[108:111], a[140:143], v[252:255]
    s_waitcnt lgkmcnt(0)
    s_waitcnt vmcnt(20)
    v_mfma_f32_16x16x32_bf16 v[32:35], a[0:3], a[144:147], v[32:35]
    v_mfma_f32_16x16x32_bf16 v[36:39], a[0:3], a[148:151], v[36:39]
    ds_read_b64_tr_b16 a[56:57], v9 offset:40960
    v_mfma_f32_16x16x32_bf16 v[40:43], a[0:3], a[152:155], v[40:43]
    ds_read_b64_tr_b16 a[58:59], v9 offset:41984
    v_mfma_f32_16x16x32_bf16 v[44:47], a[0:3], a[156:159], v[44:47]
    ds_read_b64_tr_b16 a[84:85], v9 offset:57344
    v_mfma_f32_16x16x32_bf16 v[144:147], a[28:31], a[144:147], v[144:147]
    ds_read_b64_tr_b16 a[86:87], v9 offset:58368
    v_mfma_f32_16x16x32_bf16 v[148:151], a[28:31], a[148:151], v[148:151]
    ds_read_b64_tr_b16 a[60:61], v10 offset:40960
    v_mfma_f32_16x16x32_bf16 v[152:155], a[28:31], a[152:155], v[152:155]
    ds_read_b64_tr_b16 a[62:63], v10 offset:41984
    v_mfma_f32_16x16x32_bf16 v[156:159], a[28:31], a[156:159], v[156:159]
    buffer_load_dwordx4 a[128:131], v17, s[20:23], s56 offen offset:1024
    v_mfma_f32_16x16x32_bf16 v[48:51], a[4:7], a[144:147], v[48:51]
    ds_read_b64_tr_b16 a[88:89], v10 offset:57344
    v_mfma_f32_16x16x32_bf16 v[52:55], a[4:7], a[148:151], v[52:55]
    ds_read_b64_tr_b16 a[90:91], v10 offset:58368
    v_mfma_f32_16x16x32_bf16 v[56:59], a[4:7], a[152:155], v[56:59]
    ds_read_b64_tr_b16 a[64:65], v11 offset:40960
    v_mfma_f32_16x16x32_bf16 v[60:63], a[4:7], a[156:159], v[60:63]
    ds_read_b64_tr_b16 a[66:67], v11 offset:41984
    v_mfma_f32_16x16x32_bf16 v[160:163], a[32:35], a[144:147], v[160:163]
    ds_read_b64_tr_b16 a[92:93], v11 offset:57344
    v_mfma_f32_16x16x32_bf16 v[164:167], a[32:35], a[148:151], v[164:167]
    ds_read_b64_tr_b16 a[94:95], v11 offset:58368
    v_mfma_f32_16x16x32_bf16 v[168:171], a[32:35], a[152:155], v[168:171]
    buffer_load_dwordx4 a[132:135], v17, s[20:23], s57 offen offset:1024
    v_mfma_f32_16x16x32_bf16 v[172:175], a[32:35], a[156:159], v[172:175]
    ds_read_b64_tr_b16 a[68:69], v12 offset:40960
    v_mfma_f32_16x16x32_bf16 v[64:67], a[8:11], a[144:147], v[64:67]
    ds_read_b64_tr_b16 a[70:71], v12 offset:41984
    v_mfma_f32_16x16x32_bf16 v[68:71], a[8:11], a[148:151], v[68:71]
    ds_read_b64_tr_b16 a[96:97], v12 offset:57344
    v_mfma_f32_16x16x32_bf16 v[72:75], a[8:11], a[152:155], v[72:75]
    ds_read_b64_tr_b16 a[98:99], v12 offset:58368
    v_mfma_f32_16x16x32_bf16 v[76:79], a[8:11], a[156:159], v[76:79]
    ds_read_b64_tr_b16 a[72:73], v13 offset:40960
    v_mfma_f32_16x16x32_bf16 v[176:179], a[36:39], a[144:147], v[176:179]
    ds_read_b64_tr_b16 a[74:75], v13 offset:41984
    v_mfma_f32_16x16x32_bf16 v[180:183], a[36:39], a[148:151], v[180:183]
    buffer_load_dwordx4 a[136:139], v17, s[20:23], s58 offen offset:1024
    v_mfma_f32_16x16x32_bf16 v[184:187], a[36:39], a[152:155], v[184:187]
    ds_read_b64_tr_b16 a[100:101], v13 offset:57344
    v_mfma_f32_16x16x32_bf16 v[188:191], a[36:39], a[156:159], v[188:191]
    ds_read_b64_tr_b16 a[102:103], v13 offset:58368
    v_mfma_f32_16x16x32_bf16 v[80:83], a[12:15], a[144:147], v[80:83]
    ds_read_b64_tr_b16 a[76:77], v14 offset:40960
    v_mfma_f32_16x16x32_bf16 v[84:87], a[12:15], a[148:151], v[84:87]
    ds_read_b64_tr_b16 a[78:79], v14 offset:41984
    v_mfma_f32_16x16x32_bf16 v[88:91], a[12:15], a[152:155], v[88:91]
    ds_read_b64_tr_b16 a[104:105], v14 offset:57344
    v_mfma_f32_16x16x32_bf16 v[92:95], a[12:15], a[156:159], v[92:95]
    ds_read_b64_tr_b16 a[106:107], v14 offset:58368
    v_mfma_f32_16x16x32_bf16 v[192:195], a[40:43], a[144:147], v[192:195]
    buffer_load_dwordx4 a[140:143], v17, s[20:23], s59 offen offset:1024
    v_mfma_f32_16x16x32_bf16 v[196:199], a[40:43], a[148:151], v[196:199]
    ds_read_b64_tr_b16 a[80:81], v15 offset:40960
    v_mfma_f32_16x16x32_bf16 v[200:203], a[40:43], a[152:155], v[200:203]
    ds_read_b64_tr_b16 a[82:83], v15 offset:41984
    v_mfma_f32_16x16x32_bf16 v[204:207], a[40:43], a[156:159], v[204:207]
    ds_read_b64_tr_b16 a[108:109], v15 offset:57344
    v_mfma_f32_16x16x32_bf16 v[96:99], a[16:19], a[144:147], v[96:99]
    ds_read_b64_tr_b16 a[110:111], v15 offset:58368
    v_mfma_f32_16x16x32_bf16 v[100:103], a[16:19], a[148:151], v[100:103]
    v_mfma_f32_16x16x32_bf16 v[104:107], a[16:19], a[152:155], v[104:107]
    v_mfma_f32_16x16x32_bf16 v[108:111], a[16:19], a[156:159], v[108:111]
    s_add_u32 s56, s56, 2048
    s_add_u32 s57, s57, 2048
    s_add_u32 s58, s58, 2048
    s_add_u32 s59, s59, 2048
    v_mfma_f32_16x16x32_bf16 v[208:211], a[44:47], a[144:147], v[208:211]
    s_add_u32 m0, s30, 65536
    s_add_u32 s31, s28, 0
    buffer_load_dwordx4 v16, s[16:19], s31 offen lds
    v_mfma_f32_16x16x32_bf16 v[212:215], a[44:47], a[148:151], v[212:215]
    v_mfma_f32_16x16x32_bf16 v[216:219], a[44:47], a[152:155], v[216:219]
    s_add_u32 m0, s30, 66560
    s_add_u32 s31, s28, 28672
    buffer_load_dwordx4 v16, s[16:19], s31 offen lds
    v_mfma_f32_16x16x32_bf16 v[220:223], a[44:47], a[156:159], v[220:223]
    v_mfma_f32_16x16x32_bf16 v[112:115], a[20:23], a[144:147], v[112:115]
    s_add_u32 m0, s30, 67584
    s_add_u32 s31, s28, 57344
    buffer_load_dwordx4 v18, s[16:19], s31 offen lds
    v_mfma_f32_16x16x32_bf16 v[116:119], a[20:23], a[148:151], v[116:119]
    v_mfma_f32_16x16x32_bf16 v[120:123], a[20:23], a[152:155], v[120:123]
    s_add_u32 m0, s30, 68608
    s_add_u32 s31, s28, 86016
    buffer_load_dwordx4 v18, s[16:19], s31 offen lds
    v_mfma_f32_16x16x32_bf16 v[124:127], a[20:23], a[156:159], v[124:127]
    v_mfma_f32_16x16x32_bf16 v[224:227], a[48:51], a[144:147], v[224:227]
    v_mfma_f32_16x16x32_bf16 v[228:231], a[48:51], a[148:151], v[228:231]
    v_mfma_f32_16x16x32_bf16 v[232:235], a[48:51], a[152:155], v[232:235]
    v_mfma_f32_16x16x32_bf16 v[236:239], a[48:51], a[156:159], v[236:239]
    v_mfma_f32_16x16x32_bf16 v[128:131], a[24:27], a[144:147], v[128:131]
    v_mfma_f32_16x16x32_bf16 v[132:135], a[24:27], a[148:151], v[132:135]
    v_mfma_f32_16x16x32_bf16 v[136:139], a[24:27], a[152:155], v[136:139]
    v_mfma_f32_16x16x32_bf16 v[140:143], a[24:27], a[156:159], v[140:143]
    v_mfma_f32_16x16x32_bf16 v[240:243], a[52:55], a[144:147], v[240:243]
    s_cmp_lt_u32 s32, 2
    s_cbranch_scc0 gemm3_kernel_o3a
    buffer_load_dword v30, v29, s[16:19], s62 offen
    s_add_u32 s62, s62, 688128
    buffer_load_dword v30, v0, s[72:75], s63 offen
    s_add_u32 s63, s63, 896
    s_branch gemm3_kernel_o3e
gemm3_kernel_o3a:
    s_mov_b32 s76, 6144
    buffer_load_dwordx4 a[200:203], v21, s[72:75], s76 offen
gemm3_kernel_o3e:
    v_mfma_f32_16x16x32_bf16 v[244:247], a[52:55], a[148:151], v[244:247]
    v_mfma_f32_16x16x32_bf16 v[248:251], a[52:55], a[152:155], v[248:251]
    v_mfma_f32_16x16x32_bf16 v[252:255], a[52:55], a[156:159], v[252:255]
    s_waitcnt lgkmcnt(0)
    s_waitcnt vmcnt(20)
    v_mfma_f32_16x16x32_bf16 v[32:35], a[56:59], a[160:163], v[32:35]
    s_waitcnt vmcnt(24)
    s_barrier
    v_mfma_f32_16x16x32_bf16 v[36:39], a[56:59], a[164:167], v[36:39]
    ds_read_b64_tr_b16 a[0:1], v2 offset:0
    v_mfma_f32_16x16x32_bf16 v[40:43], a[56:59], a[168:171], v[40:43]
    ds_read_b64_tr_b16 a[2:3], v2 offset:1024
    v_mfma_f32_16x16x32_bf16 v[44:47], a[56:59], a[172:175], v[44:47]
    ds_read_b64_tr_b16 a[28:29], v2 offset:16384
    v_mfma_f32_16x16x32_bf16 v[144:147], a[84:87], a[160:163], v[144:147]
    ds_read_b64_tr_b16 a[30:31], v2 offset:17408
    v_mfma_f32_16x16x32_bf16 v[148:151], a[84:87], a[164:167], v[148:151]
    ds_read_b64_tr_b16 a[4:5], v3 offset:0
    v_mfma_f32_16x16x32_bf16 v[152:155], a[84:87], a[168:171], v[152:155]
    ds_read_b64_tr_b16 a[6:7], v3 offset:1024
    v_mfma_f32_16x16x32_bf16 v[156:159], a[84:87], a[172:175], v[156:159]
    buffer_load_dwordx4 a[144:147], v17, s[20:23], s56 offen offset:0
    v_mfma_f32_16x16x32_bf16 v[48:51], a[60:63], a[160:163], v[48:51]
    ds_read_b64_tr_b16 a[32:33], v3 offset:16384
    v_mfma_f32_16x16x32_bf16 v[52:55], a[60:63], a[164:167], v[52:55]
    ds_read_b64_tr_b16 a[34:35], v3 offset:17408
    v_mfma_f32_16x16x32_bf16 v[56:59], a[60:63], a[168:171], v[56:59]
    ds_read_b64_tr_b16 a[8:9], v4 offset:0
    v_mfma_f32_16x16x32_bf16 v[60:63], a[60:63], a[172:175], v[60:63]
    ds_read_b64_tr_b16 a[10:11], v4 offset:1024
    v_mfma_f32_16x16x32_bf16 v[160:163], a[88:91], a[160:163], v[160:163]
    ds_read_b64_tr_b16 a[36:37], v4 offset:16384
    v_mfma_f32_16x16x32_bf16 v[164:167], a[88:91], a[164:167], v[164:167]
    ds_read_b64_tr_b16 a[38:39], v4 offset:17408
    v_mfma_f32_16x16x32_bf16 v[168:171], a[88:91], a[168:171], v[168:171]
    buffer_load_dwordx4 a[148:151], v17, s[20:23], s57 offen offset:0
    v_mfma_f32_16x16x32_bf16 v[172:175], a[88:91], a[172:175], v[172:175]
    ds_read_b64_tr_b16 a[12:13], v5 offset:0
    v_mfma_f32_16x16x32_bf16 v[64:67], a[64:67], a[160:163], v[64:67]
    ds_read_b64_tr_b16 a[14:15], v5 offset:1024
    v_mfma_f32_16x16x32_bf16 v[68:71], a[64:67], a[164:167], v[68:71]
    ds_read_b64_tr_b16 a[40:41], v5 offset:16384
    v_mfma_f32_16x16x32_bf16 v[72:75], a[64:67], a[168:171], v[72:75]
    ds_read_b64_tr_b16 a[42:43], v5 offset:17408
    v_mfma_f32_16x16x32_bf16 v[76:79], a[64:67], a[172:175], v[76:79]
    ds_read_b64_tr_b16 a[16:17], v6 offset:0
    v_mfma_f32_16x16x32_bf16 v[176:179], a[92:95], a[160:163], v[176:179]
    ds_read_b64_tr_b16 a[18:19], v6 offset:1024
    v_mfma_f32_16x16x32_bf16 v[180:183], a[92:95], a[164:167], v[180:183]
    buffer_load_dwordx4 a[152:155], v17, s[20:23], s58 offen offset:0
    v_mfma_f32_16x16x32_bf16 v[184:187], a[92:95], a[168:171], v[184:187]
    ds_read_b64_tr_b16 a[44:45], v6 offset:16384
    v_mfma_f32_16x16x32_bf16 v[188:191], a[92:95], a[172:175], v[188:191]
    ds_read_b64_tr_b16 a[46:47], v6 offset:17408
    v_mfma_f32_16x16x32_bf16 v[80:83], a[68:71], a[160:163], v[80:83]
    ds_read_b64_tr_b16 a[20:21], v7 offset:0
    v_mfma_f32_16x16x32_bf16 v[84:87], a[68:71], a[164:167], v[84:87]
    ds_read_b64_tr_b16 a[22:23], v7 offset:1024
    v_mfma_f32_16x16x32_bf16 v[88:91], a[68:71], a[168:171], v[88:91]
    ds_read_b64_tr_b16 a[48:49], v7 offset:16384
    v_mfma_f32_16x16x32_bf16 v[92:95], a[68:71], a[172:175], v[92:95]
    ds_read_b64_tr_b16 a[50:51], v7 offset:17408
    v_mfma_f32_16x16x32_bf16 v[192:195], a[96:99], a[160:163], v[192:195]
    buffer_load_dwordx4 a[156:159], v17, s[20:23], s59 offen offset:0
    v_mfma_f32_16x16x32_bf16 v[196:199], a[96:99], a[164:167], v[196:199]
    ds_read_b64_tr_b16 a[24:25], v8 offset:0
    v_mfma_f32_16x16x32_bf16 v[200:203], a[96:99], a[168:171], v[200:203]
    ds_read_b64_tr_b16 a[26:27], v8 offset:1024
    v_mfma_f32_16x16x32_bf16 v[204:207], a[96:99], a[172:175], v[204:207]
    ds_read_b64_tr_b16 a[52:53], v8 offset:16384
    v_mfma_f32_16x16x32_bf16 v[96:99], a[72:75], a[160:163], v[96:99]
    ds_read_b64_tr_b16 a[54:55], v8 offset:17408
    v_mfma_f32_16x16x32_bf16 v[100:103], a[72:75], a[164:167], v[100:103]
    v_mfma_f32_16x16x32_bf16 v[104:107], a[72:75], a[168:171], v[104:107]
    v_mfma_f32_16x16x32_bf16 v[108:111], a[72:75], a[172:175], v[108:111]
    v_mfma_f32_16x16x32_bf16 v[208:211], a[100:103], a[160:163], v[208:211]
    s_add_u32 m0, s30, 69632
    s_add_u32 s31, s28, 114688
    buffer_load_dwordx4 v16, s[16:19], s31 offen lds
    v_mfma_f32_16x16x32_bf16 v[212:215], a[100:103], a[164:167], v[212:215]
    v_mfma_f32_16x16x32_bf16 v[216:219], a[100:103], a[168:171], v[216:219]
    s_add_u32 m0, s30, 70656
    s_add_u32 s31, s28, 143360
    buffer_load_dwordx4 v16, s[16:19], s31 offen lds
    v_mfma_f32_16x16x32_bf16 v[220:223], a[100:103], a[172:175], v[220:223]
    v_mfma_f32_16x16x32_bf16 v[112:115], a[76:79], a[160:163], v[112:115]
    s_add_u32 m0, s30, 71680
    s_add_u32 s31, s28, 172032
    buffer_load_dwordx4 v18, s[16:19], s31 offen lds
    v_mfma_f32_16x16x32_bf16 v[116:119], a[76:79], a[164:167], v[116:119]
    v_mfma_f32_16x16x32_bf16 v[120:123], a[76:79], a[168:171], v[120:123]
    s_add_u32 m0, s30, 72704
    s_add_u32 s31, s28, 200704
    buffer_load_dwordx4 v18, s[16:19], s31 offen lds
    v_mfma_f32_16x16x32_bf16 v[124:127], a[76:79], a[172:175], v[124:127]
    v_mfma_f32_16x16x32_bf16 v[224:227], a[104:107], a[160:163], v[224:227]
    s_add_u32 s28, s28, 458752
    v_mfma_f32_16x16x32_bf16 v[228:231], a[104:107], a[164:167], v[228:231]
    v_mfma_f32_16x16x32_bf16 v[232:235], a[104:107], a[168:171], v[232:235]
    v_mfma_f32_16x16x32_bf16 v[236:239], a[104:107], a[172:175], v[236:239]
    v_mfma_f32_16x16x32_bf16 v[128:131], a[80:83], a[160:163], v[128:131]
    v_mfma_f32_16x16x32_bf16 v[132:135], a[80:83], a[164:167], v[132:135]
    v_mfma_f32_16x16x32_bf16 v[136:139], a[80:83], a[168:171], v[136:139]
    v_mfma_f32_16x16x32_bf16 v[140:143], a[80:83], a[172:175], v[140:143]
    v_mfma_f32_16x16x32_bf16 v[240:243], a[108:111], a[160:163], v[240:243]
    v_mfma_f32_16x16x32_bf16 v[244:247], a[108:111], a[164:167], v[244:247]
    v_mfma_f32_16x16x32_bf16 v[248:251], a[108:111], a[168:171], v[248:251]
    v_mfma_f32_16x16x32_bf16 v[252:255], a[108:111], a[172:175], v[252:255]
    s_add_u32 s32, s32, 1
    s_cmp_lt_u32 s32, 3
    s_cbranch_scc1 gemm3_kernel_loop
    s_waitcnt lgkmcnt(0)
    s_waitcnt vmcnt(20)
    v_mfma_f32_16x16x32_bf16 v[32:35], a[0:3], a[112:115], v[32:35]
    v_mfma_f32_16x16x32_bf16 v[36:39], a[0:3], a[116:119], v[36:39]
    ds_read_b64_tr_b16 a[56:57], v2 offset:8192
    v_mfma_f32_16x16x32_bf16 v[40:43], a[0:3], a[120:123], v[40:43]
    ds_read_b64_tr_b16 a[58:59], v2 offset:9216
    v_mfma_f32_16x16x32_bf16 v[44:47], a[0:3], a[124:127], v[44:47]
    ds_read_b64_tr_b16 a[84:85], v2 offset:24576
    v_mfma_f32_16x16x32_bf16 v[144:147], a[28:31], a[112:115], v[144:147]
    ds_read_b64_tr_b16 a[86:87], v2 offset:25600
    v_mfma_f32_16x16x32_bf16 v[148:151], a[28:31], a[116:119], v[148:151]
    ds_read_b64_tr_b16 a[60:61], v3 offset:8192
    v_mfma_f32_16x16x32_bf16 v[152:155], a[28:31], a[120:123], v[152:155]
    ds_read_b64_tr_b16 a[62:63], v3 offset:9216
    v_mfma_f32_16x16x32_bf16 v[156:159], a[28:31], a[124:127], v[156:159]
    buffer_load_dwordx4 a[160:163], v17, s[20:23], s56 offen offset:1024
    v_mfma_f32_16x16x32_bf16 v[48:51], a[4:7], a[112:115], v[48:51]
    ds_read_b64_tr_b16 a[88:89], v3 offset:24576
    v_mfma_f32_16x16x32_bf16 v[52:55], a[4:7], a[116:119], v[52:55]
    ds_read_b64_tr_b16 a[90:91], v3 offset:25600
    v_mfma_f32_16x16x32_bf16 v[56:59], a[4:7], a[120:123], v[56:59]
    ds_read_b64_tr_b16 a[64:65], v4 offset:8192
    v_mfma_f32_16x16x32_bf16 v[60:63], a[4:7], a[124:127], v[60:63]
    ds_read_b64_tr_b16 a[66:67], v4 offset:9216
    v_mfma_f32_16x16x32_bf16 v[160:163], a[32:35], a[112:115], v[160:163]
    ds_read_b64_tr_b16 a[92:93], v4 offset:24576
    v_mfma_f32_16x16x32_bf16 v[164:167], a[32:35], a[116:119], v[164:167]
    ds_read_b64_tr_b16 a[94:95], v4 offset:25600
    v_mfma_f32_16x16x32_bf16 v[168:171], a[32:35], a[120:123], v[168:171]
    buffer_load_dwordx4 a[164:167], v17, s[20:23], s57 offen offset:1024
    v_mfma_f32_16x16x32_bf16 v[172:175], a[32:35], a[124:127], v[172:175]
    ds_read_b64_tr_b16 a[68:69], v5 offset:8192
    v_mfma_f32_16x16x32_bf16 v[64:67], a[8:11], a[112:115], v[64:67]
    ds_read_b64_tr_b16 a[70:71], v5 offset:9216
    v_mfma_f32_16x16x32_bf16 v[68:71], a[8:11], a[116:119], v[68:71]
    ds_read_b64_tr_b16 a[96:97], v5 offset:24576
    v_mfma_f32_16x16x32_bf16 v[72:75], a[8:11], a[120:123], v[72:75]
    ds_read_b64_tr_b16 a[98:99], v5 offset:25600
    v_mfma_f32_16x16x32_bf16 v[76:79], a[8:11], a[124:127], v[76:79]
    ds_read_b64_tr_b16 a[72:73], v6 offset:8192
    v_mfma_f32_16x16x32_bf16 v[176:179], a[36:39], a[112:115], v[176:179]
    ds_read_b64_tr_b16 a[74:75], v6 offset:9216
    v_mfma_f32_16x16x32_bf16 v[180:183], a[36:39], a[116:119], v[180:183]
    buffer_load_dwordx4 a[168:171], v17, s[20:23], s58 offen offset:1024
    v_mfma_f32_16x16x32_bf16 v[184:187], a[36:39], a[120:123], v[184:187]
    ds_read_b64_tr_b16 a[100:101], v6 offset:24576
    v_mfma_f32_16x16x32_bf16 v[188:191], a[36:39], a[124:127], v[188:191]
    ds_read_b64_tr_b16 a[102:103], v6 offset:25600
    v_mfma_f32_16x16x32_bf16 v[80:83], a[12:15], a[112:115], v[80:83]
    ds_read_b64_tr_b16 a[76:77], v7 offset:8192
    v_mfma_f32_16x16x32_bf16 v[84:87], a[12:15], a[116:119], v[84:87]
    ds_read_b64_tr_b16 a[78:79], v7 offset:9216
    v_mfma_f32_16x16x32_bf16 v[88:91], a[12:15], a[120:123], v[88:91]
    ds_read_b64_tr_b16 a[104:105], v7 offset:24576
    v_mfma_f32_16x16x32_bf16 v[92:95], a[12:15], a[124:127], v[92:95]
    ds_read_b64_tr_b16 a[106:107], v7 offset:25600
    v_mfma_f32_16x16x32_bf16 v[192:195], a[40:43], a[112:115], v[192:195]
    buffer_load_dwordx4 a[172:175], v17, s[20:23], s59 offen offset:1024
    v_mfma_f32_16x16x32_bf16 v[196:199], a[40:43], a[116:119], v[196:199]
    ds_read_b64_tr_b16 a[80:81], v8 offset:8192
    v_mfma_f32_16x16x32_bf16 v[200:203], a[40:43], a[120:123], v[200:203]
    ds_read_b64_tr_b16 a[82:83], v8 offset:9216
    v_mfma_f32_16x16x32_bf16 v[204:207], a[40:43], a[124:127], v[204:207]
    ds_read_b64_tr_b16 a[108:109], v8 offset:24576
    v_mfma_f32_16x16x32_bf16 v[96:99], a[16:19], a[112:115], v[96:99]
    ds_read_b64_tr_b16 a[110:111], v8 offset:25600
    v_mfma_f32_16x16x32_bf16 v[100:103], a[16:19], a[116:119], v[100:103]
    v_mfma_f32_16x16x32_bf16 v[104:107], a[16:19], a[120:123], v[104:107]
    v_mfma_f32_16x16x32_bf16 v[108:111], a[16:19], a[124:127], v[108:111]
    s_add_u32 s56, s56, 2048
    s_add_u32 s57, s57, 2048
    s_add_u32 s58, s58, 2048
    s_add_u32 s59, s59, 2048
    v_mfma_f32_16x16x32_bf16 v[208:211], a[44:47], a[112:115], v[208:211]
    s_add_u32 m0, s30, 98304
    s_add_u32 s31, s28, 0
    buffer_load_dwordx4 v16, s[16:19], s31 offen lds
    v_mfma_f32_16x16x32_bf16 v[212:215], a[44:47], a[116:119], v[212:215]
    v_mfma_f32_16x16x32_bf16 v[216:219], a[44:47], a[120:123], v[216:219]
    s_add_u32 m0, s30, 99328
    s_add_u32 s31, s28, 28672
    buffer_load_dwordx4 v16, s[16:19], s31 offen lds
    v_mfma_f32_16x16x32_bf16 v[220:223], a[44:47], a[124:127], v[220:223]
    v_mfma_f32_16x16x32_bf16 v[112:115], a[20:23], a[112:115], v[112:115]
    s_add_u32 m0, s30, 100352
    s_add_u32 s31, s28, 57344
    buffer_load_dwordx4 v18, s[16:19], s31 offen lds
    v_mfma_f32_16x16x32_bf16 v[116:119], a[20:23], a[116:119], v[116:119]
    v_mfma_f32_16x16x32_bf16 v[120:123], a[20:23], a[120:123], v[120:123]
    s_add_u32 m0, s30, 101376
    s_add_u32 s31, s28, 86016
    buffer_load_dwordx4 v18, s[16:19], s31 offen lds
    v_mfma_f32_16x16x32_bf16 v[124:127], a[20:23], a[124:127], v[124:127]
    v_mfma_f32_16x16x32_bf16 v[224:227], a[48:51], a[112:115], v[224:227]
    v_mfma_f32_16x16x32_bf16 v[228:231], a[48:51], a[116:119], v[228:231]
    v_mfma_f32_16x16x32_bf16 v[232:235], a[48:51], a[120:123], v[232:235]
    v_mfma_f32_16x16x32_bf16 v[236:239], a[48:51], a[124:127], v[236:239]
    v_mfma_f32_16x16x32_bf16 v[128:131], a[24:27], a[112:115], v[128:131]
    v_mfma_f32_16x16x32_bf16 v[132:135], a[24:27], a[116:119], v[132:135]
    v_mfma_f32_16x16x32_bf16 v[136:139], a[24:27], a[120:123], v[136:139]
    v_mfma_f32_16x16x32_bf16 v[140:143], a[24:27], a[124:127], v[140:143]
    v_mfma_f32_16x16x32_bf16 v[240:243], a[52:55], a[112:115], v[240:243]
    buffer_store_dwordx4 a[176:179], v1, s[40:43], s64 offen
    v_mfma_f32_16x16x32_bf16 v[244:247], a[52:55], a[116:119], v[244:247]
    v_mfma_f32_16x16x32_bf16 v[248:251], a[52:55], a[120:123], v[248:251]
    v_mfma_f32_16x16x32_bf16 v[252:255], a[52:55], a[124:127], v[252:255]
    s_waitcnt lgkmcnt(0)
    s_waitcnt vmcnt(20)
    v_mfma_f32_16x16x32_bf16 v[32:35], a[56:59], a[128:131], v[32:35]
    s_waitcnt vmcnt(24)
    s_barrier
    v_mfma_f32_16x16x32_bf16 v[36:39], a[56:59], a[132:135], v[36:39]
    ds_read_b64_tr_b16 a[0:1], v2 offset:32768
    v_mfma_f32_16x16x32_bf16 v[40:43], a[56:59], a[136:139], v[40:43]
    ds_read_b64_tr_b16 a[2:3], v2 offset:33792
    v_mfma_f32_16x16x32_bf16 v[44:47], a[56:59], a[140:143], v[44:47]
    ds_read_b64_tr_b16 a[28:29], v2 offset:49152
    v_mfma_f32_16x16x32_bf16 v[144:147], a[84:87], a[128:131], v[144:147]
    ds_read_b64_tr_b16 a[30:31], v2 offset:50176
    v_mfma_f32_16x16x32_bf16 v[148:151], a[84:87], a[132:135], v[148:151]
    ds_read_b64_tr_b16 a[4:5], v3 offset:32768
    v_mfma_f32_16x16x32_bf16 v[152:155], a[84:87], a[136:139], v[152:155]
    ds_read_b64_tr_b16 a[6:7], v3 offset:33792
    v_mfma_f32_16x16x32_bf16 v[156:159], a[84:87], a[140:143], v[156:159]
    buffer_load_dwordx4 a[112:115], v17, s[20:23], s56 offen offset:0
    v_mfma_f32_16x16x32_bf16 v[48:51], a[60:63], a[128:131], v[48:51]
    ds_read_b64_tr_b16 a[32:33], v3 offset:49152
    v_mfma_f32_16x16x32_bf16 v[52:55], a[60:63], a[132:135], v[52:55]
    ds_read_b64_tr_b16 a[34:35], v3 offset:50176
    v_mfma_f32_16x16x32_bf16 v[56:59], a[60:63], a[136:139], v[56:59]
    ds_read_b64_tr_b16 a[8:9], v4 offset:32768
    v_mfma_f32_16x16x32_bf16 v[60:63], a[60:63], a[140:143], v[60:63]
    ds_read_b64_tr_b16 a[10:11], v4 offset:33792
    v_mfma_f32_16x16x32_bf16 v[160:163], a[88:91], a[128:131], v[160:163]
    ds_read_b64_tr_b16 a[36:37], v4 offset:49152
    v_mfma_f32_16x16x32_bf16 v[164:167], a[88:91], a[132:135], v[164:167]
    ds_read_b64_tr_b16 a[38:39], v4 offset:50176
    v_mfma_f32_16x16x32_bf16 v[168:171], a[88:91], a[136:139], v[168:171]
    buffer_load_dwordx4 a[116:119], v17, s[20:23], s57 offen offset:0
    v_mfma_f32_16x16x32_bf16 v[172:175], a[88:91], a[140:143], v[172:175]
    ds_read_b64_tr_b16 a[12:13], v5 offset:32768
    v_mfma_f32_16x16x32_bf16 v[64:67], a[64:67], a[128:131], v[64:67]
    ds_read_b64_tr_b16 a[14:15], v5 offset:33792
    v_mfma_f32_16x16x32_bf16 v[68:71], a[64:67], a[132:135], v[68:71]
    ds_read_b64_tr_b16 a[40:41], v5 offset:49152
    v_mfma_f32_16x16x32_bf16 v[72:75], a[64:67], a[136:139], v[72:75]
    ds_read_b64_tr_b16 a[42:43], v5 offset:50176
    v_mfma_f32_16x16x32_bf16 v[76:79], a[64:67], a[140:143], v[76:79]
    ds_read_b64_tr_b16 a[16:17], v6 offset:32768
    v_mfma_f32_16x16x32_bf16 v[176:179], a[92:95], a[128:131], v[176:179]
    ds_read_b64_tr_b16 a[18:19], v6 offset:33792
    v_mfma_f32_16x16x32_bf16 v[180:183], a[92:95], a[132:135], v[180:183]
    buffer_load_dwordx4 a[120:123], v17, s[20:23], s58 offen offset:0
    v_mfma_f32_16x16x32_bf16 v[184:187], a[92:95], a[136:139], v[184:187]
    ds_read_b64_tr_b16 a[44:45], v6 offset:49152
    v_mfma_f32_16x16x32_bf16 v[188:191], a[92:95], a[140:143], v[188:191]
    ds_read_b64_tr_b16 a[46:47], v6 offset:50176
    v_mfma_f32_16x16x32_bf16 v[80:83], a[68:71], a[128:131], v[80:83]
    ds_read_b64_tr_b16 a[20:21], v7 offset:32768
    v_mfma_f32_16x16x32_bf16 v[84:87], a[68:71], a[132:135], v[84:87]
    ds_read_b64_tr_b16 a[22:23], v7 offset:33792
    v_mfma_f32_16x16x32_bf16 v[88:91], a[68:71], a[136:139], v[88:91]
    ds_read_b64_tr_b16 a[48:49], v7 offset:49152
    v_mfma_f32_16x16x32_bf16 v[92:95], a[68:71], a[140:143], v[92:95]
    ds_read_b64_tr_b16 a[50:51], v7 offset:50176
    v_mfma_f32_16x16x32_bf16 v[192:195], a[96:99], a[128:131], v[192:195]
    buffer_load_dwordx4 a[124:127], v17, s[20:23], s59 offen offset:0
    v_mfma_f32_16x16x32_bf16 v[196:199], a[96:99], a[132:135], v[196:199]
    ds_read_b64_tr_b16 a[24:25], v8 offset:32768
    v_mfma_f32_16x16x32_bf16 v[200:203], a[96:99], a[136:139], v[200:203]
    ds_read_b64_tr_b16 a[26:27], v8 offset:33792
    v_mfma_f32_16x16x32_bf16 v[204:207], a[96:99], a[140:143], v[204:207]
    ds_read_b64_tr_b16 a[52:53], v8 offset:49152
    v_mfma_f32_16x16x32_bf16 v[96:99], a[72:75], a[128:131], v[96:99]
    ds_read_b64_tr_b16 a[54:55], v8 offset:50176
    v_mfma_f32_16x16x32_bf16 v[100:103], a[72:75], a[132:135], v[100:103]
    v_mfma_f32_16x16x32_bf16 v[104:107], a[72:75], a[136:139], v[104:107]
    v_mfma_f32_16x16x32_bf16 v[108:111], a[72:75], a[140:143], v[108:111]
    v_mfma_f32_16x16x32_bf16 v[208:211], a[100:103], a[128:131], v[208:211]
    s_add_u32 m0, s30, 102400
    s_add_u32 s31, s28, 114688
    buffer_load_dwordx4 v16, s[16:19], s31 offen lds
    v_mfma_f32_16x16x32_bf16 v[212:215], a[100:103], a[132:135], v[212:215]
    v_mfma_f32_16x16x32_bf16 v[216:219], a[100:103], a[136:139], v[216:219]
    s_add_u32 m0, s30, 103424
    s_add_u32 s31, s28, 143360
    buffer_load_dwordx4 v16, s[16:19], s31 offen lds
    v_mfma_f32_16x16x32_bf16 v[220:223], a[100:103], a[140:143], v[220:223]
    v_mfma_f32_16x16x32_bf16 v[112:115], a[76:79], a[128:131], v[112:115]
    s_add_u32 m0, s30, 104448
    s_add_u32 s31, s28, 172032
    buffer_load_dwordx4 v18, s[16:19], s31 offen lds
    v_mfma_f32_16x16x32_bf16 v[116:119], a[76:79], a[132:135], v[116:119]
    v_mfma_f32_16x16x32_bf16 v[120:123], a[76:79], a[136:139], v[120:123]
    s_add_u32 m0, s30, 105472
    s_add_u32 s31, s28, 200704
    buffer_load_dwordx4 v18, s[16:19], s31 offen lds
    v_mfma_f32_16x16x32_bf16 v[124:127], a[76:79], a[140:143], v[124:127]
    v_mfma_f32_16x16x32_bf16 v[224:227], a[104:107], a[128:131], v[224:227]
    s_add_u32 s28, s28, 458752
    v_mfma_f32_16x16x32_bf16 v[228:231], a[104:107], a[132:135], v[228:231]
    v_mfma_f32_16x16x32_bf16 v[232:235], a[104:107], a[136:139], v[232:235]
    v_mfma_f32_16x16x32_bf16 v[236:239], a[104:107], a[140:143], v[236:239]
    v_mfma_f32_16x16x32_bf16 v[128:131], a[80:83], a[128:131], v[128:131]
    v_mfma_f32_16x16x32_bf16 v[132:135], a[80:83], a[132:135], v[132:135]
    v_mfma_f32_16x16x32_bf16 v[136:139], a[80:83], a[136:139], v[136:139]
    v_mfma_f32_16x16x32_bf16 v[140:143], a[80:83], a[140:143], v[140:143]
    v_mfma_f32_16x16x32_bf16 v[240:243], a[108:111], a[128:131], v[240:243]
    buffer_store_dwordx4 a[180:183], v1, s[40:43], s65 offen
    v_mfma_f32_16x16x32_bf16 v[244:247], a[108:111], a[132:135], v[244:247]
    v_mfma_f32_16x16x32_bf16 v[248:251], a[108:111], a[136:139], v[248:251]
    v_mfma_f32_16x16x32_bf16 v[252:255], a[108:111], a[140:143], v[252:255]
    s_waitcnt lgkmcnt(0)
    s_waitcnt vmcnt(20)
    v_mfma_f32_16x16x32_bf16 v[32:35], a[0:3], a[144:147], v[32:35]
    v_mfma_f32_16x16x32_bf16 v[36:39], a[0:3], a[148:151], v[36:39]
    ds_read_b64_tr_b16 a[56:57], v2 offset:40960
    v_mfma_f32_16x16x32_bf16 v[40:43], a[0:3], a[152:155], v[40:43]
    ds_read_b64_tr_b16 a[58:59], v2 offset:41984
    v_mfma_f32_16x16x32_bf16 v[44:47], a[0:3], a[156:159], v[44:47]
    ds_read_b64_tr_b16 a[84:85], v2 offset:57344
    v_mfma_f32_16x16x32_bf16 v[144:147], a[28:31], a[144:147], v[144:147]
    ds_read_b64_tr_b16 a[86:87], v2 offset:58368
    v_mfma_f32_16x16x32_bf16 v[148:151], a[28:31], a[148:151], v[148:151]
    ds_read_b64_tr_b16 a[60:61], v3 offset:40960
    v_mfma_f32_16x16x32_bf16 v[152:155], a[28:31], a[152:155], v[152:155]
    ds_read_b64_tr_b16 a[62:63], v3 offset:41984
    v_mfma_f32_16x16x32_bf16 v[156:159], a[28:31], a[156:159], v[156:159]
    buffer_load_dwordx4 a[128:131], v17, s[20:23], s56 offen offset:1024
    v_mfma_f32_16x16x32_bf16 v[48:51], a[4:7], a[144:147], v[48:51]
    ds_read_b64_tr_b16 a[88:89], v3 offset:57344
    v_mfma_f32_16x16x32_bf16 v[52:55], a[4:7], a[148:151], v[52:55]
    ds_read_b64_tr_b16 a[90:91], v3 offset:58368
    v_mfma_f32_16x16x32_bf16 v[56:59], a[4:7], a[152:155], v[56:59]
    ds_read_b64_tr_b16 a[64:65], v4 offset:40960
    v_mfma_f32_16x16x32_bf16 v[60:63], a[4:7], a[156:159], v[60:63]
    ds_read_b64_tr_b16 a[66:67], v4 offset:41984
    v_mfma_f32_16x16x32_bf16 v[160:163], a[32:35], a[144:147], v[160:163]
    ds_read_b64_tr_b16 a[92:93], v4 offset:57344
    v_mfma_f32_16x16x32_bf16 v[164:167], a[32:35], a[148:151], v[164:167]
    ds_read_b64_tr_b16 a[94:95], v4 offset:58368
    v_mfma_f32_16x16x32_bf16 v[168:171], a[32:35], a[152:155], v[168:171]
    buffer_load_dwordx4 a[132:135], v17, s[20:23], s57 offen offset:1024
    v_mfma_f32_16x16x32_bf16 v[172:175], a[32:35], a[156:159], v[172:175]
    ds_read_b64_tr_b16 a[68:69], v5 offset:40960
    v_mfma_f32_16x16x32_bf16 v[64:67], a[8:11], a[144:147], v[64:67]
    ds_read_b64_tr_b16 a[70:71], v5 offset:41984
    v_mfma_f32_16x16x32_bf16 v[68:71], a[8:11], a[148:151], v[68:71]
    ds_read_b64_tr_b16 a[96:97], v5 offset:57344
    v_mfma_f32_16x16x32_bf16 v[72:75], a[8:11], a[152:155], v[72:75]
    ds_read_b64_tr_b16 a[98:99], v5 offset:58368
    v_mfma_f32_16x16x32_bf16 v[76:79], a[8:11], a[156:159], v[76:79]
    ds_read_b64_tr_b16 a[72:73], v6 offset:40960
    v_mfma_f32_16x16x32_bf16 v[176:179], a[36:39], a[144:147], v[176:179]
    ds_read_b64_tr_b16 a[74:75], v6 offset:41984
    v_mfma_f32_16x16x32_bf16 v[180:183], a[36:39], a[148:151], v[180:183]
    buffer_load_dwordx4 a[136:139], v17, s[20:23], s58 offen offset:1024
    v_mfma_f32_16x16x32_bf16 v[184:187], a[36:39], a[152:155], v[184:187]
    ds_read_b64_tr_b16 a[100:101], v6 offset:57344
    v_mfma_f32_16x16x32_bf16 v[188:191], a[36:39], a[156:159], v[188:191]
    ds_read_b64_tr_b16 a[102:103], v6 offset:58368
    v_mfma_f32_16x16x32_bf16 v[80:83], a[12:15], a[144:147], v[80:83]
    ds_read_b64_tr_b16 a[76:77], v7 offset:40960
    v_mfma_f32_16x16x32_bf16 v[84:87], a[12:15], a[148:151], v[84:87]
    ds_read_b64_tr_b16 a[78:79], v7 offset:41984
    v_mfma_f32_16x16x32_bf16 v[88:91], a[12:15], a[152:155], v[88:91]
    ds_read_b64_tr_b16 a[104:105], v7 offset:57344
    v_mfma_f32_16x16x32_bf16 v[92:95], a[12:15], a[156:159], v[92:95]
    ds_read_b64_tr_b16 a[106:107], v7 offset:58368
    v_mfma_f32_16x16x32_bf16 v[192:195], a[40:43], a[144:147], v[192:195]
    buffer_load_dwordx4 a[140:143], v17, s[20:23], s59 offen offset:1024
    v_mfma_f32_16x16x32_bf16 v[196:199], a[40:43], a[148:151], v[196:199]
    ds_read_b64_tr_b16 a[80:81], v8 offset:40960
    v_mfma_f32_16x16x32_bf16 v[200:203], a[40:43], a[152:155], v[200:203]
    ds_read_b64_tr_b16 a[82:83], v8 offset:41984
    v_mfma_f32_16x16x32_bf16 v[204:207], a[40:43], a[156:159], v[204:207]
    ds_read_b64_tr_b16 a[108:109], v8 offset:57344
    v_mfma_f32_16x16x32_bf16 v[96:99], a[16:19], a[144:147], v[96:99]
    ds_read_b64_tr_b16 a[110:111], v8 offset:58368
    v_mfma_f32_16x16x32_bf16 v[100:103], a[16:19], a[148:151], v[100:103]
    v_mfma_f32_16x16x32_bf16 v[104:107], a[16:19], a[152:155], v[104:107]
    v_mfma_f32_16x16x32_bf16 v[108:111], a[16:19], a[156:159], v[108:111]
    s_add_u32 s56, s56, 2048
    s_add_u32 s57, s57, 2048
    s_add_u32 s58, s58, 2048
    s_add_u32 s59, s59, 2048
    v_mfma_f32_16x16x32_bf16 v[208:211], a[44:47], a[144:147], v[208:211]
    v_mfma_f32_16x16x32_bf16 v[212:215], a[44:47], a[148:151], v[212:215]
    v_mfma_f32_16x16x32_bf16 v[216:219], a[44:47], a[152:155], v[216:219]
    v_mfma_f32_16x16x32_bf16 v[220:223], a[44:47], a[156:159], v[220:223]
    v_mfma_f32_16x16x32_bf16 v[112:115], a[20:23], a[144:147], v[112:115]
    v_mfma_f32_16x16x32_bf16 v[116:119], a[20:23], a[148:151], v[116:119]
    v_mfma_f32_16x16x32_bf16 v[120:123], a[20:23], a[152:155], v[120:123]
    v_mfma_f32_16x16x32_bf16 v[124:127], a[20:23], a[156:159], v[124:127]
    v_mfma_f32_16x16x32_bf16 v[224:227], a[48:51], a[144:147], v[224:227]
    v_mfma_f32_16x16x32_bf16 v[228:231], a[48:51], a[148:151], v[228:231]
    v_mfma_f32_16x16x32_bf16 v[232:235], a[48:51], a[152:155], v[232:235]
    v_mfma_f32_16x16x32_bf16 v[236:239], a[48:51], a[156:159], v[236:239]
    v_mfma_f32_16x16x32_bf16 v[128:131], a[24:27], a[144:147], v[128:131]
    v_mfma_f32_16x16x32_bf16 v[132:135], a[24:27], a[148:151], v[132:135]
    v_mfma_f32_16x16x32_bf16 v[136:139], a[24:27], a[152:155], v[136:139]
    v_mfma_f32_16x16x32_bf16 v[140:143], a[24:27], a[156:159], v[140:143]
    v_mfma_f32_16x16x32_bf16 v[240:243], a[52:55], a[144:147], v[240:243]
    buffer_store_dwordx4 a[184:187], v1, s[40:43], s66 offen
    v_mfma_f32_16x16x32_bf16 v[244:247], a[52:55], a[148:151], v[244:247]
    v_mfma_f32_16x16x32_bf16 v[248:251], a[52:55], a[152:155], v[248:251]
    v_mfma_f32_16x16x32_bf16 v[252:255], a[52:55], a[156:159], v[252:255]
    s_waitcnt lgkmcnt(0)
    s_waitcnt vmcnt(16)
    v_mfma_f32_16x16x32_bf16 v[32:35], a[56:59], a[160:163], v[32:35]
    s_waitcnt vmcnt(20)
    s_barrier
    v_mfma_f32_16x16x32_bf16 v[36:39], a[56:59], a[164:167], v[36:39]
    ds_read_b64_tr_b16 a[0:1], v9 offset:0
    v_mfma_f32_16x16x32_bf16 v[40:43], a[56:59], a[168:171], v[40:43]
    ds_read_b64_tr_b16 a[2:3], v9 offset:1024
    v_mfma_f32_16x16x32_bf16 v[44:47], a[56:59], a[172:175], v[44:47]
    ds_read_b64_tr_b16 a[28:29], v9 offset:16384
    v_mfma_f32_16x16x32_bf16 v[144:147], a[84:87], a[160:163], v[144:147]
    ds_read_b64_tr_b16 a[30:31], v9 offset:17408
    v_mfma_f32_16x16x32_bf16 v[148:151], a[84:87], a[164:167], v[148:151]
    ds_read_b64_tr_b16 a[4:5], v10 offset:0
    v_mfma_f32_16x16x32_bf16 v[152:155], a[84:87], a[168:171], v[152:155]
    ds_read_b64_tr_b16 a[6:7], v10 offset:1024
    v_mfma_f32_16x16x32_bf16 v[156:159], a[84:87], a[172:175], v[156:159]
    buffer_load_dwordx4 a[144:147], v17, s[20:23], s56 offen offset:0
    v_mfma_f32_16x16x32_bf16 v[48:51], a[60:63], a[160:163], v[48:51]
    ds_read_b64_tr_b16 a[32:33], v10 offset:16384
    v_mfma_f32_16x16x32_bf16 v[52:55], a[60:63], a[164:167], v[52:55]
    ds_read_b64_tr_b16 a[34:35], v10 offset:17408
    v_mfma_f32_16x16x32_bf16 v[56:59], a[60:63], a[168:171], v[56:59]
    ds_read_b64_tr_b16 a[8:9], v11 offset:0
    v_mfma_f32_16x16x32_bf16 v[60:63], a[60:63], a[172:175], v[60:63]
    ds_read_b64_tr_b16 a[10:11], v11 offset:1024
    v_mfma_f32_16x16x32_bf16 v[160:163], a[88:91], a[160:163], v[160:163]
    ds_read_b64_tr_b16 a[36:37], v11 offset:16384
    v_mfma_f32_16x16x32_bf16 v[164:167], a[88:91], a[164:167], v[164:167]
    ds_read_b64_tr_b16 a[38:39], v11 offset:17408
    v_mfma_f32_16x16x32_bf16 v[168:171], a[88:91], a[168:171], v[168:171]
    buffer_load_dwordx4 a[148:151], v17, s[20:23], s57 offen offset:0
    v_mfma_f32_16x16x32_bf16 v[172:175], a[88:91], a[172:175], v[172:175]
    ds_read_b64_tr_b16 a[12:13], v12 offset:0
    v_mfma_f32_16x16x32_bf16 v[64:67], a[64:67], a[160:163], v[64:67]
    ds_read_b64_tr_b16 a[14:15], v12 offset:1024
    v_mfma_f32_16x16x32_bf16 v[68:71], a[64:67], a[164:167], v[68:71]
    ds_read_b64_tr_b16 a[40:41], v12 offset:16384
    v_mfma_f32_16x16x32_bf16 v[72:75], a[64:67], a[168:171], v[72:75]
    ds_read_b64_tr_b16 a[42:43], v12 offset:17408
    v_mfma_f32_16x16x32_bf16 v[76:79], a[64:67], a[172:175], v[76:79]
    ds_read_b64_tr_b16 a[16:17], v13 offset:0
    v_mfma_f32_16x16x32_bf16 v[176:179], a[92:95], a[160:163], v[176:179]
    ds_read_b64_tr_b16 a[18:19], v13 offset:1024
    v_mfma_f32_16x16x32_bf16 v[180:183], a[92:95], a[164:167], v[180:183]
    buffer_load_dwordx4 a[152:155], v17, s[20:23], s58 offen offset:0
    v_mfma_f32_16x16x32_bf16 v[184:187], a[92:95], a[168:171], v[184:187]
    ds_read_b64_tr_b16 a[44:45], v13 offset:16384
    v_mfma_f32_16x16x32_bf16 v[188:191], a[92:95], a[172:175], v[188:191]
    ds_read_b64_tr_b16 a[46:47], v13 offset:17408
    v_mfma_f32_16x16x32_bf16 v[80:83], a[68:71], a[160:163], v[80:83]
    ds_read_b64_tr_b16 a[20:21], v14 offset:0
    v_mfma_f32_16x16x32_bf16 v[84:87], a[68:71], a[164:167], v[84:87]
    ds_read_b64_tr_b16 a[22:23], v14 offset:1024
    v_mfma_f32_16x16x32_bf16 v[88:91], a[68:71], a[168:171], v[88:91]
    ds_read_b64_tr_b16 a[48:49], v14 offset:16384
    v_mfma_f32_16x16x32_bf16 v[92:95], a[68:71], a[172:175], v[92:95]
    ds_read_b64_tr_b16 a[50:51], v14 offset:17408
    v_mfma_f32_16x16x32_bf16 v[192:195], a[96:99], a[160:163], v[192:195]
    buffer_load_dwordx4 a[156:159], v17, s[20:23], s59 offen offset:0
    v_mfma_f32_16x16x32_bf16 v[196:199], a[96:99], a[164:167], v[196:199]
    ds_read_b64_tr_b16 a[24:25], v15 offset:0
    v_mfma_f32_16x16x32_bf16 v[200:203], a[96:99], a[168:171], v[200:203]
    ds_read_b64_tr_b16 a[26:27], v15 offset:1024
    v_mfma_f32_16x16x32_bf16 v[204:207], a[96:99], a[172:175], v[204:207]
    ds_read_b64_tr_b16 a[52:53], v15 offset:16384
    v_mfma_f32_16x16x32_bf16 v[96:99], a[72:75], a[160:163], v[96:99]
    ds_read_b64_tr_b16 a[54:55], v15 offset:17408
    v_mfma_f32_16x16x32_bf16 v[100:103], a[72:75], a[164:167], v[100:103]
    v_mfma_f32_16x16x32_bf16 v[104:107], a[72:75], a[168:171], v[104:107]
    v_mfma_f32_16x16x32_bf16 v[108:111], a[72:75], a[172:175], v[108:111]
    v_mfma_f32_16x16x32_bf16 v[208:211], a[100:103], a[160:163], v[208:211]
    v_mfma_f32_16x16x32_bf16 v[212:215], a[100:103], a[164:167], v[212:215]
    v_mfma_f32_16x16x32_bf16 v[216:219], a[100:103], a[168:171], v[216:219]
    v_mfma_f32_16x16x32_bf16 v[220:223], a[100:103], a[172:175], v[220:223]
    v_mfma_f32_16x16x32_bf16 v[112:115], a[76:79], a[160:163], v[112:115]
    v_mfma_f32_16x16x32_bf16 v[116:119], a[76:79], a[164:167], v[116:119]
    v_mfma_f32_16x16x32_bf16 v[120:123], a[76:79], a[168:171], v[120:123]
    v_mfma_f32_16x16x32_bf16 v[124:127], a[76:79], a[172:175], v[124:127]
    v_mfma_f32_16x16x32_bf16 v[224:227], a[104:107], a[160:163], v[224:227]
    v_mfma_f32_16x16x32_bf16 v[228:231], a[104:107], a[164:167], v[228:231]
    v_mfma_f32_16x16x32_bf16 v[232:235], a[104:107], a[168:171], v[232:235]
    v_mfma_f32_16x16x32_bf16 v[236:239], a[104:107], a[172:175], v[236:239]
    v_mfma_f32_16x16x32_bf16 v[128:131], a[80:83], a[160:163], v[128:131]
    v_mfma_f32_16x16x32_bf16 v[132:135], a[80:83], a[164:167], v[132:135]
    v_mfma_f32_16x16x32_bf16 v[136:139], a[80:83], a[168:171], v[136:139]
    v_mfma_f32_16x16x32_bf16 v[140:143], a[80:83], a[172:175], v[140:143]
    v_mfma_f32_16x16x32_bf16 v[240:243], a[108:111], a[160:163], v[240:243]
    buffer_store_dwordx4 a[188:191], v1, s[40:43], s67 offen
    v_mfma_f32_16x16x32_bf16 v[244:247], a[108:111], a[164:167], v[244:247]
    v_mfma_f32_16x16x32_bf16 v[248:251], a[108:111], a[168:171], v[248:251]
    v_mfma_f32_16x16x32_bf16 v[252:255], a[108:111], a[172:175], v[252:255]
    s_waitcnt lgkmcnt(0)
    s_waitcnt vmcnt(12)
    v_mfma_f32_16x16x32_bf16 v[32:35], a[0:3], a[112:115], v[32:35]
    v_mfma_f32_16x16x32_bf16 v[36:39], a[0:3], a[116:119], v[36:39]
    ds_read_b64_tr_b16 a[56:57], v9 offset:8192
    v_mfma_f32_16x16x32_bf16 v[40:43], a[0:3], a[120:123], v[40:43]
    ds_read_b64_tr_b16 a[58:59], v9 offset:9216
    v_mfma_f32_16x16x32_bf16 v[44:47], a[0:3], a[124:127], v[44:47]
    ds_read_b64_tr_b16 a[84:85], v9 offset:24576
    v_mfma_f32_16x16x32_bf16 v[144:147], a[28:31], a[112:115], v[144:147]
    ds_read_b64_tr_b16 a[86:87], v9 offset:25600
    v_mfma_f32_16x16x32_bf16 v[148:151], a[28:31], a[116:119], v[148:151]
    ds_read_b64_tr_b16 a[60:61], v10 offset:8192
    v_mfma_f32_16x16x32_bf16 v[152:155], a[28:31], a[120:123], v[152:155]
    ds_read_b64_tr_b16 a[62:63], v10 offset:9216
    v_mfma_f32_16x16x32_bf16 v[156:159], a[28:31], a[124:127], v[156:159]
    buffer_load_dwordx4 a[160:163], v17, s[20:23], s56 offen offset:1024
    v_mfma_f32_16x16x32_bf16 v[48:51], a[4:7], a[112:115], v[48:51]
    ds_read_b64_tr_b16 a[88:89], v10 offset:24576
    v_mfma_f32_16x16x32_bf16 v[52:55], a[4:7], a[116:119], v[52:55]
    ds_read_b64_tr_b16 a[90:91], v10 offset:25600
    v_mfma_f32_16x16x32_bf16 v[56:59], a[4:7], a[120:123], v[56:59]
    ds_read_b64_tr_b16 a[64:65], v11 offset:8192
    v_mfma_f32_16x16x32_bf16 v[60:63], a[4:7], a[124:127], v[60:63]
    ds_read_b64_tr_b16 a[66:67], v11 offset:9216
    v_mfma_f32_16x16x32_bf16 v[160:163], a[32:35], a[112:115], v[160:163]
    ds_read_b64_tr_b16 a[92:93], v11 offset:24576
    v_mfma_f32_16x16x32_bf16 v[164:167], a[32:35], a[116:119], v[164:167]
    ds_read_b64_tr_b16 a[94:95], v11 offset:25600
    v_mfma_f32_16x16x32_bf16 v[168:171], a[32:35], a[120:123], v[168:171]
    buffer_load_dwordx4 a[164:167], v17, s[20:23], s57 offen offset:1024
    v_mfma_f32_16x16x32_bf16 v[172:175], a[32:35], a[124:127], v[172:175]
    ds_read_b64_tr_b16 a[68:69], v12 offset:8192
    v_mfma_f32_16x16x32_bf16 v[64:67], a[8:11], a[112:115], v[64:67]
    ds_read_b64_tr_b16 a[70:71], v12 offset:9216
    v_mfma_f32_16x16x32_bf16 v[68:71], a[8:11], a[116:119], v[68:71]
    ds_read_b64_tr_b16 a[96:97], v12 offset:24576
    v_mfma_f32_16x16x32_bf16 v[72:75], a[8:11], a[120:123], v[72:75]
    ds_read_b64_tr_b16 a[98:99], v12 offset:25600
    v_mfma_f32_16x16x32_bf16 v[76:79], a[8:11], a[124:127], v[76:79]
    ds_read_b64_tr_b16 a[72:73], v13 offset:8192
    v_mfma_f32_16x16x32_bf16 v[176:179], a[36:39], a[112:115], v[176:179]
    ds_read_b64_tr_b16 a[74:75], v13 offset:9216
    v_mfma_f32_16x16x32_bf16 v[180:183], a[36:39], a[116:119], v[180:183]
    buffer_load_dwordx4 a[168:171], v17, s[20:23], s58 offen offset:1024
    v_mfma_f32_16x16x32_bf16 v[184:187], a[36:39], a[120:123], v[184:187]
    ds_read_b64_tr_b16 a[100:101], v13 offset:24576
    v_mfma_f32_16x16x32_bf16 v[188:191], a[36:39], a[124:127], v[188:191]
    ds_read_b64_tr_b16 a[102:103], v13 offset:25600
    v_mfma_f32_16x16x32_bf16 v[80:83], a[12:15], a[112:115], v[80:83]
    ds_read_b64_tr_b16 a[76:77], v14 offset:8192
    v_mfma_f32_16x16x32_bf16 v[84:87], a[12:15], a[116:119], v[84:87]
    ds_read_b64_tr_b16 a[78:79], v14 offset:9216
    v_mfma_f32_16x16x32_bf16 v[88:91], a[12:15], a[120:123], v[88:91]
    ds_read_b64_tr_b16 a[104:105], v14 offset:24576
    v_mfma_f32_16x16x32_bf16 v[92:95], a[12:15], a[124:127], v[92:95]
    ds_read_b64_tr_b16 a[106:107], v14 offset:25600
    v_mfma_f32_16x16x32_bf16 v[192:195], a[40:43], a[112:115], v[192:195]
    buffer_load_dwordx4 a[172:175], v17, s[20:23], s59 offen offset:1024
    v_mfma_f32_16x16x32_bf16 v[196:199], a[40:43], a[116:119], v[196:199]
    ds_read_b64_tr_b16 a[80:81], v15 offset:8192
    v_mfma_f32_16x16x32_bf16 v[200:203], a[40:43], a[120:123], v[200:203]
    ds_read_b64_tr_b16 a[82:83], v15 offset:9216
    v_mfma_f32_16x16x32_bf16 v[204:207], a[40:43], a[124:127], v[204:207]
    ds_read_b64_tr_b16 a[108:109], v15 offset:24576
    v_mfma_f32_16x16x32_bf16 v[96:99], a[16:19], a[112:115], v[96:99]
    ds_read_b64_tr_b16 a[110:111], v15 offset:25600
    v_mfma_f32_16x16x32_bf16 v[100:103], a[16:19], a[116:119], v[100:103]
    v_mfma_f32_16x16x32_bf16 v[104:107], a[16:19], a[120:123], v[104:107]
    v_mfma_f32_16x16x32_bf16 v[108:111], a[16:19], a[124:127], v[108:111]
    s_add_u32 s56, s56, 2048
    s_add_u32 s57, s57, 2048
    s_add_u32 s58, s58, 2048
    s_add_u32 s59, s59, 2048
    v_mfma_f32_16x16x32_bf16 v[208:211], a[44:47], a[112:115], v[208:211]
    v_mfma_f32_16x16x32_bf16 v[212:215], a[44:47], a[116:119], v[212:215]
    v_mfma_f32_16x16x32_bf16 v[216:219], a[44:47], a[120:123], v[216:219]
    v_mfma_f32_16x16x32_bf16 v[220:223], a[44:47], a[124:127], v[220:223]
    v_mfma_f32_16x16x32_bf16 v[112:115], a[20:23], a[112:115], v[112:115]
    v_mfma_f32_16x16x32_bf16 v[116:119], a[20:23], a[116:119], v[116:119]
    v_mfma_f32_16x16x32_bf16 v[120:123], a[20:23], a[120:123], v[120:123]
    v_mfma_f32_16x16x32_bf16 v[124:127], a[20:23], a[124:127], v[124:127]
    v_mfma_f32_16x16x32_bf16 v[224:227], a[48:51], a[112:115], v[224:227]
    v_mfma_f32_16x16x32_bf16 v[228:231], a[48:51], a[116:119], v[228:231]
    v_mfma_f32_16x16x32_bf16 v[232:235], a[48:51], a[120:123], v[232:235]
    v_mfma_f32_16x16x32_bf16 v[236:239], a[48:51], a[124:127], v[236:239]
    v_mfma_f32_16x16x32_bf16 v[128:131], a[24:27], a[112:115], v[128:131]
    v_mfma_f32_16x16x32_bf16 v[132:135], a[24:27], a[116:119], v[132:135]
    v_mfma_f32_16x16x32_bf16 v[136:139], a[24:27], a[120:123], v[136:139]
    v_mfma_f32_16x16x32_bf16 v[140:143], a[24:27], a[124:127], v[140:143]
    v_mfma_f32_16x16x32_bf16 v[240:243], a[52:55], a[112:115], v[240:243]
    buffer_store_dwordx4 a[192:195], v1, s[40:43], s68 offen
    v_mfma_f32_16x16x32_bf16 v[244:247], a[52:55], a[116:119], v[244:247]
    v_mfma_f32_16x16x32_bf16 v[248:251], a[52:55], a[120:123], v[248:251]
    v_mfma_f32_16x16x32_bf16 v[252:255], a[52:55], a[124:127], v[252:255]
    s_waitcnt lgkmcnt(0)
    s_waitcnt vmcnt(8)
    v_mfma_f32_16x16x32_bf16 v[32:35], a[56:59], a[128:131], v[32:35]
    s_waitcnt vmcnt(12)
    s_barrier
    v_mfma_f32_16x16x32_bf16 v[36:39], a[56:59], a[132:135], v[36:39]
    ds_read_b64_tr_b16 a[0:1], v9 offset:32768
    v_mfma_f32_16x16x32_bf16 v[40:43], a[56:59], a[136:139], v[40:43]
    ds_read_b64_tr_b16 a[2:3], v9 offset:33792
    v_mfma_f32_16x16x32_bf16 v[44:47], a[56:59], a[140:143], v[44:47]
    ds_read_b64_tr_b16 a[28:29], v9 offset:49152
    v_mfma_f32_16x16x32_bf16 v[144:147], a[84:87], a[128:131], v[144:147]
    ds_read_b64_tr_b16 a[30:31], v9 offset:50176
    v_mfma_f32_16x16x32_bf16 v[148:151], a[84:87], a[132:135], v[148:151]
    ds_read_b64_tr_b16 a[4:5], v10 offset:32768
    v_mfma_f32_16x16x32_bf16 v[152:155], a[84:87], a[136:139], v[152:155]
    ds_read_b64_tr_b16 a[6:7], v10 offset:33792
    v_mfma_f32_16x16x32_bf16 v[156:159], a[84:87], a[140:143], v[156:159]
    v_mfma_f32_16x16x32_bf16 v[48:51], a[60:63], a[128:131], v[48:51]
    ds_read_b64_tr_b16 a[32:33], v10 offset:49152
    v_mfma_f32_16x16x32_bf16 v[52:55], a[60:63], a[132:135], v[52:55]
    ds_read_b64_tr_b16 a[34:35], v10 offset:50176
    v_mfma_f32_16x16x32_bf16 v[56:59], a[60:63], a[136:139], v[56:59]
    ds_read_b64_tr_b16 a[8:9], v11 offset:32768
    v_mfma_f32_16x16x32_bf16 v[60:63], a[60:63], a[140:143], v[60:63]
    ds_read_b64_tr_b16 a[10:11], v11 offset:33792
    v_mfma_f32_16x16x32_bf16 v[160:163], a[88:91], a[128:131], v[160:163]
    ds_read_b64_tr_b16 a[36:37], v11 offset:49152
    v_mfma_f32_16x16x32_bf16 v[164:167], a[88:91], a[132:135], v[164:167]
    ds_read_b64_tr_b16 a[38:39], v11 offset:50176
    v_mfma_f32_16x16x32_bf16 v[168:171], a[88:91], a[136:139], v[168:171]
    v_mfma_f32_16x16x32_bf16 v[172:175], a[88:91], a[140:143], v[172:175]
    ds_read_b64_tr_b16 a[12:13], v12 offset:32768
    v_mfma_f32_16x16x32_bf16 v[64:67], a[64:67], a[128:131], v[64:67]
    ds_read_b64_tr_b16 a[14:15], v12 offset:33792
    v_mfma_f32_16x16x32_bf16 v[68:71], a[64:67], a[132:135], v[68:71]
    ds_read_b64_tr_b16 a[40:41], v12 offset:49152
    v_mfma_f32_16x16x32_bf16 v[72:75], a[64:67], a[136:139], v[72:75]
    ds_read_b64_tr_b16 a[42:43], v12 offset:50176
    v_mfma_f32_16x16x32_bf16 v[76:79], a[64:67], a[140:143], v[76:79]
    ds_read_b64_tr_b16 a[16:17], v13 offset:32768
    v_mfma_f32_16x16x32_bf16 v[176:179], a[92:95], a[128:131], v[176:179]
    ds_read_b64_tr_b16 a[18:19], v13 offset:33792
    v_mfma_f32_16x16x32_bf16 v[180:183], a[92:95], a[132:135], v[180:183]
    v_mfma_f32_16x16x32_bf16 v[184:187], a[92:95], a[136:139], v[184:187]
    ds_read_b64_tr_b16 a[44:45], v13 offset:49152
    v_mfma_f32_16x16x32_bf16 v[188:191], a[92:95], a[140:143], v[188:191]
    ds_read_b64_tr_b16 a[46:47], v13 offset:50176
    v_mfma_f32_16x16x32_bf16 v[80:83], a[68:71], a[128:131], v[80:83]
    ds_read_b64_tr_b16 a[20:21], v14 offset:32768
    v_mfma_f32_16x16x32_bf16 v[84:87], a[68:71], a[132:135], v[84:87]
    ds_read_b64_tr_b16 a[22:23], v14 offset:33792
    v_mfma_f32_16x16x32_bf16 v[88:91], a[68:71], a[136:139], v[88:91]
    ds_read_b64_tr_b16 a[48:49], v14 offset:49152
    v_mfma_f32_16x16x32_bf16 v[92:95], a[68:71], a[140:143], v[92:95]
    ds_read_b64_tr_b16 a[50:51], v14 offset:50176
    v_mfma_f32_16x16x32_bf16 v[192:195], a[96:99], a[128:131], v[192:195]
    v_mfma_f32_16x16x32_bf16 v[196:199], a[96:99], a[132:135], v[196:199]
    ds_read_b64_tr_b16 a[24:25], v15 offset:32768
    v_mfma_f32_16x16x32_bf16 v[200:203], a[96:99], a[136:139], v[200:203]
    ds_read_b64_tr_b16 a[26:27], v15 offset:33792
    v_mfma_f32_16x16x32_bf16 v[204:207], a[96:99], a[140:143], v[204:207]
    ds_read_b64_tr_b16 a[52:53], v15 offset:49152
    v_mfma_f32_16x16x32_bf16 v[96:99], a[72:75], a[128:131], v[96:99]
    ds_read_b64_tr_b16 a[54:55], v15 offset:50176
    v_mfma_f32_16x16x32_bf16 v[100:103], a[72:75], a[132:135], v[100:103]
    v_mfma_f32_16x16x32_bf16 v[104:107], a[72:75], a[136:139], v[104:107]
    v_mfma_f32_16x16x32_bf16 v[108:111], a[72:75], a[140:143], v[108:111]
    v_mfma_f32_16x16x32_bf16 v[208:211], a[100:103], a[128:131], v[208:211]
    v_mfma_f32_16x16x32_bf16 v[212:215], a[100:103], a[132:135], v[212:215]
    v_mfma_f32_16x16x32_bf16 v[216:219], a[100:103], a[136:139], v[216:219]
    v_mfma_f32_16x16x32_bf16 v[220:223], a[100:103], a[140:143], v[220:223]
    v_mfma_f32_16x16x32_bf16 v[112:115], a[76:79], a[128:131], v[112:115]
    v_mfma_f32_16x16x32_bf16 v[116:119], a[76:79], a[132:135], v[116:119]
    v_mfma_f32_16x16x32_bf16 v[120:123], a[76:79], a[136:139], v[120:123]
    v_mfma_f32_16x16x32_bf16 v[124:127], a[76:79], a[140:143], v[124:127]
    v_mfma_f32_16x16x32_bf16 v[224:227], a[104:107], a[128:131], v[224:227]
    v_mfma_f32_16x16x32_bf16 v[228:231], a[104:107], a[132:135], v[228:231]
    v_mfma_f32_16x16x32_bf16 v[232:235], a[104:107], a[136:139], v[232:235]
    v_mfma_f32_16x16x32_bf16 v[236:239], a[104:107], a[140:143], v[236:239]
    v_mfma_f32_16x16x32_bf16 v[128:131], a[80:83], a[128:131], v[128:131]
    v_mfma_f32_16x16x32_bf16 v[132:135], a[80:83], a[132:135], v[132:135]
    v_mfma_f32_16x16x32_bf16 v[136:139], a[80:83], a[136:139], v[136:139]
    v_mfma_f32_16x16x32_bf16 v[140:143], a[80:83], a[140:143], v[140:143]
    v_mfma_f32_16x16x32_bf16 v[240:243], a[108:111], a[128:131], v[240:243]
    buffer_store_dwordx4 a[196:199], v1, s[40:43], s69 offen
    v_mfma_f32_16x16x32_bf16 v[244:247], a[108:111], a[132:135], v[244:247]
    v_mfma_f32_16x16x32_bf16 v[248:251], a[108:111], a[136:139], v[248:251]
    v_mfma_f32_16x16x32_bf16 v[252:255], a[108:111], a[140:143], v[252:255]
    s_waitcnt lgkmcnt(0)
    s_waitcnt vmcnt(4)
    v_mfma_f32_16x16x32_bf16 v[32:35], a[0:3], a[144:147], v[32:35]
    v_mfma_f32_16x16x32_bf16 v[36:39], a[0:3], a[148:151], v[36:39]
    ds_read_b64_tr_b16 a[56:57], v9 offset:40960
    v_mfma_f32_16x16x32_bf16 v[40:43], a[0:3], a[152:155], v[40:43]
    ds_read_b64_tr_b16 a[58:59], v9 offset:41984
    v_mfma_f32_16x16x32_bf16 v[44:47], a[0:3], a[156:159], v[44:47]
    ds_read_b64_tr_b16 a[84:85], v9 offset:57344
    v_mfma_f32_16x16x32_bf16 v[144:147], a[28:31], a[144:147], v[144:147]
    ds_read_b64_tr_b16 a[86:87], v9 offset:58368
    v_mfma_f32_16x16x32_bf16 v[148:151], a[28:31], a[148:151], v[148:151]
    ds_read_b64_tr_b16 a[60:61], v10 offset:40960
    v_mfma_f32_16x16x32_bf16 v[152:155], a[28:31], a[152:155], v[152:155]
    ds_read_b64_tr_b16 a[62:63], v10 offset:41984
    v_mfma_f32_16x16x32_bf16 v[156:159], a[28:31], a[156:159], v[156:159]
    s_add_u32 s56, s56, 2048
    s_add_u32 s57, s57, 2048
    s_add_u32 s58, s58, 2048
    s_add_u32 s59, s59, 2048
    v_mfma_f32_16x16x32_bf16 v[48:51], a[4:7], a[144:147], v[48:51]
    ds_read_b64_tr_b16 a[88:89], v10 offset:57344
    v_mfma_f32_16x16x32_bf16 v[52:55], a[4:7], a[148:151], v[52:55]
    ds_read_b64_tr_b16 a[90:91], v10 offset:58368
    v_mfma_f32_16x16x32_bf16 v[56:59], a[4:7], a[152:155], v[56:59]
    ds_read_b64_tr_b16 a[64:65], v11 offset:40960
    v_mfma_f32_16x16x32_bf16 v[60:63], a[4:7], a[156:159], v[60:63]
    ds_read_b64_tr_b16 a[66:67], v11 offset:41984
    v_mfma_f32_16x16x32_bf16 v[160:163], a[32:35], a[144:147], v[160:163]
    ds_read_b64_tr_b16 a[92:93], v11 offset:57344
    v_mfma_f32_16x16x32_bf16 v[164:167], a[32:35], a[148:151], v[164:167]
    ds_read_b64_tr_b16 a[94:95], v11 offset:58368
    v_mfma_f32_16x16x32_bf16 v[168:171], a[32:35], a[152:155], v[168:171]
    v_mfma_f32_16x16x32_bf16 v[172:175], a[32:35], a[156:159], v[172:175]
    ds_read_b64_tr_b16 a[68:69], v12 offset:40960
    v_mfma_f32_16x16x32_bf16 v[64:67], a[8:11], a[144:147], v[64:67]
    ds_read_b64_tr_b16 a[70:71], v12 offset:41984
    v_mfma_f32_16x16x32_bf16 v[68:71], a[8:11], a[148:151], v[68:71]
    ds_read_b64_tr_b16 a[96:97], v12 offset:57344
    v_mfma_f32_16x16x32_bf16 v[72:75], a[8:11], a[152:155], v[72:75]
    ds_read_b64_tr_b16 a[98:99], v12 offset:58368
    v_mfma_f32_16x16x32_bf16 v[76:79], a[8:11], a[156:159], v[76:79]
    ds_read_b64_tr_b16 a[72:73], v13 offset:40960
    v_mfma_f32_16x16x32_bf16 v[176:179], a[36:39], a[144:147], v[176:179]
    ds_read_b64_tr_b16 a[74:75], v13 offset:41984
    v_mfma_f32_16x16x32_bf16 v[180:183], a[36:39], a[148:151], v[180:183]
    v_mfma_f32_16x16x32_bf16 v[184:187], a[36:39], a[152:155], v[184:187]
    ds_read_b64_tr_b16 a[100:101], v13 offset:57344
    v_mfma_f32_16x16x32_bf16 v[188:191], a[36:39], a[156:159], v[188:191]
    ds_read_b64_tr_b16 a[102:103], v13 offset:58368
    v_mfma_f32_16x16x32_bf16 v[80:83], a[12:15], a[144:147], v[80:83]
    ds_read_b64_tr_b16 a[76:77], v14 offset:40960
    v_mfma_f32_16x16x32_bf16 v[84:87], a[12:15], a[148:151], v[84:87]
    ds_read_b64_tr_b16 a[78:79], v14 offset:41984
    v_mfma_f32_16x16x32_bf16 v[88:91], a[12:15], a[152:155], v[88:91]
    ds_read_b64_tr_b16 a[104:105], v14 offset:57344
    v_mfma_f32_16x16x32_bf16 v[92:95], a[12:15], a[156:159], v[92:95]
    ds_read_b64_tr_b16 a[106:107], v14 offset:58368
    v_mfma_f32_16x16x32_bf16 v[192:195], a[40:43], a[144:147], v[192:195]
    v_mfma_f32_16x16x32_bf16 v[196:199], a[40:43], a[148:151], v[196:199]
    ds_read_b64_tr_b16 a[80:81], v15 offset:40960
    v_mfma_f32_16x16x32_bf16 v[200:203], a[40:43], a[152:155], v[200:203]
    ds_read_b64_tr_b16 a[82:83], v15 offset:41984
    v_mfma_f32_16x16x32_bf16 v[204:207], a[40:43], a[156:159], v[204:207]
    ds_read_b64_tr_b16 a[108:109], v15 offset:57344
    v_mfma_f32_16x16x32_bf16 v[96:99], a[16:19], a[144:147], v[96:99]
    ds_read_b64_tr_b16 a[110:111], v15 offset:58368
    v_mfma_f32_16x16x32_bf16 v[100:103], a[16:19], a[148:151], v[100:103]
    v_mfma_f32_16x16x32_bf16 v[104:107], a[16:19], a[152:155], v[104:107]
    v_mfma_f32_16x16x32_bf16 v[108:111], a[16:19], a[156:159], v[108:111]
    v_mfma_f32_16x16x32_bf16 v[208:211], a[44:47], a[144:147], v[208:211]
    v_mfma_f32_16x16x32_bf16 v[212:215], a[44:47], a[148:151], v[212:215]
    v_mfma_f32_16x16x32_bf16 v[216:219], a[44:47], a[152:155], v[216:219]
    v_mfma_f32_16x16x32_bf16 v[220:223], a[44:47], a[156:159], v[220:223]
    v_mfma_f32_16x16x32_bf16 v[112:115], a[20:23], a[144:147], v[112:115]
    v_mfma_f32_16x16x32_bf16 v[116:119], a[20:23], a[148:151], v[116:119]
    v_mfma_f32_16x16x32_bf16 v[120:123], a[20:23], a[152:155], v[120:123]
    v_mfma_f32_16x16x32_bf16 v[124:127], a[20:23], a[156:159], v[124:127]
    v_mfma_f32_16x16x32_bf16 v[224:227], a[48:51], a[144:147], v[224:227]
    v_mfma_f32_16x16x32_bf16 v[228:231], a[48:51], a[148:151], v[228:231]
    v_mfma_f32_16x16x32_bf16 v[232:235], a[48:51], a[152:155], v[232:235]
    v_mfma_f32_16x16x32_bf16 v[236:239], a[48:51], a[156:159], v[236:239]
    v_mfma_f32_16x16x32_bf16 v[128:131], a[24:27], a[144:147], v[128:131]
    v_mfma_f32_16x16x32_bf16 v[132:135], a[24:27], a[148:151], v[132:135]
    v_mfma_f32_16x16x32_bf16 v[136:139], a[24:27], a[152:155], v[136:139]
    v_mfma_f32_16x16x32_bf16 v[140:143], a[24:27], a[156:159], v[140:143]
    v_mfma_f32_16x16x32_bf16 v[240:243], a[52:55], a[144:147], v[240:243]
    buffer_store_dwordx4 a[200:203], v1, s[40:43], s70 offen
    v_mfma_f32_16x16x32_bf16 v[244:247], a[52:55], a[148:151], v[244:247]
    v_mfma_f32_16x16x32_bf16 v[248:251], a[52:55], a[152:155], v[248:251]
    v_mfma_f32_16x16x32_bf16 v[252:255], a[52:55], a[156:159], v[252:255]
    s_waitcnt lgkmcnt(0)
    s_waitcnt vmcnt(0)
    v_mfma_f32_16x16x32_bf16 v[32:35], a[56:59], a[160:163], v[32:35]
    v_mfma_f32_16x16x32_bf16 v[36:39], a[56:59], a[164:167], v[36:39]
    v_mfma_f32_16x16x32_bf16 v[40:43], a[56:59], a[168:171], v[40:43]
    v_mfma_f32_16x16x32_bf16 v[44:47], a[56:59], a[172:175], v[44:47]
    v_mfma_f32_16x16x32_bf16 v[144:147], a[84:87], a[160:163], v[144:147]
    v_mfma_f32_16x16x32_bf16 v[148:151], a[84:87], a[164:167], v[148:151]
    v_mfma_f32_16x16x32_bf16 v[152:155], a[84:87], a[168:171], v[152:155]
    v_mfma_f32_16x16x32_bf16 v[156:159], a[84:87], a[172:175], v[156:159]
    v_mfma_f32_16x16x32_bf16 v[48:51], a[60:63], a[160:163], v[48:51]
    v_mfma_f32_16x16x32_bf16 v[52:55], a[60:63], a[164:167], v[52:55]
    v_mfma_f32_16x16x32_bf16 v[56:59], a[60:63], a[168:171], v[56:59]
    v_mfma_f32_16x16x32_bf16 v[60:63], a[60:63], a[172:175], v[60:63]
    v_mfma_f32_16x16x32_bf16 v[160:163], a[88:91], a[160:163], v[160:163]
    v_mfma_f32_16x16x32_bf16 v[164:167], a[88:91], a[164:167], v[164:167]
    v_mfma_f32_16x16x32_bf16 v[168:171], a[88:91], a[168:171], v[168:171]
    v_mfma_f32_16x16x32_bf16 v[172:175], a[88:91], a[172:175], v[172:175]
    v_mfma_f32_16x16x32_bf16 v[64:67], a[64:67], a[160:163], v[64:67]
    v_mfma_f32_16x16x32_bf16 v[68:71], a[64:67], a[164:167], v[68:71]
    v_mfma_f32_16x16x32_bf16 v[72:75], a[64:67], a[168:171], v[72:75]
    v_mfma_f32_16x16x32_bf16 v[76:79], a[64:67], a[172:175], v[76:79]
    v_mfma_f32_16x16x32_bf16 v[176:179], a[92:95], a[160:163], v[176:179]
    v_mfma_f32_16x16x32_bf16 v[180:183], a[92:95], a[164:167], v[180:183]
    v_mfma_f32_16x16x32_bf16 v[184:187], a[92:95], a[168:171], v[184:187]
    v_mfma_f32_16x16x32_bf16 v[188:191], a[92:95], a[172:175], v[188:191]
    v_mfma_f32_16x16x32_bf16 v[80:83], a[68:71], a[160:163], v[80:83]
    v_mfma_f32_16x16x32_bf16 v[84:87], a[68:71], a[164:167], v[84:87]
    v_mfma_f32_16x16x32_bf16 v[88:91], a[68:71], a[168:171], v[88:91]
    v_mfma_f32_16x16x32_bf16 v[92:95], a[68:71], a[172:175], v[92:95]
    v_mfma_f32_16x16x32_bf16 v[192:195], a[96:99], a[160:163], v[192:195]
    v_mfma_f32_16x16x32_bf16 v[196:199], a[96:99], a[164:167], v[196:199]
    v_mfma_f32_16x16x32_bf16 v[200:203], a[96:99], a[168:171], v[200:203]
    v_mfma_f32_16x16x32_bf16 v[204:207], a[96:99], a[172:175], v[204:207]
    v_mfma_f32_16x16x32_bf16 v[96:99], a[72:75], a[160:163], v[96:99]
    v_mfma_f32_16x16x32_bf16 v[100:103], a[72:75], a[164:167], v[100:103]
    v_mfma_f32_16x16x32_bf16 v[104:107], a[72:75], a[168:171], v[104:107]
    v_mfma_f32_16x16x32_bf16 v[108:111], a[72:75], a[172:175], v[108:111]
    v_mfma_f32_16x16x32_bf16 v[208:211], a[100:103], a[160:163], v[208:211]
    v_mfma_f32_16x16x32_bf16 v[212:215], a[100:103], a[164:167], v[212:215]
    v_mfma_f32_16x16x32_bf16 v[216:219], a[100:103], a[168:171], v[216:219]
    v_mfma_f32_16x16x32_bf16 v[220:223], a[100:103], a[172:175], v[220:223]
    v_mfma_f32_16x16x32_bf16 v[112:115], a[76:79], a[160:163], v[112:115]
    v_mfma_f32_16x16x32_bf16 v[116:119], a[76:79], a[164:167], v[116:119]
    v_mfma_f32_16x16x32_bf16 v[120:123], a[76:79], a[168:171], v[120:123]
    v_mfma_f32_16x16x32_bf16 v[124:127], a[76:79], a[172:175], v[124:127]
    v_mfma_f32_16x16x32_bf16 v[224:227], a[104:107], a[160:163], v[224:227]
    v_mfma_f32_16x16x32_bf16 v[228:231], a[104:107], a[164:167], v[228:231]
    v_mfma_f32_16x16x32_bf16 v[232:235], a[104:107], a[168:171], v[232:235]
    v_mfma_f32_16x16x32_bf16 v[236:239], a[104:107], a[172:175], v[236:239]
    v_mfma_f32_16x16x32_bf16 v[128:131], a[80:83], a[160:163], v[128:131]
    v_mfma_f32_16x16x32_bf16 v[132:135], a[80:83], a[164:167], v[132:135]
    v_mfma_f32_16x16x32_bf16 v[136:139], a[80:83], a[168:171], v[136:139]
    v_mfma_f32_16x16x32_bf16 v[140:143], a[80:83], a[172:175], v[140:143]
    v_mfma_f32_16x16x32_bf16 v[240:243], a[108:111], a[160:163], v[240:243]
    v_mfma_f32_16x16x32_bf16 v[244:247], a[108:111], a[164:167], v[244:247]
    v_mfma_f32_16x16x32_bf16 v[248:251], a[108:111], a[168:171], v[248:251]
    v_mfma_f32_16x16x32_bf16 v[252:255], a[108:111], a[172:175], v[252:255]
    s_nop 9
    v_mov_b32 v16, 0xc0135761
    v_mov_b32 v17, 0xc0135761
    s_mov_b32 s44, 0xbdd2d3e8
    s_mov_b32 s45, 0xbdd2d3e8
    s_mov_b32 s46, 1.0
    s_mov_b32 s47, 1.0
    v_pk_mul_f32 v[22:23], v[32:33], v[32:33]
    v_pk_mul_f32 v[24:25], v[34:35], v[34:35]
    v_pk_mul_f32 v[26:27], v[36:37], v[36:37]
    v_pk_mul_f32 v[28:29], v[38:39], v[38:39]
    v_pk_fma_f32 v[22:23], v[22:23], s[44:45], v[16:17]
    v_pk_fma_f32 v[24:25], v[24:25], s[44:45], v[16:17]
    v_pk_fma_f32 v[26:27], v[26:27], s[44:45], v[16:17]
    v_pk_fma_f32 v[28:29], v[28:29], s[44:45], v[16:17]
    v_pk_mul_f32 v[22:23], v[22:23], v[32:33]
    v_pk_mul_f32 v[24:25], v[24:25], v[34:35]
    v_pk_mul_f32 v[26:27], v[26:27], v[36:37]
    v_pk_mul_f32 v[28:29], v[28:29], v[38:39]
    v_exp_f32 v22, v22
    v_exp_f32 v23, v23
    v_exp_f32 v24, v24
    v_exp_f32 v25, v25
    v_exp_f32 v26, v26
    v_exp_f32 v27, v27
    v_exp_f32 v28, v28
    v_exp_f32 v29, v29
    v_pk_mul_f32 v[144:145], v[144:145], v[32:33]
    v_pk_mul_f32 v[146:147], v[146:147], v[34:35]
    v_pk_mul_f32 v[148:149], v[148:149], v[36:37]
    v_pk_mul_f32 v[150:151], v[150:151], v[38:39]
    v_pk_add_f32 v[22:23], v[22:23], s[46:47]
    v_pk_add_f32 v[24:25], v[24:25], s[46:47]
    v_pk_add_f32 v[26:27], v[26:27], s[46:47]
    v_pk_add_f32 v[28:29], v[28:29], s[46:47]
    v_rcp_f32 v22, v22
    v_rcp_f32 v23, v23
    v_rcp_f32 v24, v24
    v_rcp_f32 v25, v25
    v_rcp_f32 v26, v26
    v_rcp_f32 v27, v27
    v_rcp_f32 v28, v28
    v_rcp_f32 v29, v29
    s_nop 0
    v_pk_mul_f32 v[144:145], v[144:145], v[22:23]
    v_pk_mul_f32 v[146:147], v[146:147], v[24:25]
    v_pk_mul_f32 v[148:149], v[148:149], v[26:27]
    v_pk_mul_f32 v[150:151], v[150:151], v[28:29]
    v_cvt_pk_bf16_f32 v0, v144, v145
    v_cvt_pk_bf16_f32 v1, v146, v147
    v_cvt_pk_bf16_f32 v2, v148, v149
    v_cvt_pk_bf16_f32 v3, v150, v151
    s_mov_b32 s31, 0
    s_nop 0
    v_permlane16_swap_b32 v0, v2
    v_permlane16_swap_b32 v1, v3
    buffer_store_dwordx4 v[0:3], v19, s[24:27], s31 offen sc0 sc1
    v_pk_mul_f32 v[22:23], v[40:41], v[40:41]
    v_pk_mul_f32 v[24:25], v[42:43], v[42:43]
    v_pk_mul_f32 v[26:27], v[44:45], v[44:45]
    v_pk_mul_f32 v[28:29], v[46:47], v[46:47]
    v_pk_fma_f32 v[22:23], v[22:23], s[44:45], v[16:17]
    v_pk_fma_f32 v[24:25], v[24:25], s[44:45], v[16:17]
    v_pk_fma_f32 v[26:27], v[26:27], s[44:45], v[16:17]
    v_pk_fma_f32 v[28:29], v[28:29], s[44:45], v[16:17]
    v_pk_mul_f32 v[22:23], v[22:23], v[40:41]
    v_pk_mul_f32 v[24:25], v[24:25], v[42:43]
    v_pk_mul_f32 v[26:27], v[26:27], v[44:45]
    v_pk_mul_f32 v[28:29], v[28:29], v[46:47]
    v_exp_f32 v22, v22
    v_exp_f32 v23, v23
    v_exp_f32 v24, v24
    v_exp_f32 v25, v25
    v_exp_f32 v26, v26
    v_exp_f32 v27, v27
    v_exp_f32 v28, v28
    v_exp_f32 v29, v29
    v_pk_mul_f32 v[152:153], v[152:153], v[40:41]
    v_pk_mul_f32 v[154:155], v[154:155], v[42:43]
    v_pk_mul_f32 v[156:157], v[156:157], v[44:45]
    v_pk_mul_f32 v[158:159], v[158:159], v[46:47]
    v_pk_add_f32 v[22:23], v[22:23], s[46:47]
    v_pk_add_f32 v[24:25], v[24:25], s[46:47]
    v_pk_add_f32 v[26:27], v[26:27], s[46:47]
    v_pk_add_f32 v[28:29], v[28:29], s[46:47]
    v_rcp_f32 v22, v22
    v_rcp_f32 v23, v23
    v_rcp_f32 v24, v24
    v_rcp_f32 v25, v25
    v_rcp_f32 v26, v26
    v_rcp_f32 v27, v27
    v_rcp_f32 v28, v28
    v_rcp_f32 v29, v29
    s_nop 0
    v_pk_mul_f32 v[152:153], v[152:153], v[22:23]
    v_pk_mul_f32 v[154:155], v[154:155], v[24:25]
    v_pk_mul_f32 v[156:157], v[156:157], v[26:27]
    v_pk_mul_f32 v[158:159], v[158:159], v[28:29]
    v_cvt_pk_bf16_f32 v4, v152, v153
    v_cvt_pk_bf16_f32 v5, v154, v155
    v_cvt_pk_bf16_f32 v6, v156, v157
    v_cvt_pk_bf16_f32 v7, v158, v159
    s_mov_b32 s31, 229376
    s_nop 0
    v_permlane16_swap_b32 v4, v6
    v_permlane16_swap_b32 v5, v7
    buffer_store_dwordx4 v[4:7], v19, s[24:27], s31 offen sc0 sc1
    v_pk_mul_f32 v[22:23], v[48:49], v[48:49]
    v_pk_mul_f32 v[24:25], v[50:51], v[50:51]
    v_pk_mul_f32 v[26:27], v[52:53], v[52:53]
    v_pk_mul_f32 v[28:29], v[54:55], v[54:55]
    v_pk_fma_f32 v[22:23], v[22:23], s[44:45], v[16:17]
    v_pk_fma_f32 v[24:25], v[24:25], s[44:45], v[16:17]
    v_pk_fma_f32 v[26:27], v[26:27], s[44:45], v[16:17]
    v_pk_fma_f32 v[28:29], v[28:29], s[44:45], v[16:17]
    v_pk_mul_f32 v[22:23], v[22:23], v[48:49]
    v_pk_mul_f32 v[24:25], v[24:25], v[50:51]
    v_pk_mul_f32 v[26:27], v[26:27], v[52:53]
    v_pk_mul_f32 v[28:29], v[28:29], v[54:55]
    v_exp_f32 v22, v22
    v_exp_f32 v23, v23
    v_exp_f32 v24, v24
    v_exp_f32 v25, v25
    v_exp_f32 v26, v26
    v_exp_f32 v27, v27
    v_exp_f32 v28, v28
    v_exp_f32 v29, v29
    v_pk_mul_f32 v[160:161], v[160:161], v[48:49]
    v_pk_mul_f32 v[162:163], v[162:163], v[50:51]
    v_pk_mul_f32 v[164:165], v[164:165], v[52:53]
    v_pk_mul_f32 v[166:167], v[166:167], v[54:55]
    v_pk_add_f32 v[22:23], v[22:23], s[46:47]
    v_pk_add_f32 v[24:25], v[24:25], s[46:47]
    v_pk_add_f32 v[26:27], v[26:27], s[46:47]
    v_pk_add_f32 v[28:29], v[28:29], s[46:47]
    v_rcp_f32 v22, v22
    v_rcp_f32 v23, v23
    v_rcp_f32 v24, v24
    v_rcp_f32 v25, v25
    v_rcp_f32 v26, v26
    v_rcp_f32 v27, v27
    v_rcp_f32 v28, v28
    v_rcp_f32 v29, v29
    s_nop 0
    v_pk_mul_f32 v[160:161], v[160:161], v[22:23]
    v_pk_mul_f32 v[162:163], v[162:163], v[24:25]
    v_pk_mul_f32 v[164:165], v[164:165], v[26:27]
    v_pk_mul_f32 v[166:167], v[166:167], v[28:29]
    v_cvt_pk_bf16_f32 v0, v160, v161
    v_cvt_pk_bf16_f32 v1, v162, v163
    v_cvt_pk_bf16_f32 v2, v164, v165
    v_cvt_pk_bf16_f32 v3, v166, v167
    s_mov_b32 s31, 1024
    s_nop 0
    v_permlane16_swap_b32 v0, v2
    v_permlane16_swap_b32 v1, v3
    buffer_store_dwordx4 v[0:3], v19, s[24:27], s31 offen sc0 sc1
    v_pk_mul_f32 v[22:23], v[56:57], v[56:57]
    v_pk_mul_f32 v[24:25], v[58:59], v[58:59]
    v_pk_mul_f32 v[26:27], v[60:61], v[60:61]
    v_pk_mul_f32 v[28:29], v[62:63], v[62:63]
    v_pk_fma_f32 v[22:23], v[22:23], s[44:45], v[16:17]
    v_pk_fma_f32 v[24:25], v[24:25], s[44:45], v[16:17]
    v_pk_fma_f32 v[26:27], v[26:27], s[44:45], v[16:17]
    v_pk_fma_f32 v[28:29], v[28:29], s[44:45], v[16:17]
    v_pk_mul_f32 v[22:23], v[22:23], v[56:57]
    v_pk_mul_f32 v[24:25], v[24:25], v[58:59]
    v_pk_mul_f32 v[26:27], v[26:27], v[60:61]
    v_pk_mul_f32 v[28:29], v[28:29], v[62:63]
    v_exp_f32 v22, v22
    v_exp_f32 v23, v23
    v_exp_f32 v24, v24
    v_exp_f32 v25, v25
    v_exp_f32 v26, v26
    v_exp_f32 v27, v27
    v_exp_f32 v28, v28
    v_exp_f32 v29, v29
    v_pk_mul_f32 v[168:169], v[168:169], v[56:57]
    v_pk_mul_f32 v[170:171], v[170:171], v[58:59]
    v_pk_mul_f32 v[172:173], v[172:173], v[60:61]
    v_pk_mul_f32 v[174:175], v[174:175], v[62:63]
    v_pk_add_f32 v[22:23], v[22:23], s[46:47]
    v_pk_add_f32 v[24:25], v[24:25], s[46:47]
    v_pk_add_f32 v[26:27], v[26:27], s[46:47]
    v_pk_add_f32 v[28:29], v[28:29], s[46:47]
    v_rcp_f32 v22, v22
    v_rcp_f32 v23, v23
    v_rcp_f32 v24, v24
    v_rcp_f32 v25, v25
    v_rcp_f32 v26, v26
    v_rcp_f32 v27, v27
    v_rcp_f32 v28, v28
    v_rcp_f32 v29, v29
    s_nop 0
    v_pk_mul_f32 v[168:169], v[168:169], v[22:23]
    v_pk_mul_f32 v[170:171], v[170:171], v[24:25]
    v_pk_mul_f32 v[172:173], v[172:173], v[26:27]
    v_pk_mul_f32 v[174:175], v[174:175], v[28:29]
    v_cvt_pk_bf16_f32 v4, v168, v169
    v_cvt_pk_bf16_f32 v5, v170, v171
    v_cvt_pk_bf16_f32 v6, v172, v173
    v_cvt_pk_bf16_f32 v7, v174, v175
    s_mov_b32 s31, 230400
    s_nop 0
    v_permlane16_swap_b32 v4, v6
    v_permlane16_swap_b32 v5, v7
    buffer_store_dwordx4 v[4:7], v19, s[24:27], s31 offen sc0 sc1
    v_pk_mul_f32 v[22:23], v[64:65], v[64:65]
    v_pk_mul_f32 v[24:25], v[66:67], v[66:67]
    v_pk_mul_f32 v[26:27], v[68:69], v[68:69]
    v_pk_mul_f32 v[28:29], v[70:71], v[70:71]
    v_pk_fma_f32 v[22:23], v[22:23], s[44:45], v[16:17]
    v_pk_fma_f32 v[24:25], v[24:25], s[44:45], v[16:17]
    v_pk_fma_f32 v[26:27], v[26:27], s[44:45], v[16:17]
    v_pk_fma_f32 v[28:29], v[28:29], s[44:45], v[16:17]
    v_pk_mul_f32 v[22:23], v[22:23], v[64:65]
    v_pk_mul_f32 v[24:25], v[24:25], v[66:67]
    v_pk_mul_f32 v[26:27], v[26:27], v[68:69]
    v_pk_mul_f32 v[28:29], v[28:29], v[70:71]
    v_exp_f32 v22, v22
    v_exp_f32 v23, v23
    v_exp_f32 v24, v24
    v_exp_f32 v25, v25
    v_exp_f32 v26, v26
    v_exp_f32 v27, v27
    v_exp_f32 v28, v28
    v_exp_f32 v29, v29
    v_pk_mul_f32 v[176:177], v[176:177], v[64:65]
    v_pk_mul_f32 v[178:179], v[178:179], v[66:67]
    v_pk_mul_f32 v[180:181], v[180:181], v[68:69]
    v_pk_mul_f32 v[182:183], v[182:183], v[70:71]
    v_pk_add_f32 v[22:23], v[22:23], s[46:47]
    v_pk_add_f32 v[24:25], v[24:25], s[46:47]
    v_pk_add_f32 v[26:27], v[26:27], s[46:47]
    v_pk_add_f32 v[28:29], v[28:29], s[46:47]
    v_rcp_f32 v22, v22
    v_rcp_f32 v23, v23
    v_rcp_f32 v24, v24
    v_rcp_f32 v25, v25
    v_rcp_f32 v26, v26
    v_rcp_f32 v27, v27
    v_rcp_f32 v28, v28
    v_rcp_f32 v29, v29
    s_nop 0
    v_pk_mul_f32 v[176:177], v[176:177], v[22:23]
    v_pk_mul_f32 v[178:179], v[178:179], v[24:25]
    v_pk_mul_f32 v[180:181], v[180:181], v[26:27]
    v_pk_mul_f32 v[182:183], v[182:183], v[28:29]
    v_cvt_pk_bf16_f32 v0, v176, v177
    v_cvt_pk_bf16_f32 v1, v178, v179
    v_cvt_pk_bf16_f32 v2, v180, v181
    v_cvt_pk_bf16_f32 v3, v182, v183
    s_mov_b32 s31, 2048
    s_nop 0
    v_permlane16_swap_b32 v0, v2
    v_permlane16_swap_b32 v1, v3
    buffer_store_dwordx4 v[0:3], v19, s[24:27], s31 offen sc0 sc1
    v_pk_mul_f32 v[22:23], v[72:73], v[72:73]
    v_pk_mul_f32 v[24:25], v[74:75], v[74:75]
    v_pk_mul_f32 v[26:27], v[76:77], v[76:77]
    v_pk_mul_f32 v[28:29], v[78:79], v[78:79]
    v_pk_fma_f32 v[22:23], v[22:23], s[44:45], v[16:17]
    v_pk_fma_f32 v[24:25], v[24:25], s[44:45], v[16:17]
    v_pk_fma_f32 v[26:27], v[26:27], s[44:45], v[16:17]
    v_pk_fma_f32 v[28:29], v[28:29], s[44:45], v[16:17]
    v_pk_mul_f32 v[22:23], v[22:23], v[72:73]
    v_pk_mul_f32 v[24:25], v[24:25], v[74:75]
    v_pk_mul_f32 v[26:27], v[26:27], v[76:77]
    v_pk_mul_f32 v[28:29], v[28:29], v[78:79]
    v_exp_f32 v22, v22
    v_exp_f32 v23, v23
    v_exp_f32 v24, v24
    v_exp_f32 v25, v25
    v_exp_f32 v26, v26
    v_exp_f32 v27, v27
    v_exp_f32 v28, v28
    v_exp_f32 v29, v29
    v_pk_mul_f32 v[184:185], v[184:185], v[72:73]
    v_pk_mul_f32 v[186:187], v[186:187], v[74:75]
    v_pk_mul_f32 v[188:189], v[188:189], v[76:77]
    v_pk_mul_f32 v[190:191], v[190:191], v[78:79]
    v_pk_add_f32 v[22:23], v[22:23], s[46:47]
    v_pk_add_f32 v[24:25], v[24:25], s[46:47]
    v_pk_add_f32 v[26:27], v[26:27], s[46:47]
    v_pk_add_f32 v[28:29], v[28:29], s[46:47]
    v_rcp_f32 v22, v22
    v_rcp_f32 v23, v23
    v_rcp_f32 v24, v24
    v_rcp_f32 v25, v25
    v_rcp_f32 v26, v26
    v_rcp_f32 v27, v27
    v_rcp_f32 v28, v28
    v_rcp_f32 v29, v29
    s_nop 0
    v_pk_mul_f32 v[184:185], v[184:185], v[22:23]
    v_pk_mul_f32 v[186:187], v[186:187], v[24:25]
    v_pk_mul_f32 v[188:189], v[188:189], v[26:27]
    v_pk_mul_f32 v[190:191], v[190:191], v[28:29]
    v_cvt_pk_bf16_f32 v4, v184, v185
    v_cvt_pk_bf16_f32 v5, v186, v187
    v_cvt_pk_bf16_f32 v6, v188, v189
    v_cvt_pk_bf16_f32 v7, v190, v191
    s_mov_b32 s31, 231424
    s_nop 0
    v_permlane16_swap_b32 v4, v6
    v_permlane16_swap_b32 v5, v7
    buffer_store_dwordx4 v[4:7], v19, s[24:27], s31 offen sc0 sc1
    v_pk_mul_f32 v[22:23], v[80:81], v[80:81]
    v_pk_mul_f32 v[24:25], v[82:83], v[82:83]
    v_pk_mul_f32 v[26:27], v[84:85], v[84:85]
    v_pk_mul_f32 v[28:29], v[86:87], v[86:87]
    v_pk_fma_f32 v[22:23], v[22:23], s[44:45], v[16:17]
    v_pk_fma_f32 v[24:25], v[24:25], s[44:45], v[16:17]
    v_pk_fma_f32 v[26:27], v[26:27], s[44:45], v[16:17]
    v_pk_fma_f32 v[28:29], v[28:29], s[44:45], v[16:17]
    v_pk_mul_f32 v[22:23], v[22:23], v[80:81]
    v_pk_mul_f32 v[24:25], v[24:25], v[82:83]
    v_pk_mul_f32 v[26:27], v[26:27], v[84:85]
    v_pk_mul_f32 v[28:29], v[28:29], v[86:87]
    v_exp_f32 v22, v22
    v_exp_f32 v23, v23
    v_exp_f32 v24, v24
    v_exp_f32 v25, v25
    v_exp_f32 v26, v26
    v_exp_f32 v27, v27
    v_exp_f32 v28, v28
    v_exp_f32 v29, v29
    v_pk_mul_f32 v[192:193], v[192:193], v[80:81]
    v_pk_mul_f32 v[194:195], v[194:195], v[82:83]
    v_pk_mul_f32 v[196:197], v[196:197], v[84:85]
    v_pk_mul_f32 v[198:199], v[198:199], v[86:87]
    v_pk_add_f32 v[22:23], v[22:23], s[46:47]
    v_pk_add_f32 v[24:25], v[24:25], s[46:47]
    v_pk_add_f32 v[26:27], v[26:27], s[46:47]
    v_pk_add_f32 v[28:29], v[28:29], s[46:47]
    v_rcp_f32 v22, v22
    v_rcp_f32 v23, v23
    v_rcp_f32 v24, v24
    v_rcp_f32 v25, v25
    v_rcp_f32 v26, v26
    v_rcp_f32 v27, v27
    v_rcp_f32 v28, v28
    v_rcp_f32 v29, v29
    s_nop 0
    v_pk_mul_f32 v[192:193], v[192:193], v[22:23]
    v_pk_mul_f32 v[194:195], v[194:195], v[24:25]
    v_pk_mul_f32 v[196:197], v[196:197], v[26:27]
    v_pk_mul_f32 v[198:199], v[198:199], v[28:29]
    v_cvt_pk_bf16_f32 v0, v192, v193
    v_cvt_pk_bf16_f32 v1, v194, v195
    v_cvt_pk_bf16_f32 v2, v196, v197
    v_cvt_pk_bf16_f32 v3, v198, v199
    s_mov_b32 s31, 3072
    s_nop 0
    v_permlane16_swap_b32 v0, v2
    v_permlane16_swap_b32 v1, v3
    buffer_store_dwordx4 v[0:3], v19, s[24:27], s31 offen sc0 sc1
    v_pk_mul_f32 v[22:23], v[88:89], v[88:89]
    v_pk_mul_f32 v[24:25], v[90:91], v[90:91]
    v_pk_mul_f32 v[26:27], v[92:93], v[92:93]
    v_pk_mul_f32 v[28:29], v[94:95], v[94:95]
    v_pk_fma_f32 v[22:23], v[22:23], s[44:45], v[16:17]
    v_pk_fma_f32 v[24:25], v[24:25], s[44:45], v[16:17]
    v_pk_fma_f32 v[26:27], v[26:27], s[44:45], v[16:17]
    v_pk_fma_f32 v[28:29], v[28:29], s[44:45], v[16:17]
    v_pk_mul_f32 v[22:23], v[22:23], v[88:89]
    v_pk_mul_f32 v[24:25], v[24:25], v[90:91]
    v_pk_mul_f32 v[26:27], v[26:27], v[92:93]
    v_pk_mul_f32 v[28:29], v[28:29], v[94:95]
    v_exp_f32 v22, v22
    v_exp_f32 v23, v23
    v_exp_f32 v24, v24
    v_exp_f32 v25, v25
    v_exp_f32 v26, v26
    v_exp_f32 v27, v27
    v_exp_f32 v28, v28
    v_exp_f32 v29, v29
    v_pk_mul_f32 v[200:201], v[200:201], v[88:89]
    v_pk_mul_f32 v[202:203], v[202:203], v[90:91]
    v_pk_mul_f32 v[204:205], v[204:205], v[92:93]
    v_pk_mul_f32 v[206:207], v[206:207], v[94:95]
    v_pk_add_f32 v[22:23], v[22:23], s[46:47]
    v_pk_add_f32 v[24:25], v[24:25], s[46:47]
    v_pk_add_f32 v[26:27], v[26:27], s[46:47]
    v_pk_add_f32 v[28:29], v[28:29], s[46:47]
    v_rcp_f32 v22, v22
    v_rcp_f32 v23, v23
    v_rcp_f32 v24, v24
    v_rcp_f32 v25, v25
    v_rcp_f32 v26, v26
    v_rcp_f32 v27, v27
    v_rcp_f32 v28, v28
    v_rcp_f32 v29, v29
    s_nop 0
    v_pk_mul_f32 v[200:201], v[200:201], v[22:23]
    v_pk_mul_f32 v[202:203], v[202:203], v[24:25]
    v_pk_mul_f32 v[204:205], v[204:205], v[26:27]
    v_pk_mul_f32 v[206:207], v[206:207], v[28:29]
    v_cvt_pk_bf16_f32 v4, v200, v201
    v_cvt_pk_bf16_f32 v5, v202, v203
    v_cvt_pk_bf16_f32 v6, v204, v205
    v_cvt_pk_bf16_f32 v7, v206, v207
    s_mov_b32 s31, 232448
    s_nop 0
    v_permlane16_swap_b32 v4, v6
    v_permlane16_swap_b32 v5, v7
    buffer_store_dwordx4 v[4:7], v19, s[24:27], s31 offen sc0 sc1
    v_pk_mul_f32 v[22:23], v[96:97], v[96:97]
    v_pk_mul_f32 v[24:25], v[98:99], v[98:99]
    v_pk_mul_f32 v[26:27], v[100:101], v[100:101]
    v_pk_mul_f32 v[28:29], v[102:103], v[102:103]
    v_pk_fma_f32 v[22:23], v[22:23], s[44:45], v[16:17]
    v_pk_fma_f32 v[24:25], v[24:25], s[44:45], v[16:17]
    v_pk_fma_f32 v[26:27], v[26:27], s[44:45], v[16:17]
    v_pk_fma_f32 v[28:29], v[28:29], s[44:45], v[16:17]
    v_pk_mul_f32 v[22:23], v[22:23], v[96:97]
    v_pk_mul_f32 v[24:25], v[24:25], v[98:99]
    v_pk_mul_f32 v[26:27], v[26:27], v[100:101]
    v_pk_mul_f32 v[28:29], v[28:29], v[102:103]
    v_exp_f32 v22, v22
    v_exp_f32 v23, v23
    v_exp_f32 v24, v24
    v_exp_f32 v25, v25
    v_exp_f32 v26, v26
    v_exp_f32 v27, v27
    v_exp_f32 v28, v28
    v_exp_f32 v29, v29
    v_pk_mul_f32 v[208:209], v[208:209], v[96:97]
    v_pk_mul_f32 v[210:211], v[210:211], v[98:99]
    v_pk_mul_f32 v[212:213], v[212:213], v[100:101]
    v_pk_mul_f32 v[214:215], v[214:215], v[102:103]
    v_pk_add_f32 v[22:23], v[22:23], s[46:47]
    v_pk_add_f32 v[24:25], v[24:25], s[46:47]
    v_pk_add_f32 v[26:27], v[26:27], s[46:47]
    v_pk_add_f32 v[28:29], v[28:29], s[46:47]
    v_rcp_f32 v22, v22
    v_rcp_f32 v23, v23
    v_rcp_f32 v24, v24
    v_rcp_f32 v25, v25
    v_rcp_f32 v26, v26
    v_rcp_f32 v27, v27
    v_rcp_f32 v28, v28
    v_rcp_f32 v29, v29
    s_nop 0
    v_pk_mul_f32 v[208:209], v[208:209], v[22:23]
    v_pk_mul_f32 v[210:211], v[210:211], v[24:25]
    v_pk_mul_f32 v[212:213], v[212:213], v[26:27]
    v_pk_mul_f32 v[214:215], v[214:215], v[28:29]
    v_cvt_pk_bf16_f32 v0, v208, v209
    v_cvt_pk_bf16_f32 v1, v210, v211
    v_cvt_pk_bf16_f32 v2, v212, v213
    v_cvt_pk_bf16_f32 v3, v214, v215
    s_mov_b32 s31, 4096
    s_nop 0
    v_permlane16_swap_b32 v0, v2
    v_permlane16_swap_b32 v1, v3
    buffer_store_dwordx4 v[0:3], v19, s[24:27], s31 offen sc0 sc1
    v_pk_mul_f32 v[22:23], v[104:105], v[104:105]
    v_pk_mul_f32 v[24:25], v[106:107], v[106:107]
    v_pk_mul_f32 v[26:27], v[108:109], v[108:109]
    v_pk_mul_f32 v[28:29], v[110:111], v[110:111]
    v_pk_fma_f32 v[22:23], v[22:23], s[44:45], v[16:17]
    v_pk_fma_f32 v[24:25], v[24:25], s[44:45], v[16:17]
    v_pk_fma_f32 v[26:27], v[26:27], s[44:45], v[16:17]
    v_pk_fma_f32 v[28:29], v[28:29], s[44:45], v[16:17]
    v_pk_mul_f32 v[22:23], v[22:23], v[104:105]
    v_pk_mul_f32 v[24:25], v[24:25], v[106:107]
    v_pk_mul_f32 v[26:27], v[26:27], v[108:109]
    v_pk_mul_f32 v[28:29], v[28:29], v[110:111]
    v_exp_f32 v22, v22
    v_exp_f32 v23, v23
    v_exp_f32 v24, v24
    v_exp_f32 v25, v25
    v_exp_f32 v26, v26
    v_exp_f32 v27, v27
    v_exp_f32 v28, v28
    v_exp_f32 v29, v29
    v_pk_mul_f32 v[216:217], v[216:217], v[104:105]
    v_pk_mul_f32 v[218:219], v[218:219], v[106:107]
    v_pk_mul_f32 v[220:221], v[220:221], v[108:109]
    v_pk_mul_f32 v[222:223], v[222:223], v[110:111]
    v_pk_add_f32 v[22:23], v[22:23], s[46:47]
    v_pk_add_f32 v[24:25], v[24:25], s[46:47]
    v_pk_add_f32 v[26:27], v[26:27], s[46:47]
    v_pk_add_f32 v[28:29], v[28:29], s[46:47]
    v_rcp_f32 v22, v22
    v_rcp_f32 v23, v23
    v_rcp_f32 v24, v24
    v_rcp_f32 v25, v25
    v_rcp_f32 v26, v26
    v_rcp_f32 v27, v27
    v_rcp_f32 v28, v28
    v_rcp_f32 v29, v29
    s_nop 0
    v_pk_mul_f32 v[216:217], v[216:217], v[22:23]
    v_pk_mul_f32 v[218:219], v[218:219], v[24:25]
    v_pk_mul_f32 v[220:221], v[220:221], v[26:27]
    v_pk_mul_f32 v[222:223], v[222:223], v[28:29]
    v_cvt_pk_bf16_f32 v4, v216, v217
    v_cvt_pk_bf16_f32 v5, v218, v219
    v_cvt_pk_bf16_f32 v6, v220, v221
    v_cvt_pk_bf16_f32 v7, v222, v223
    s_mov_b32 s31, 233472
    s_nop 0
    v_permlane16_swap_b32 v4, v6
    v_permlane16_swap_b32 v5, v7
    buffer_store_dwordx4 v[4:7], v19, s[24:27], s31 offen sc0 sc1
    v_pk_mul_f32 v[22:23], v[112:113], v[112:113]
    v_pk_mul_f32 v[24:25], v[114:115], v[114:115]
    v_pk_mul_f32 v[26:27], v[116:117], v[116:117]
    v_pk_mul_f32 v[28:29], v[118:119], v[118:119]
    v_pk_fma_f32 v[22:23], v[22:23], s[44:45], v[16:17]
    v_pk_fma_f32 v[24:25], v[24:25], s[44:45], v[16:17]
    v_pk_fma_f32 v[26:27], v[26:27], s[44:45], v[16:17]
    v_pk_fma_f32 v[28:29], v[28:29], s[44:45], v[16:17]
    v_pk_mul_f32 v[22:23], v[22:23], v[112:113]
    v_pk_mul_f32 v[24:25], v[24:25], v[114:115]
    v_pk_mul_f32 v[26:27], v[26:27], v[116:117]
    v_pk_mul_f32 v[28:29], v[28:29], v[118:119]
    v_exp_f32 v22, v22
    v_exp_f32 v23, v23
    v_exp_f32 v24, v24
    v_exp_f32 v25, v25
    v_exp_f32 v26, v26
    v_exp_f32 v27, v27
    v_exp_f32 v28, v28
    v_exp_f32 v29, v29
    v_pk_mul_f32 v[224:225], v[224:225], v[112:113]
    v_pk_mul_f32 v[226:227], v[226:227], v[114:115]
    v_pk_mul_f32 v[228:229], v[228:229], v[116:117]
    v_pk_mul_f32 v[230:231], v[230:231], v[118:119]
    v_pk_add_f32 v[22:23], v[22:23], s[46:47]
    v_pk_add_f32 v[24:25], v[24:25], s[46:47]
    v_pk_add_f32 v[26:27], v[26:27], s[46:47]
    v_pk_add_f32 v[28:29], v[28:29], s[46:47]
    v_rcp_f32 v22, v22
    v_rcp_f32 v23, v23
    v_rcp_f32 v24, v24
    v_rcp_f32 v25, v25
    v_rcp_f32 v26, v26
    v_rcp_f32 v27, v27
    v_rcp_f32 v28, v28
    v_rcp_f32 v29, v29
    s_nop 0
    v_pk_mul_f32 v[224:225], v[224:225], v[22:23]
    v_pk_mul_f32 v[226:227], v[226:227], v[24:25]
    v_pk_mul_f32 v[228:229], v[228:229], v[26:27]
    v_pk_mul_f32 v[230:231], v[230:231], v[28:29]
    v_cvt_pk_bf16_f32 v0, v224, v225
    v_cvt_pk_bf16_f32 v1, v226, v227
    v_cvt_pk_bf16_f32 v2, v228, v229
    v_cvt_pk_bf16_f32 v3, v230, v231
    s_mov_b32 s31, 5120
    s_nop 0
    v_permlane16_swap_b32 v0, v2
    v_permlane16_swap_b32 v1, v3
    buffer_store_dwordx4 v[0:3], v19, s[24:27], s31 offen sc0 sc1
    v_pk_mul_f32 v[22:23], v[120:121], v[120:121]
    v_pk_mul_f32 v[24:25], v[122:123], v[122:123]
    v_pk_mul_f32 v[26:27], v[124:125], v[124:125]
    v_pk_mul_f32 v[28:29], v[126:127], v[126:127]
    v_pk_fma_f32 v[22:23], v[22:23], s[44:45], v[16:17]
    v_pk_fma_f32 v[24:25], v[24:25], s[44:45], v[16:17]
    v_pk_fma_f32 v[26:27], v[26:27], s[44:45], v[16:17]
    v_pk_fma_f32 v[28:29], v[28:29], s[44:45], v[16:17]
    v_pk_mul_f32 v[22:23], v[22:23], v[120:121]
    v_pk_mul_f32 v[24:25], v[24:25], v[122:123]
    v_pk_mul_f32 v[26:27], v[26:27], v[124:125]
    v_pk_mul_f32 v[28:29], v[28:29], v[126:127]
    v_exp_f32 v22, v22
    v_exp_f32 v23, v23
    v_exp_f32 v24, v24
    v_exp_f32 v25, v25
    v_exp_f32 v26, v26
    v_exp_f32 v27, v27
    v_exp_f32 v28, v28
    v_exp_f32 v29, v29
    v_pk_mul_f32 v[232:233], v[232:233], v[120:121]
    v_pk_mul_f32 v[234:235], v[234:235], v[122:123]
    v_pk_mul_f32 v[236:237], v[236:237], v[124:125]
    v_pk_mul_f32 v[238:239], v[238:239], v[126:127]
    v_pk_add_f32 v[22:23], v[22:23], s[46:47]
    v_pk_add_f32 v[24:25], v[24:25], s[46:47]
    v_pk_add_f32 v[26:27], v[26:27], s[46:47]
    v_pk_add_f32 v[28:29], v[28:29], s[46:47]
    v_rcp_f32 v22, v22
    v_rcp_f32 v23, v23
    v_rcp_f32 v24, v24
    v_rcp_f32 v25, v25
    v_rcp_f32 v26, v26
    v_rcp_f32 v27, v27
    v_rcp_f32 v28, v28
    v_rcp_f32 v29, v29
    s_nop 0
    v_pk_mul_f32 v[232:233], v[232:233], v[22:23]
    v_pk_mul_f32 v[234:235], v[234:235], v[24:25]
    v_pk_mul_f32 v[236:237], v[236:237], v[26:27]
    v_pk_mul_f32 v[238:239], v[238:239], v[28:29]
    v_cvt_pk_bf16_f32 v4, v232, v233
    v_cvt_pk_bf16_f32 v5, v234, v235
    v_cvt_pk_bf16_f32 v6, v236, v237
    v_cvt_pk_bf16_f32 v7, v238, v239
    s_mov_b32 s31, 234496
    s_nop 0
    v_permlane16_swap_b32 v4, v6
    v_permlane16_swap_b32 v5, v7
    buffer_store_dwordx4 v[4:7], v19, s[24:27], s31 offen sc0 sc1
    v_pk_mul_f32 v[22:23], v[128:129], v[128:129]
    v_pk_mul_f32 v[24:25], v[130:131], v[130:131]
    v_pk_mul_f32 v[26:27], v[132:133], v[132:133]
    v_pk_mul_f32 v[28:29], v[134:135], v[134:135]
    v_pk_fma_f32 v[22:23], v[22:23], s[44:45], v[16:17]
    v_pk_fma_f32 v[24:25], v[24:25], s[44:45], v[16:17]
    v_pk_fma_f32 v[26:27], v[26:27], s[44:45], v[16:17]
    v_pk_fma_f32 v[28:29], v[28:29], s[44:45], v[16:17]
    v_pk_mul_f32 v[22:23], v[22:23], v[128:129]
    v_pk_mul_f32 v[24:25], v[24:25], v[130:131]
    v_pk_mul_f32 v[26:27], v[26:27], v[132:133]
    v_pk_mul_f32 v[28:29], v[28:29], v[134:135]
    v_exp_f32 v22, v22
    v_exp_f32 v23, v23
    v_exp_f32 v24, v24
    v_exp_f32 v25, v25
    v_exp_f32 v26, v26
    v_exp_f32 v27, v27
    v_exp_f32 v28, v28
    v_exp_f32 v29, v29
    v_pk_mul_f32 v[240:241], v[240:241], v[128:129]
    v_pk_mul_f32 v[242:243], v[242:243], v[130:131]
    v_pk_mul_f32 v[244:245], v[244:245], v[132:133]
    v_pk_mul_f32 v[246:247], v[246:247], v[134:135]
    v_pk_add_f32 v[22:23], v[22:23], s[46:47]
    v_pk_add_f32 v[24:25], v[24:25], s[46:47]
    v_pk_add_f32 v[26:27], v[26:27], s[46:47]
    v_pk_add_f32 v[28:29], v[28:29], s[46:47]
    v_rcp_f32 v22, v22
    v_rcp_f32 v23, v23
    v_rcp_f32 v24, v24
    v_rcp_f32 v25, v25
    v_rcp_f32 v26, v26
    v_rcp_f32 v27, v27
    v_rcp_f32 v28, v28
    v_rcp_f32 v29, v29
    s_nop 0
    v_pk_mul_f32 v[240:241], v[240:241], v[22:23]
    v_pk_mul_f32 v[242:243], v[242:243], v[24:25]
    v_pk_mul_f32 v[244:245], v[244:245], v[26:27]
    v_pk_mul_f32 v[246:247], v[246:247], v[28:29]
    v_cvt_pk_bf16_f32 v0, v240, v241
    v_cvt_pk_bf16_f32 v1, v242, v243
    v_cvt_pk_bf16_f32 v2, v244, v245
    v_cvt_pk_bf16_f32 v3, v246, v247
    s_mov_b32 s31, 6144
    s_nop 0
    v_permlane16_swap_b32 v0, v2
    v_permlane16_swap_b32 v1, v3
    buffer_store_dwordx4 v[0:3], v19, s[24:27], s31 offen sc0 sc1
    v_pk_mul_f32 v[22:23], v[136:137], v[136:137]
    v_pk_mul_f32 v[24:25], v[138:139], v[138:139]
    v_pk_mul_f32 v[26:27], v[140:141], v[140:141]
    v_pk_mul_f32 v[28:29], v[142:143], v[142:143]
    v_pk_fma_f32 v[22:23], v[22:23], s[44:45], v[16:17]
    v_pk_fma_f32 v[24:25], v[24:25], s[44:45], v[16:17]
    v_pk_fma_f32 v[26:27], v[26:27], s[44:45], v[16:17]
    v_pk_fma_f32 v[28:29], v[28:29], s[44:45], v[16:17]
    v_pk_mul_f32 v[22:23], v[22:23], v[136:137]
    v_pk_mul_f32 v[24:25], v[24:25], v[138:139]
    v_pk_mul_f32 v[26:27], v[26:27], v[140:141]
    v_pk_mul_f32 v[28:29], v[28:29], v[142:143]
    v_exp_f32 v22, v22
    v_exp_f32 v23, v23
    v_exp_f32 v24, v24
    v_exp_f32 v25, v25
    v_exp_f32 v26, v26
    v_exp_f32 v27, v27
    v_exp_f32 v28, v28
    v_exp_f32 v29, v29
    v_pk_mul_f32 v[248:249], v[248:249], v[136:137]
    v_pk_mul_f32 v[250:251], v[250:251], v[138:139]
    v_pk_mul_f32 v[252:253], v[252:253], v[140:141]
    v_pk_mul_f32 v[254:255], v[254:255], v[142:143]
    v_pk_add_f32 v[22:23], v[22:23], s[46:47]
    v_pk_add_f32 v[24:25], v[24:25], s[46:47]
    v_pk_add_f32 v[26:27], v[26:27], s[46:47]
    v_pk_add_f32 v[28:29], v[28:29], s[46:47]
    v_rcp_f32 v22, v22
    v_rcp_f32 v23, v23
    v_rcp_f32 v24, v24
    v_rcp_f32 v25, v25
    v_rcp_f32 v26, v26
    v_rcp_f32 v27, v27
    v_rcp_f32 v28, v28
    v_rcp_f32 v29, v29
    s_nop 0
    v_pk_mul_f32 v[248:249], v[248:249], v[22:23]
    v_pk_mul_f32 v[250:251], v[250:251], v[24:25]
    v_pk_mul_f32 v[252:253], v[252:253], v[26:27]
    v_pk_mul_f32 v[254:255], v[254:255], v[28:29]
    v_cvt_pk_bf16_f32 v4, v248, v249
    v_cvt_pk_bf16_f32 v5, v250, v251
    v_cvt_pk_bf16_f32 v6, v252, v253
    v_cvt_pk_bf16_f32 v7, v254, v255
    s_mov_b32 s31, 235520
    s_nop 0
    v_permlane16_swap_b32 v4, v6
    v_permlane16_swap_b32 v5, v7
    buffer_store_dwordx4 v[4:7], v19, s[24:27], s31 offen sc0 sc1
gemm3_kernel_end:
    s_endpgm

.globl gemm4_kernel
.p2align 8
.type gemm4_kernel,@function
gemm4_kernel:
    s_cmp_ge_u32 s2, 256
    s_cbranch_scc1 gemm4_kernel_end
    s_load_dwordx2 s[4:5], s[0:1], 64
    s_load_dwordx2 s[6:7], s[0:1], 88
    s_load_dwordx2 s[8:9], s[0:1], 104
    v_lshrrev_b32 v1, 6, v0
    v_and_b32 v20, 63, v0
    v_readfirstlane_b32 s33, v1
    s_and_b32 s11, s2, 7
    s_lshr_b32 s12, s2, 3
    s_lshr_b32 s13, s11, 1
    s_lshl_b32 s13, s13, 2
    s_and_b32 s14, s12, 3
    s_add_u32 s13, s13, s14
    s_and_b32 s14, s11, 1
    s_lshl_b32 s14, s14, 3
    s_lshr_b32 s15, s12, 2
    s_add_u32 s14, s14, s15
    v_lshrrev_b32 v2, 3, v20
    v_bfe_u32 v3, v20, 1, 2
    v_bfe_u32 v4, v20, 4, 1
    v_lshlrev_b32 v5, 7, v2
    v_and_b32 v6, 1, v20
    v_lshl_add_u32 v5, v6, 4, v5
    v_add_u32 v6, 0, v4
    v_xor_b32 v6, v3, v6
    v_lshl_add_u32 v16, v6, 5, v5
    v_add_u32 v6, 2, v4
    v_xor_b32 v6, v3, v6
    v_lshl_add_u32 v17, v6, 5, v5
    v_lshrrev_b32 v22, 4, v20
    v_lshrrev_b32 v23, 1, v22
    v_lshlrev_b32 v18, 10, v23
    v_and_b32 v23, 1, v22
    v_lshl_add_u32 v18, v23, 9, v18
    v_and_b32 v29, 15, v20
    v_lshl_add_u32 v18, v29, 4, v18
    v_bfe_u32 v24, v20, 2, 2
    v_and_b32 v25, 3, v20
    v_lshl_add_u32 v27, v22, 3, v24
    v_lshlrev_b32 v26, 7, v27
    v_lshl_add_u32 v26, v25, 3, v26
    v_lshrrev_b32 v27, 1, v24
    v_lshl_add_u32 v27, v23, 1, v27
    v_xor_b32 v28, 0, v27
    v_lshl_add_u32 v2, v28, 5, v26
    v_xor_b32 v28, 1, v27
    v_lshl_add_u32 v3, v28, 5, v26
    v_xor_b32 v28, 2, v27
    v_lshl_add_u32 v4, v28, 5, v26
    v_xor_b32 v28, 3, v27
    v_lshl_add_u32 v5, v28, 5, v26
    v_lshlrev_b32 v30, 5, v23
    v_lshrrev_b32 v28, 1, v22
    v_lshl_add_u32 v30, v28, 4, v30
    v_lshl_add_u32 v19, v29, 11, v30
    s_lshl_b32 s35, s13, 7
    s_lshl_b32 s36, s33, 5
    s_add_u32 s35, s35, s36
    v_add_u32 v24, s35, v29
    v_lshrrev_b32 v25, 3, v24
    v_lshlrev_b32 v25, 2, v25
    v_and_b32 v26, 3, v24
    v_add_u32 v25, v25, v26
    v_sub_u32 v26, 2048, v25
    v_and_b32 v27, 4, v24
    v_cmp_ne_u32 vcc, 0, v27
    s_nop 1
    v_cndmask_b32 v25, v25, v26, vcc
    v_mov_b32 v26, 1024
    v_cmp_eq_u32 vcc, 4, v24
    s_nop 1
    v_cndmask_b32 v25, v25, v26, vcc
    v_lshl_add_u32 v10, v25, 11, v30
    v_add_u32 v24, s35, v29
    v_add_u32 v24, 16, v24
    v_lshrrev_b32 v25, 3, v24
    v_lshlrev_b32 v25, 2, v25
    v_and_b32 v26, 3, v24
    v_add_u32 v25, v25, v26
    v_sub_u32 v26, 2048, v25
    v_and_b32 v27, 4, v24
    v_cmp_ne_u32 vcc, 0, v27
    s_nop 1
    v_cndmask_b32 v25, v25, v26, vcc
    v_mov_b32 v26, 1024
    v_cmp_eq_u32 vcc, 4, v24
    s_nop 1
    v_cndmask_b32 v25, v25, v26, vcc
    v_lshl_add_u32 v11, v25, 11, v30
    s_waitcnt lgkmcnt(0)
    s_mul_i32 s36, s33, 4096
    s_mul_i32 s37, s14, 458752
    s_add_u32 s36, s36, s37
    s_add_u32 s36, s36, 34603008
    s_add_u32 s16, s8, s36
    s_addc_u32 s17, s9, 0
    s_mul_i32 s36, s33, 4096
    s_sub_u32 s18, 458752, s36
    s_mov_b32 s19, 0x20000
    s_mul_i32 s30, s33, 4096
    s_lshl_b32 s38, s13, 2
    s_add_u32 s38, s38, s33
    s_mul_i32 s36, s38, 229376
    s_add_u32 s36, s36, 18874368
    s_add_u32 s20, s8, s36
    s_addc_u32 s21, s9, 0
    s_mov_b32 s22, 229376
    s_mov_b32 s23, 0x20000
    s_lshl_b32 s37, s14, 7
    s_add_u32 s24, s6, s37
    s_addc_u32 s25, s7, 0
    s_sub_u32 s26, 4194304, s37
    s_mov_b32 s27, 0x20000
    s_lshl_b32 s36, s35, 11
    s_add_u32 s36, s36, s37
    s_add_u32 s37, s36, 10485760
    s_add_u32 s40, s8, s37
    s_addc_u32 s41, s9, 0
    s_sub_u32 s42, 4194304, s36
    s_mov_b32 s43, 0x20000
    s_lshl_b32 s37, s14, 8
    s_add_u32 s37, s37, 208896
    s_add_u32 s44, s8, s37
    s_addc_u32 s45, s9, 0
    v_lshlrev_b32 v28, 2, v20
    v_add_u32 v29, 24576, v28
    v_add_u32 v14, 4096, v18
    s_mov_b32 s28, 0
    s_add_u32 m0, s30, 0
    s_add_u32 s31, s28, 0
    buffer_load_dwordx4 v16, s[16:19], s31 offen lds
    s_add_u32 m0, s30, 1024
    s_add_u32 s31, s28, 1024
    buffer_load_dwordx4 v17, s[16:19], s31 offen lds
    s_add_u32 m0, s30, 2048
    s_add_u32 s31, s28, 2048
    buffer_load_dwordx4 v16, s[16:19], s31 offen lds
    s_add_u32 m0, s30, 3072
    s_add_u32 s31, s28, 3072
    buffer_load_dwordx4 v17, s[16:19], s31 offen lds
    s_mov_b32 s56, 0
    buffer_load_dwordx4 v[96:99], v18, s[20:23], s56 offen offset:0
    buffer_load_dwordx4 v[100:103], v18, s[20:23], s56 offen offset:256
    buffer_load_dwordx4 v[104:107], v18, s[20:23], s56 offen offset:2048
    buffer_load_dwordx4 v[108:111], v18, s[20:23], s56 offen offset:2304
    buffer_load_dwordx4 v[112:115], v14, s[20:23], s56 offen offset:0
    buffer_load_dwordx4 v[116:119], v14, s[20:23], s56 offen offset:256
    buffer_load_dwordx4 v[120:123], v14, s[20:23], s56 offen offset:2048
    buffer_load_dwordx4 v[124:127], v14, s[20:23], s56 offen offset:2304
    global_load_dword v12, v28, s[44:45]
    s_add_u32 s28, s28, 16384
    s_add_u32 m0, s30, 16384
    s_add_u32 s31, s28, 0
    buffer_load_dwordx4 v16, s[16:19], s31 offen lds
    s_add_u32 m0, s30, 17408
    s_add_u32 s31, s28, 1024
    buffer_load_dwordx4 v17, s[16:19], s31 offen lds
    s_add_u32 m0, s30, 18432
    s_add_u32 s31, s28, 2048
    buffer_load_dwordx4 v16, s[16:19], s31 offen lds
    s_add_u32 m0, s30, 19456
    s_add_u32 s31, s28, 3072
    buffer_load_dwordx4 v17, s[16:19], s31 offen lds
    s_mov_b32 s56, 8192
    buffer_load_dwordx4 v[128:131], v18, s[20:23], s56 offen offset:0
    buffer_load_dwordx4 v[132:135], v18, s[20:23], s56 offen offset:256
    buffer_load_dwordx4 v[136:139], v18, s[20:23], s56 offen offset:2048
    buffer_load_dwordx4 v[140:143], v18, s[20:23], s56 offen offset:2304
    buffer_load_dwordx4 v[144:147], v14, s[20:23], s56 offen offset:0
    buffer_load_dwordx4 v[148:151], v14, s[20:23], s56 offen offset:256
    s_add_u32 s28, s28, 16384
    s_add_u32 m0, s30, 32768
    s_add_u32 s31, s28, 0
    buffer_load_dwordx4 v16, s[16:19], s31 offen lds
    s_add_u32 m0, s30, 33792
    s_add_u32 s31, s28, 1024
    buffer_load_dwordx4 v17, s[16:19], s31 offen lds
    s_add_u32 m0, s30, 34816
    s_add_u32 s31, s28, 2048
    buffer_load_dwordx4 v16, s[16:19], s31 offen lds
    s_add_u32 m0, s30, 35840
    s_add_u32 s31, s28, 3072
    buffer_load_dwordx4 v17, s[16:19], s31 offen lds
    s_add_u32 s28, s28, 16384
    s_mov_b32 s31, 0
    buffer_load_dwordx4 v[160:163], v19, s[40:43], s31 offen
    s_mov_b32 s31, 64
    buffer_load_dwordx4 v[164:167], v19, s[40:43], s31 offen
    s_mov_b32 s31, 32768
    buffer_load_dwordx4 v[168:171], v19, s[40:43], s31 offen
    s_mov_b32 s31, 32832
    buffer_load_dwordx4 v[172:175], v19, s[40:43], s31 offen
    v_mov_b32 v32, 0
    v_mov_b32 v33, 0
    v_mov_b32 v34, 0
    v_mov_b32 v35, 0
    v_mov_b32 v36, 0
    v_mov_b32 v37, 0
    v_mov_b32 v38, 0
    v_mov_b32 v39, 0
    v_mov_b32 v40, 0
    v_mov_b32 v41, 0
    v_mov_b32 v42, 0
    v_mov_b32 v43, 0
    v_mov_b32 v44, 0
    v_mov_b32 v45, 0
    v_mov_b32 v46, 0
    v_mov_b32 v47, 0
    v_mov_b32 v48, 0
    v_mov_b32 v49, 0
    v_mov_b32 v50, 0
    v_mov_b32 v51, 0
    v_mov_b32 v52, 0
    v_mov_b32 v53, 0
    v_mov_b32 v54, 0
    v_mov_b32 v55, 0
    v_mov_b32 v56, 0
    v_mov_b32 v57, 0
    v_mov_b32 v58, 0
    v_mov_b32 v59, 0
    v_mov_b32 v60, 0
    v_mov_b32 v61, 0
    v_mov_b32 v62, 0
    v_mov_b32 v63, 0
    s_waitcnt vmcnt(18)
    v_cvt_pk_bf16_f32 v12, v12, v12
    v_and_b32 v12, 0xffff0000, v12
    v_add_u32 v28, 65536, v28
    ds_write_b32 v28, v12
    s_waitcnt lgkmcnt(0)
    s_mov_b32 s32, 0
    s_waitcnt vmcnt(27)
    s_barrier
    ds_read_b64_tr_b16 v[64:65], v2 offset:0
    ds_read_b64_tr_b16 v[66:67], v2 offset:512
    ds_read_b64_tr_b16 v[68:69], v3 offset:0
    ds_read_b64_tr_b16 v[70:71], v3 offset:512
    ds_read_b64_tr_b16 v[72:73], v4 offset:0
    ds_read_b64_tr_b16 v[74:75], v4 offset:512
    ds_read_b64_tr_b16 v[76:77], v5 offset:0
    ds_read_b64_tr_b16 v[78:79], v5 offset:512
.p2align 6
gemm4_kernel_loop:
    s_waitcnt lgkmcnt(0)
    s_waitcnt vmcnt(19)
    v_mfma_f32_16x16x32_bf16 v[32:35], v[64:67], v[96:99], v[32:35]
    ds_read_b64_tr_b16 v[80:81], v2 offset:4096
    ds_read_b64_tr_b16 v[82:83], v2 offset:4608
    v_mfma_f32_16x16x32_bf16 v[36:39], v[64:67], v[100:103], v[36:39]
    ds_read_b64_tr_b16 v[84:85], v3 offset:4096
    ds_read_b64_tr_b16 v[86:87], v3 offset:4608
    v_mfma_f32_16x16x32_bf16 v[40:43], v[68:71], v[96:99], v[40:43]
    ds_read_b64_tr_b16 v[88:89], v4 offset:4096
    ds_read_b64_tr_b16 v[90:91], v4 offset:4608
    v_mfma_f32_16x16x32_bf16 v[44:47], v[68:71], v[100:103], v[44:47]
    ds_read_b64_tr_b16 v[92:93], v5 offset:4096
    ds_read_b64_tr_b16 v[94:95], v5 offset:4608
    v_mfma_f32_16x16x32_bf16 v[48:51], v[72:75], v[96:99], v[48:51]
    buffer_load_dwordx4 v[152:155], v14, s[20:23], s56 offen offset:2048
    v_mfma_f32_16x16x32_bf16 v[52:55], v[72:75], v[100:103], v[52:55]
    buffer_load_dwordx4 v[156:159], v14, s[20:23], s56 offen offset:2304
    s_add_u32 s56, s56, 8192
    v_mfma_f32_16x16x32_bf16 v[56:59], v[76:79], v[96:99], v[56:59]
    s_add_u32 m0, s30, 49152
    s_add_u32 s31, s28, 0
    buffer_load_dwordx4 v16, s[16:19], s31 offen lds
    v_mfma_f32_16x16x32_bf16 v[60:63], v[76:79], v[100:103], v[60:63]
    s_waitcnt lgkmcnt(0)
    s_waitcnt vmcnt(19)
    v_mfma_f32_16x16x32_bf16 v[32:35], v[80:83], v[104:107], v[32:35]
    ds_read_b64_tr_b16 v[64:65], v2 offset:8192
    ds_read_b64_tr_b16 v[66:67], v2 offset:8704
    v_mfma_f32_16x16x32_bf16 v[36:39], v[80:83], v[108:111], v[36:39]
    ds_read_b64_tr_b16 v[68:69], v3 offset:8192
    ds_read_b64_tr_b16 v[70:71], v3 offset:8704
    v_mfma_f32_16x16x32_bf16 v[40:43], v[84:87], v[104:107], v[40:43]
    ds_read_b64_tr_b16 v[72:73], v4 offset:8192
    ds_read_b64_tr_b16 v[74:75], v4 offset:8704
    v_mfma_f32_16x16x32_bf16 v[44:47], v[84:87], v[108:111], v[44:47]
    ds_read_b64_tr_b16 v[76:77], v5 offset:8192
    ds_read_b64_tr_b16 v[78:79], v5 offset:8704
    v_mfma_f32_16x16x32_bf16 v[48:51], v[88:91], v[104:107], v[48:51]
    buffer_load_dwordx4 v[96:99], v18, s[20:23], s56 offen offset:0
    v_mfma_f32_16x16x32_bf16 v[52:55], v[88:91], v[108:111], v[52:55]
    buffer_load_dwordx4 v[100:103], v18, s[20:23], s56 offen offset:256
    v_mfma_f32_16x16x32_bf16 v[56:59], v[92:95], v[104:107], v[56:59]
    s_add_u32 m0, s30, 50176
    s_add_u32 s31, s28, 1024
    buffer_load_dwordx4 v17, s[16:19], s31 offen lds
    v_mfma_f32_16x16x32_bf16 v[60:63], v[92:95], v[108:111], v[60:63]
    s_waitcnt lgkmcnt(0)
    s_waitcnt vmcnt(19)
    v_mfma_f32_16x16x32_bf16 v[32:35], v[64:67], v[112:115], v[32:35]
    ds_read_b64_tr_b16 v[80:81], v2 offset:12288
    ds_read_b64_tr_b16 v[82:83], v2 offset:12800
    v_mfma_f32_16x16x32_bf16 v[36:39], v[64:67], v[116:119], v[36:39]
    ds_read_b64_tr_b16 v[84:85], v3 offset:12288
    ds_read_b64_tr_b16 v[86:87], v3 offset:12800
    v_mfma_f32_16x16x32_bf16 v[40:43], v[68:71], v[112:115], v[40:43]
    ds_read_b64_tr_b16 v[88:89], v4 offset:12288
    ds_read_b64_tr_b16 v[90:91], v4 offset:12800
    v_mfma_f32_16x16x32_bf16 v[44:47], v[68:71], v[116:119], v[44:47]
    ds_read_b64_tr_b16 v[92:93], v5 offset:12288
    ds_read_b64_tr_b16 v[94:95], v5 offset:12800
    v_mfma_f32_16x16x32_bf16 v[48:51], v[72:75], v[112:115], v[48:51]
    buffer_load_dwordx4 v[104:107], v18, s[20:23], s56 offen offset:2048
    v_mfma_f32_16x16x32_bf16 v[52:55], v[72:75], v[116:119], v[52:55]
    buffer_load_dwordx4 v[108:111], v18, s[20:23], s56 offen offset:2304
    v_mfma_f32_16x16x32_bf16 v[56:59], v[76:79], v[112:115], v[56:59]
    s_add_u32 m0, s30, 51200
    s_add_u32 s31, s28, 2048
    buffer_load_dwordx4 v16, s[16:19], s31 offen lds
    v_mfma_f32_16x16x32_bf16 v[60:63], v[76:79], v[116:119], v[60:63]
    s_waitcnt lgkmcnt(0)
    s_waitcnt vmcnt(19)
    v_mfma_f32_16x16x32_bf16 v[32:35], v[80:83], v[120:123], v[32:35]
    s_waitcnt vmcnt(21)
    s_barrier
    ds_read_b64_tr_b16 v[64:65], v2 offset:16384
    ds_read_b64_tr_b16 v[66:67], v2 offset:16896
    v_mfma_f32_16x16x32_bf16 v[36:39], v[80:83], v[124:127], v[36:39]
    ds_read_b64_tr_b16 v[68:69], v3 offset:16384
    ds_read_b64_tr_b16 v[70:71], v3 offset:16896
    v_mfma_f32_16x16x32_bf16 v[40:43], v[84:87], v[120:123], v[40:43]
    ds_read_b64_tr_b16 v[72:73], v4 offset:16384
    ds_read_b64_tr_b16 v[74:75], v4 offset:16896
    v_mfma_f32_16x16x32_bf16 v[44:47], v[84:87], v[124:127], v[44:47]
    ds_read_b64_tr_b16 v[76:77], v5 offset:16384
    ds_read_b64_tr_b16 v[78:79], v5 offset:16896
    v_mfma_f32_16x16x32_bf16 v[48:51], v[88:91], v[120:123], v[48:51]
    buffer_load_dwordx4 v[112:115], v14, s[20:23], s56 offen offset:0
    v_mfma_f32_16x16x32_bf16 v[52:55], v[88:91], v[124:127], v[52:55]
    buffer_load_dwordx4 v[116:119], v14, s[20:23], s56 offen offset:256
    v_mfma_f32_16x16x32_bf16 v[56:59], v[92:95], v[120:123], v[56:59]
    s_add_u32 m0, s30, 52224
    s_add_u32 s31, s28, 3072
    buffer_load_dwordx4 v17, s[16:19], s31 offen lds
    v_mfma_f32_16x16x32_bf16 v[60:63], v[92:95], v[124:127], v[60:63]
    s_add_u32 s28, s28, 16384
    s_waitcnt lgkmcnt(0)
    s_waitcnt vmcnt(19)
    v_mfma_f32_16x16x32_bf16 v[32:35], v[64:67], v[128:131], v[32:35]
    ds_read_b64_tr_b16 v[80:81], v2 offset:20480
    ds_read_b64_tr_b16 v[82:83], v2 offset:20992
    v_mfma_f32_16x16x32_bf16 v[36:39], v[64:67], v[132:135], v[36:39]
    ds_read_b64_tr_b16 v[84:85], v3 offset:20480
    ds_read_b64_tr_b16 v[86:87], v3 offset:20992
    v_mfma_f32_16x16x32_bf16 v[40:43], v[68:71], v[128:131], v[40:43]
    ds_read_b64_tr_b16 v[88:89], v4 offset:20480
    ds_read_b64_tr_b16 v[90:91], v4 offset:20992
    v_mfma_f32_16x16x32_bf16 v[44:47], v[68:71], v[132:135], v[44:47]
    ds_read_b64_tr_b16 v[92:93], v5 offset:20480
    ds_read_b64_tr_b16 v[94:95], v5 offset:20992
    v_mfma_f32_16x16x32_bf16 v[48:51], v[72:75], v[128:131], v[48:51]
    buffer_load_dwordx4 v[120:123], v14, s[20:23], s56 offen offset:2048
    v_mfma_f32_16x16x32_bf16 v[52:55], v[72:75], v[132:135], v[52:55]
    buffer_load_dwordx4 v[124:127], v14, s[20:23], s56 offen offset:2304
    s_add_u32 s56, s56, 8192
    v_mfma_f32_16x16x32_bf16 v[56:59], v[76:79], v[128:131], v[56:59]
    s_add_u32 m0, s30, 0
    s_add_u32 s31, s28, 0
    buffer_load_dwordx4 v16, s[16:19], s31 offen lds
    v_mfma_f32_16x16x32_bf16 v[60:63], v[76:79], v[132:135], v[60:63]
    s_waitcnt lgkmcnt(0)
    s_waitcnt vmcnt(19)
    v_mfma_f32_16x16x32_bf16 v[32:35], v[80:83], v[136:139], v[32:35]
    ds_read_b64_tr_b16 v[64:65], v2 offset:24576
    ds_read_b64_tr_b16 v[66:67], v2 offset:25088
    v_mfma_f32_16x16x32_bf16 v[36:39], v[80:83], v[140:143], v[36:39]
    ds_read_b64_tr_b16 v[68:69], v3 offset:24576
    ds_read_b64_tr_b16 v[70:71], v3 offset:25088
    v_mfma_f32_16x16x32_bf16 v[40:43], v[84:87], v[136:139], v[40:43]
    ds_read_b64_tr_b16 v[72:73], v4 offset:24576
    ds_read_b64_tr_b16 v[74:75], v4 offset:25088
    v_mfma_f32_16x16x32_bf16 v[44:47], v[84:87], v[140:143], v[44:47]
    ds_read_b64_tr_b16 v[76:77], v5 offset:24576
    ds_read_b64_tr_b16 v[78:79], v5 offset:25088
    v_mfma_f32_16x16x32_bf16 v[48:51], v[88:91], v[136:139], v[48:51]
    buffer_load_dwordx4 v[128:131], v18, s[20:23], s56 offen offset:0
    v_mfma_f32_16x16x32_bf16 v[52:55], v[88:91], v[140:143], v[52:55]
    buffer_load_dwordx4 v[132:135], v18, s[20:23], s56 offen offset:256
    v_mfma_f32_16x16x32_bf16 v[56:59], v[92:95], v[136:139], v[56:59]
    s_add_u32 m0, s30, 1024
    s_add_u32 s31, s28, 1024
    buffer_load_dwordx4 v17, s[16:19], s31 offen lds
    v_mfma_f32_16x16x32_bf16 v[60:63], v[92:95], v[140:143], v[60:63]
    s_waitcnt lgkmcnt(0)
    s_waitcnt vmcnt(19)
    v_mfma_f32_16x16x32_bf16 v[32:35], v[64:67], v[144:147], v[32:35]
    ds_read_b64_tr_b16 v[80:81], v2 offset:28672
    ds_read_b64_tr_b16 v[82:83], v2 offset:29184
    v_mfma_f32_16x16x32_bf16 v[36:39], v[64:67], v[148:151], v[36:39]
    ds_read_b64_tr_b16 v[84:85], v3 offset:28672
    ds_read_b64_tr_b16 v[86:87], v3 offset:29184
    v_mfma_f32_16x16x32_bf16 v[40:43], v[68:71], v[144:147], v[40:43]
    ds_read_b64_tr_b16 v[88:89], v4 offset:28672
    ds_read_b64_tr_b16 v[90:91], v4 offset:29184
    v_mfma_f32_16x16x32_bf16 v[44:47], v[68:71], v[148:151], v[44:47]
    ds_read_b64_tr_b16 v[92:93], v5 offset:28672
    ds_read_b64_tr_b16 v[94:95], v5 offset:29184
    v_mfma_f32_16x16x32_bf16 v[48:51], v[72:75], v[144:147], v[48:51]
    buffer_load_dwordx4 v[136:139], v18, s[20:23], s56 offen offset:2048
    v_mfma_f32_16x16x32_bf16 v[52:55], v[72:75], v[148:151], v[52:55]
    buffer_load_dwordx4 v[140:143], v18, s[20:23], s56 offen offset:2304
    v_mfma_f32_16x16x32_bf16 v[56:59], v[76:79], v[144:147], v[56:59]
    s_add_u32 m0, s30, 2048
    s_add_u32 s31, s28, 2048
    buffer_load_dwordx4 v16, s[16:19], s31 offen lds
    v_mfma_f32_16x16x32_bf16 v[60:63], v[76:79], v[148:151], v[60:63]
    s_waitcnt lgkmcnt(0)
    s_waitcnt vmcnt(19)
    v_mfma_f32_16x16x32_bf16 v[32:35], v[80:83], v[152:155], v[32:35]
    s_waitcnt vmcnt(21)
    s_barrier
    ds_read_b64_tr_b16 v[64:65], v2 offset:32768
    ds_read_b64_tr_b16 v[66:67], v2 offset:33280
    v_mfma_f32_16x16x32_bf16 v[36:39], v[80:83], v[156:159], v[36:39]
    ds_read_b64_tr_b16 v[68:69], v3 offset:32768
    ds_read_b64_tr_b16 v[70:71], v3 offset:33280
    v_mfma_f32_16x16x32_bf16 v[40:43], v[84:87], v[152:155], v[40:43]
    ds_read_b64_tr_b16 v[72:73], v4 offset:32768
    ds_read_b64_tr_b16 v[74:75], v4 offset:33280
    v_mfma_f32_16x16x32_bf16 v[44:47], v[84:87], v[156:159], v[44:47]
    ds_read_b64_tr_b16 v[76:77], v5 offset:32768
    ds_read_b64_tr_b16 v[78:79], v5 offset:33280
    v_mfma_f32_16x16x32_bf16 v[48:51], v[88:91], v[152:155], v[48:51]
    buffer_load_dwordx4 v[144:147], v14, s[20:23], s56 offen offset:0
    v_mfma_f32_16x16x32_bf16 v[52:55], v[88:91], v[156:159], v[52:55]
    buffer_load_dwordx4 v[148:151], v14, s[20:23], s56 offen offset:256
    v_mfma_f32_16x16x32_bf16 v[56:59], v[92:95], v[152:155], v[56:59]
    s_add_u32 m0, s30, 3072
    s_add_u32 s31, s28, 3072
    buffer_load_dwordx4 v17, s[16:19], s31 offen lds
    v_mfma_f32_16x16x32_bf16 v[60:63], v[92:95], v[156:159], v[60:63]
    s_add_u32 s28, s28, 16384
    s_waitcnt lgkmcnt(0)
    s_waitcnt vmcnt(19)
    v_mfma_f32_16x16x32_bf16 v[32:35], v[64:67], v[96:99], v[32:35]
    ds_read_b64_tr_b16 v[80:81], v2 offset:36864
    ds_read_b64_tr_b16 v[82:83], v2 offset:37376
    v_mfma_f32_16x16x32_bf16 v[36:39], v[64:67], v[100:103], v[36:39]
    ds_read_b64_tr_b16 v[84:85], v3 offset:36864
    ds_read_b64_tr_b16 v[86:87], v3 offset:37376
    v_mfma_f32_16x16x32_bf16 v[40:43], v[68:71], v[96:99], v[40:43]
    ds_read_b64_tr_b16 v[88:89], v4 offset:36864
    ds_read_b64_tr_b16 v[90:91], v4 offset:37376
    v_mfma_f32_16x16x32_bf16 v[44:47], v[68:71], v[100:103], v[44:47]
    ds_read_b64_tr_b16 v[92:93], v5 offset:36864
    ds_read_b64_tr_b16 v[94:95], v5 offset:37376
    v_mfma_f32_16x16x32_bf16 v[48:51], v[72:75], v[96:99], v[48:51]
    buffer_load_dwordx4 v[152:155], v14, s[20:23], s56 offen offset:2048
    v_mfma_f32_16x16x32_bf16 v[52:55], v[72:75], v[100:103], v[52:55]
    buffer_load_dwordx4 v[156:159], v14, s[20:23], s56 offen offset:2304
    s_add_u32 s56, s56, 8192
    v_mfma_f32_16x16x32_bf16 v[56:59], v[76:79], v[96:99], v[56:59]
    s_add_u32 m0, s30, 16384
    s_add_u32 s31, s28, 0
    buffer_load_dwordx4 v16, s[16:19], s31 offen lds
    v_mfma_f32_16x16x32_bf16 v[60:63], v[76:79], v[100:103], v[60:63]
    s_waitcnt lgkmcnt(0)
    s_waitcnt vmcnt(19)
    v_mfma_f32_16x16x32_bf16 v[32:35], v[80:83], v[104:107], v[32:35]
    ds_read_b64_tr_b16 v[64:65], v2 offset:40960
    ds_read_b64_tr_b16 v[66:67], v2 offset:41472
    v_mfma_f32_16x16x32_bf16 v[36:39], v[80:83], v[108:111], v[36:39]
    ds_read_b64_tr_b16 v[68:69], v3 offset:40960
    ds_read_b64_tr_b16 v[70:71], v3 offset:41472
    v_mfma_f32_16x16x32_bf16 v[40:43], v[84:87], v[104:107], v[40:43]
    ds_read_b64_tr_b16 v[72:73], v4 offset:40960
    ds_read_b64_tr_b16 v[74:75], v4 offset:41472
    v_mfma_f32_16x16x32_bf16 v[44:47], v[84:87], v[108:111], v[44:47]
    ds_read_b64_tr_b16 v[76:77], v5 offset:40960
    ds_read_b64_tr_b16 v[78:79], v5 offset:41472
    v_mfma_f32_16x16x32_bf16 v[48:51], v[88:91], v[104:107], v[48:51]
    buffer_load_dwordx4 v[96:99], v18, s[20:23], s56 offen offset:0
    v_mfma_f32_16x16x32_bf16 v[52:55], v[88:91], v[108:111], v[52:55]
    buffer_load_dwordx4 v[100:103], v18, s[20:23], s56 offen offset:256
    v_mfma_f32_16x16x32_bf16 v[56:59], v[92:95], v[104:107], v[56:59]
    s_add_u32 m0, s30, 17408
    s_add_u32 s31, s28, 1024
    buffer_load_dwordx4 v17, s[16:19], s31 offen lds
    v_mfma_f32_16x16x32_bf16 v[60:63], v[92:95], v[108:111], v[60:63]
    s_waitcnt lgkmcnt(0)
    s_waitcnt vmcnt(19)
    v_mfma_f32_16x16x32_bf16 v[32:35], v[64:67], v[112:115], v[32:35]
    ds_read_b64_tr_b16 v[80:81], v2 offset:45056
    ds_read_b64_tr_b16 v[82:83], v2 offset:45568
    v_mfma_f32_16x16x32_bf16 v[36:39], v[64:67], v[116:119], v[36:39]
    ds_read_b64_tr_b16 v[84:85], v3 offset:45056
    ds_read_b64_tr_b16 v[86:87], v3 offset:45568
    v_mfma_f32_16x16x32_bf16 v[40:43], v[68:71], v[112:115], v[40:43]
    ds_read_b64_tr_b16 v[88:89], v4 offset:45056
    ds_read_b64_tr_b16 v[90:91], v4 offset:45568
    v_mfma_f32_16x16x32_bf16 v[44:47], v[68:71], v[116:119], v[44:47]
    ds_read_b64_tr_b16 v[92:93], v5 offset:45056
    ds_read_b64_tr_b16 v[94:95], v5 offset:45568
    v_mfma_f32_16x16x32_bf16 v[48:51], v[72:75], v[112:115], v[48:51]
    buffer_load_dwordx4 v[104:107], v18, s[20:23], s56 offen offset:2048
    v_mfma_f32_16x16x32_bf16 v[52:55], v[72:75], v[116:119], v[52:55]
    buffer_load_dwordx4 v[108:111], v18, s[20:23], s56 offen offset:2304
    v_mfma_f32_16x16x32_bf16 v[56:59], v[76:79], v[112:115], v[56:59]
    s_add_u32 m0, s30, 18432
    s_add_u32 s31, s28, 2048
    buffer_load_dwordx4 v16, s[16:19], s31 offen lds
    v_mfma_f32_16x16x32_bf16 v[60:63], v[76:79], v[116:119], v[60:63]
    s_waitcnt lgkmcnt(0)
    s_waitcnt vmcnt(19)
    v_mfma_f32_16x16x32_bf16 v[32:35], v[80:83], v[120:123], v[32:35]
    s_waitcnt vmcnt(21)
    s_barrier
    ds_read_b64_tr_b16 v[64:65], v2 offset:49152
    ds_read_b64_tr_b16 v[66:67], v2 offset:49664
    v_mfma_f32_16x16x32_bf16 v[36:39], v[80:83], v[124:127], v[36:39]
    ds_read_b64_tr_b16 v[68:69], v3 offset:49152
    ds_read_b64_tr_b16 v[70:71], v3 offset:49664
    v_mfma_f32_16x16x32_bf16 v[40:43], v[84:87], v[120:123], v[40:43]
    ds_read_b64_tr_b16 v[72:73], v4 offset:49152
    ds_read_b64_tr_b16 v[74:75], v4 offset:49664
    v_mfma_f32_16x16x32_bf16 v[44:47], v[84:87], v[124:127], v[44:47]
    ds_read_b64_tr_b16 v[76:77], v5 offset:49152
    ds_read_b64_tr_b16 v[78:79], v5 offset:49664
    v_mfma_f32_16x16x32_bf16 v[48:51], v[88:91], v[120:123], v[48:51]
    buffer_load_dwordx4 v[112:115], v14, s[20:23], s56 offen offset:0
    v_mfma_f32_16x16x32_bf16 v[52:55], v[88:91], v[124:127], v[52:55]
    buffer_load_dwordx4 v[116:119], v14, s[20:23], s56 offen offset:256
    v_mfma_f32_16x16x32_bf16 v[56:59], v[92:95], v[120:123], v[56:59]
    s_add_u32 m0, s30, 19456
    s_add_u32 s31, s28, 3072
    buffer_load_dwordx4 v17, s[16:19], s31 offen lds
    v_mfma_f32_16x16x32_bf16 v[60:63], v[92:95], v[124:127], v[60:63]
    s_add_u32 s28, s28, 16384
    s_waitcnt lgkmcnt(0)
    s_waitcnt vmcnt(19)
    v_mfma_f32_16x16x32_bf16 v[32:35], v[64:67], v[128:131], v[32:35]
    ds_read_b64_tr_b16 v[80:81], v2 offset:53248
    ds_read_b64_tr_b16 v[82:83], v2 offset:53760
    v_mfma_f32_16x16x32_bf16 v[36:39], v[64:67], v[132:135], v[36:39]
    ds_read_b64_tr_b16 v[84:85], v3 offset:53248
    ds_read_b64_tr_b16 v[86:87], v3 offset:53760
    v_mfma_f32_16x16x32_bf16 v[40:43], v[68:71], v[128:131], v[40:43]
    ds_read_b64_tr_b16 v[88:89], v4 offset:53248
    ds_read_b64_tr_b16 v[90:91], v4 offset:53760
    v_mfma_f32_16x16x32_bf16 v[44:47], v[68:71], v[132:135], v[44:47]
    ds_read_b64_tr_b16 v[92:93], v5 offset:53248
    ds_read_b64_tr_b16 v[94:95], v5 offset:53760
    v_mfma_f32_16x16x32_bf16 v[48:51], v[72:75], v[128:131], v[48:51]
    buffer_load_dwordx4 v[120:123], v14, s[20:23], s56 offen offset:2048
    v_mfma_f32_16x16x32_bf16 v[52:55], v[72:75], v[132:135], v[52:55]
    buffer_load_dwordx4 v[124:127], v14, s[20:23], s56 offen offset:2304
    s_add_u32 s56, s56, 8192
    v_mfma_f32_16x16x32_bf16 v[56:59], v[76:79], v[128:131], v[56:59]
    s_add_u32 m0, s30, 32768
    s_add_u32 s31, s28, 0
    buffer_load_dwordx4 v16, s[16:19], s31 offen lds
    v_mfma_f32_16x16x32_bf16 v[60:63], v[76:79], v[132:135], v[60:63]
    s_waitcnt lgkmcnt(0)
    s_waitcnt vmcnt(19)
    v_mfma_f32_16x16x32_bf16 v[32:35], v[80:83], v[136:139], v[32:35]
    ds_read_b64_tr_b16 v[64:65], v2 offset:57344
    ds_read_b64_tr_b16 v[66:67], v2 offset:57856
    v_mfma_f32_16x16x32_bf16 v[36:39], v[80:83], v[140:143], v[36:39]
    ds_read_b64_tr_b16 v[68:69], v3 offset:57344
    ds_read_b64_tr_b16 v[70:71], v3 offset:57856
    v_mfma_f32_16x16x32_bf16 v[40:43], v[84:87], v[136:139], v[40:43]
    ds_read_b64_tr_b16 v[72:73], v4 offset:57344
    ds_read_b64_tr_b16 v[74:75], v4 offset:57856
    v_mfma_f32_16x16x32_bf16 v[44:47], v[84:87], v[140:143], v[44:47]
    ds_read_b64_tr_b16 v[76:77], v5 offset:57344
    ds_read_b64_tr_b16 v[78:79], v5 offset:57856
    v_mfma_f32_16x16x32_bf16 v[48:51], v[88:91], v[136:139], v[48:51]
    buffer_load_dwordx4 v[128:131], v18, s[20:23], s56 offen offset:0
    v_mfma_f32_16x16x32_bf16 v[52:55], v[88:91], v[140:143], v[52:55]
    buffer_load_dwordx4 v[132:135], v18, s[20:23], s56 offen offset:256
    v_mfma_f32_16x16x32_bf16 v[56:59], v[92:95], v[136:139], v[56:59]
    s_add_u32 m0, s30, 33792
    s_add_u32 s31, s28, 1024
    buffer_load_dwordx4 v17, s[16:19], s31 offen lds
    v_mfma_f32_16x16x32_bf16 v[60:63], v[92:95], v[140:143], v[60:63]
    s_waitcnt lgkmcnt(0)
    s_waitcnt vmcnt(19)
    v_mfma_f32_16x16x32_bf16 v[32:35], v[64:67], v[144:147], v[32:35]
    ds_read_b64_tr_b16 v[80:81], v2 offset:61440
    ds_read_b64_tr_b16 v[82:83], v2 offset:61952
    v_mfma_f32_16x16x32_bf16 v[36:39], v[64:67], v[148:151], v[36:39]
    ds_read_b64_tr_b16 v[84:85], v3 offset:61440
    ds_read_b64_tr_b16 v[86:87], v3 offset:61952
    v_mfma_f32_16x16x32_bf16 v[40:43], v[68:71], v[144:147], v[40:43]
    ds_read_b64_tr_b16 v[88:89], v4 offset:61440
    ds_read_b64_tr_b16 v[90:91], v4 offset:61952
    v_mfma_f32_16x16x32_bf16 v[44:47], v[68:71], v[148:151], v[44:47]
    ds_read_b64_tr_b16 v[92:93], v5 offset:61440
    ds_read_b64_tr_b16 v[94:95], v5 offset:61952
    v_mfma_f32_16x16x32_bf16 v[48:51], v[72:75], v[144:147], v[48:51]
    buffer_load_dwordx4 v[136:139], v18, s[20:23], s56 offen offset:2048
    v_mfma_f32_16x16x32_bf16 v[52:55], v[72:75], v[148:151], v[52:55]
    buffer_load_dwordx4 v[140:143], v18, s[20:23], s56 offen offset:2304
    v_mfma_f32_16x16x32_bf16 v[56:59], v[76:79], v[144:147], v[56:59]
    s_add_u32 m0, s30, 34816
    s_add_u32 s31, s28, 2048
    buffer_load_dwordx4 v16, s[16:19], s31 offen lds
    v_mfma_f32_16x16x32_bf16 v[60:63], v[76:79], v[148:151], v[60:63]
    s_waitcnt lgkmcnt(0)
    s_waitcnt vmcnt(19)
    v_mfma_f32_16x16x32_bf16 v[32:35], v[80:83], v[152:155], v[32:35]
    s_waitcnt vmcnt(21)
    s_barrier
    ds_read_b64_tr_b16 v[64:65], v2 offset:0
    ds_read_b64_tr_b16 v[66:67], v2 offset:512
    v_mfma_f32_16x16x32_bf16 v[36:39], v[80:83], v[156:159], v[36:39]
    ds_read_b64_tr_b16 v[68:69], v3 offset:0
    ds_read_b64_tr_b16 v[70:71], v3 offset:512
    v_mfma_f32_16x16x32_bf16 v[40:43], v[84:87], v[152:155], v[40:43]
    ds_read_b64_tr_b16 v[72:73], v4 offset:0
    ds_read_b64_tr_b16 v[74:75], v4 offset:512
    v_mfma_f32_16x16x32_bf16 v[44:47], v[84:87], v[156:159], v[44:47]
    ds_read_b64_tr_b16 v[76:77], v5 offset:0
    ds_read_b64_tr_b16 v[78:79], v5 offset:512
    v_mfma_f32_16x16x32_bf16 v[48:51], v[88:91], v[152:155], v[48:51]
    buffer_load_dwordx4 v[144:147], v14, s[20:23], s56 offen offset:0
    v_mfma_f32_16x16x32_bf16 v[52:55], v[88:91], v[156:159], v[52:55]
    buffer_load_dwordx4 v[148:151], v14, s[20:23], s56 offen offset:256
    v_mfma_f32_16x16x32_bf16 v[56:59], v[92:95], v[152:155], v[56:59]
    s_add_u32 m0, s30, 35840
    s_add_u32 s31, s28, 3072
    buffer_load_dwordx4 v17, s[16:19], s31 offen lds
    v_mfma_f32_16x16x32_bf16 v[60:63], v[92:95], v[156:159], v[60:63]
    s_add_u32 s28, s28, 16384
    s_add_u32 s32, s32, 1
    s_cmp_lt_u32 s32, 7
    s_cbranch_scc1 gemm4_kernel_loop
    v_lshrrev_b32 v22, 4, v20
    v_and_b32 v23, 1, v22
    v_lshlrev_b32 v23, 6, v23
    v_lshrrev_b32 v22, 1, v22
    v_lshl_add_u32 v23, v22, 5, v23
    v_add_u32 v23, 65536, v23
    ds_read_b128 v[176:179], v23 offset:0
    ds_read_b128 v[180:183], v23 offset:16
    ds_read_b128 v[184:187], v23 offset:128
    ds_read_b128 v[188:191], v23 offset:144
    s_nop 1
    v_permlane16_swap_b32 v32, v40
    v_permlane16_swap_b32 v33, v41
    v_permlane16_swap_b32 v34, v42
    v_permlane16_swap_b32 v35, v43
    v_permlane16_swap_b32 v48, v56
    v_permlane16_swap_b32 v49, v57
    v_permlane16_swap_b32 v50, v58
    v_permlane16_swap_b32 v51, v59
    v_permlane16_swap_b32 v36, v44
    v_permlane16_swap_b32 v37, v45
    v_permlane16_swap_b32 v38, v46
    v_permlane16_swap_b32 v39, v47
    v_permlane16_swap_b32 v52, v60
    v_permlane16_swap_b32 v53, v61
    v_permlane16_swap_b32 v54, v62
    v_permlane16_swap_b32 v55, v63
    s_waitcnt lgkmcnt(0)
    v_lshlrev_b32 v24, 16, v160
    v_and_b32 v160, 0xffff0000, v160
    v_lshlrev_b32 v25, 16, v161
    v_and_b32 v161, 0xffff0000, v161
    v_lshlrev_b32 v26, 16, v162
    v_and_b32 v162, 0xffff0000, v162
    v_lshlrev_b32 v27, 16, v163
    v_and_b32 v163, 0xffff0000, v163
    v_fma_f32 v32, v32, v176, v24
    v_fma_f32 v33, v33, v177, v160
    v_fma_f32 v34, v34, v178, v25
    v_fma_f32 v35, v35, v179, v161
    v_fma_f32 v40, v40, v180, v26
    v_fma_f32 v41, v41, v181, v162
    v_fma_f32 v42, v42, v182, v27
    v_fma_f32 v43, v43, v183, v163
    v_cvt_pk_bf16_f32 v160, v32, v33
    v_cvt_pk_bf16_f32 v161, v34, v35
    v_cvt_pk_bf16_f32 v162, v40, v41
    v_cvt_pk_bf16_f32 v163, v42, v43
    buffer_store_dwordx4 v[160:163], v10, s[24:27], 0 offen offset:0
    v_lshlrev_b32 v24, 16, v164
    v_and_b32 v164, 0xffff0000, v164
    v_lshlrev_b32 v25, 16, v165
    v_and_b32 v165, 0xffff0000, v165
    v_lshlrev_b32 v26, 16, v166
    v_and_b32 v166, 0xffff0000, v166
    v_lshlrev_b32 v27, 16, v167
    v_and_b32 v167, 0xffff0000, v167
    v_fma_f32 v48, v48, v184, v24
    v_fma_f32 v49, v49, v185, v164
    v_fma_f32 v50, v50, v186, v25
    v_fma_f32 v51, v51, v187, v165
    v_fma_f32 v56, v56, v188, v26
    v_fma_f32 v57, v57, v189, v166
    v_fma_f32 v58, v58, v190, v27
    v_fma_f32 v59, v59, v191, v167
    v_cvt_pk_bf16_f32 v164, v48, v49
    v_cvt_pk_bf16_f32 v165, v50, v51
    v_cvt_pk_bf16_f32 v166, v56, v57
    v_cvt_pk_bf16_f32 v167, v58, v59
    buffer_store_dwordx4 v[164:167], v10, s[24:27], 0 offen offset:64
    v_lshlrev_b32 v24, 16, v168
    v_and_b32 v168, 0xffff0000, v168
    v_lshlrev_b32 v25, 16, v169
    v_and_b32 v169, 0xffff0000, v169
    v_lshlrev_b32 v26, 16, v170
    v_and_b32 v170, 0xffff0000, v170
    v_lshlrev_b32 v27, 16, v171
    v_and_b32 v171, 0xffff0000, v171
    v_fma_f32 v36, v36, v176, v24
    v_fma_f32 v37, v37, v177, v168
    v_fma_f32 v38, v38, v178, v25
    v_fma_f32 v39, v39, v179, v169
    v_fma_f32 v44, v44, v180, v26
    v_fma_f32 v45, v45, v181, v170
    v_fma_f32 v46, v46, v182, v27
    v_fma_f32 v47, v47, v183, v171
    v_cvt_pk_bf16_f32 v168, v36, v37
    v_cvt_pk_bf16_f32 v169, v38, v39
    v_cvt_pk_bf16_f32 v170, v44, v45
    v_cvt_pk_bf16_f32 v171, v46, v47
    buffer_store_dwordx4 v[168:171], v11, s[24:27], 0 offen offset:0
    v_lshlrev_b32 v24, 16, v172
    v_and_b32 v172, 0xffff0000, v172
    v_lshlrev_b32 v25, 16, v173
    v_and_b32 v173, 0xffff0000, v173
    v_lshlrev_b32 v26, 16, v174
    v_and_b32 v174, 0xffff0000, v174
    v_lshlrev_b32 v27, 16, v175
    v_and_b32 v175, 0xffff0000, v175
    v_fma_f32 v52, v52, v184, v24
    v_fma_f32 v53, v53, v185, v172
    v_fma_f32 v54, v54, v186, v25
    v_fma_f32 v55, v55, v187, v173
    v_fma_f32 v60, v60, v188, v26
    v_fma_f32 v61, v61, v189, v174
    v_fma_f32 v62, v62, v190, v27
    v_fma_f32 v63, v63, v191, v175
    v_cvt_pk_bf16_f32 v172, v52, v53
    v_cvt_pk_bf16_f32 v173, v54, v55
    v_cvt_pk_bf16_f32 v174, v60, v61
    v_cvt_pk_bf16_f32 v175, v62, v63
    buffer_store_dwordx4 v[172:175], v11, s[24:27], 0 offen offset:64
gemm4_kernel_end:
    s_endpgm
.type tab_W1,@object
.p2align 8
tab_W1:
.long 0x3f803f80, 0x3f803f80, 0x3f803f80, 0x3f803f80, 0x80008000, 0x80008000, 0x80008000, 0x80008000
.long 0x3f7b3f80, 0x3f553f6d, 0x3f0e3f35, 0x3e483ec4, 0xbe488000, 0xbf0ebec4, 0xbf55bf35, 0xbf7bbf6d
.long 0x248d3f80, 0xa554bf80, 0x248d3f80, 0xa554bf80, 0xbf808000, 0x3f80a50d, 0xbf808000, 0x3f80a50d
.long 0xbe483f80, 0x3f0ebf6d, 0xbf553f35, 0x3f7bbec4, 0xbf7b8000, 0x3f553ec4, 0xbf0ebf35, 0x3e483f6d
.long 0x3f6d3f80, 0x3ec43f35, 0xbec4248d, 0xbf6dbf35, 0xbec48000, 0xbf6dbf35, 0xbf6dbf80, 0xbec4bf35
.long 0x3f553f80, 0xbe483ec4, 0xbf7bbf35, 0xbf0ebf6d, 0xbf0e8000, 0xbf7bbf6d, 0xbe48bf35, 0x3f553ec4
.long 0xbec43f80, 0x3f6dbf35, 0xbf6d248d, 0x3ec43f35, 0xbf6d8000, 0x3ec43f35, 0x3ec4bf80, 0xbf6d3f35
.long 0xbf0e3f80, 0x3f7bbec4, 0xbe48bf35, 0xbf553f6d, 0xbf558000, 0xbe483f6d, 0x3f7bbf35, 0xbf0ebec4
.long 0x3f353f80, 0xbf35248d, 0xbf35bf80, 0x3f35a554, 0xbf358000, 0xbf35bf80, 0x3f35a50d, 0x3f353f80
.long 0x3f0e3f80, 0xbf7bbec4, 0x3e48bf35, 0x3f553f6d, 0xbf558000, 0xbe48bf6d, 0x3f7b3f35, 0xbf0e3ec4
.long 0xbf353f80, 0x3f35a554, 0x3f35bf80, 0xbf35248d, 0xbf358000, 0xbf353f80, 0x3f35a50d, 0x3f35bf80
.long 0xbf553f80, 0x3e483ec4, 0x3f7bbf35, 0x3f0ebf6d, 0xbf0e8000, 0xbf7b3f6d, 0xbe483f35, 0x3f55bec4
.long 0x3ec43f80, 0xbf6dbf35, 0x3f6da554, 0xbec43f35, 0xbf6d8000, 0x3ec4bf35, 0x3ec43f80, 0xbf6dbf35
.long 0x3e483f80, 0xbf0ebf6d, 0x3f553f35, 0xbf7bbec4, 0xbf7b8000, 0x3f55bec4, 0xbf0e3f35, 0x3e48bf6d
.long 0xbf6d3f80, 0xbec43f35, 0x3ec4a554, 0x3f6dbf35, 0xbec48000, 0xbf6d3f35, 0xbf6d3f80, 0xbec43f35
.long 0xbf7b3f80, 0xbf553f6d, 0xbf0e3f35, 0xbe483ec4, 0xbe488000, 0xbf0e3ec4, 0xbf553f35, 0xbf7b3f6d
.long 0x3f803f80, 0x3f803f80, 0x3f803f80, 0x3f803f80, 0x80008000, 0x80008000, 0x80008000, 0x80008000
.long 0xbe48248d, 0xbf0ebec4, 0xbf55bf35, 0xbf7bbf6d, 0xbf7bbf80, 0xbf55bf6d, 0xbf0ebf35, 0xbe48bec4
.long 0x248d3f80, 0xa554bf80, 0x248d3f80, 0xa554bf80, 0xbf808000, 0x3f80a50d, 0xbf808000, 0x3f80a50d
.long 0xbf7b248d, 0x3f553ec4, 0xbf0ebf35, 0x3e483f6d, 0x3e48bf80, 0xbf0e3f6d, 0x3f55bf35, 0xbf7b3ec4
.long 0xbf6dbf80, 0xbec4bf35, 0x3ec4a554, 0x3f6d3f35, 0x3ec4a50d, 0x3f6d3f35, 0x3f6d3f80, 0x3ec43f35
.long 0x3f0ea554, 0x3f7b3f6d, 0x3e483f35, 0xbf55bec4, 0x3f553f80, 0xbe483ec4, 0xbf7bbf35, 0xbf0ebf6d
.long 0x3ec4bf80, 0xbf6d3f35, 0x3f6da554, 0xbec4bf35, 0x3f6da50d, 0xbec4bf35, 0xbec43f80, 0x3f6dbf35
.long 0x3f55a554, 0x3e48bf6d, 0xbf7b3f35, 0x3f0e3ec4, 0xbf0e3f80, 0x3f7bbec4, 0xbe48bf35, 0xbf553f6d
.long 0x3f353f80, 0xbf35248d, 0xbf35bf80, 0x3f35a554, 0xbf358000, 0xbf35bf80, 0x3f35a50d, 0x3f353f80
.long 0xbf55248d, 0xbe48bf6d, 0x3f7b3f35, 0xbf0e3ec4, 0xbf0ebf80, 0x3f7b3ec4, 0xbe483f35, 0xbf55bf6d
.long 0xbf353f80, 0x3f35a554, 0x3f35bf80, 0xbf35248d, 0xbf358000, 0xbf353f80, 0x3f35a50d, 0x3f35bf80
.long 0xbf0e248d, 0xbf7b3f6d, 0xbe483f35, 0x3f55bec4, 0x3f55bf80, 0xbe48bec4, 0xbf7b3f35, 0xbf0e3f6d
.long 0xbec4bf80, 0x3f6d3f35, 0xbf6d248d, 0x3ec4bf35, 0x3f6da50d, 0xbec43f35, 0xbec4bf80, 0x3f6d3f35
.long 0x3f7ba554, 0xbf553ec4, 0x3f0ebf35, 0xbe483f6d, 0x3e483f80, 0xbf0ebf6d, 0x3f553f35, 0xbf7bbec4
.long 0x3f6dbf80, 0x3ec4bf35, 0xbec4248d, 0xbf6d3f35, 0x3ec4a50d, 0x3f6dbf35, 0x3f6dbf80, 0x3ec4bf35
.long 0x3e48a554, 0x3f0ebec4, 0x3f55bf35, 0x3f7bbf6d, 0xbf7b3f80, 0xbf553f6d, 0xbf0e3f35, 0xbe483ec4
.long 0x3f803f80, 0x3f803f80, 0x3f803f80, 0x3f803f80, 0x80008000, 0x80008000, 0x80008000, 0x80008000
.long 0xbf7bbf80, 0xbf55bf6d, 0xbf0ebf35, 0xbe48bec4, 0x3e48a50d, 0x3f0e3ec4, 0x3f553f35, 0x3f7b3f6d
.long 0x248d3f80, 0xa554bf80, 0x248d3f80, 0xa554bf80, 0xbf808000, 0x3f80a50d, 0xbf808000, 0x3f80a50d
.long 0x3e48bf80, 0xbf0e3f6d, 0x3f55bf35, 0xbf7b3ec4, 0x3f7ba50d, 0xbf55bec4, 0x3f0e3f35, 0xbe48bf6d
.long 0x3f6d3f80, 0x3ec43f35, 0xbec4248d, 0xbf6dbf35, 0xbec48000, 0xbf6dbf35, 0xbf6dbf80, 0xbec4bf35
.long 0xbf55bf80, 0x3e48bec4, 0x3f7b3f35, 0x3f0e3f6d, 0x3f0ea50d, 0x3f7b3f6d, 0x3e483f35, 0xbf55bec4
.long 0xbec43f80, 0x3f6dbf35, 0xbf6d248d, 0x3ec43f35, 0xbf6d8000, 0x3ec43f35, 0x3ec4bf80, 0xbf6d3f35
.long 0x3f0ebf80, 0xbf7b3ec4, 0x3e483f35, 0x3f55bf6d, 0x3f55a50d, 0x3e48bf6d, 0xbf7b3f35, 0x3f0e3ec4
.long 0x3f353f80, 0xbf35248d, 0xbf35bf80, 0x3f35a554, 0xbf358000, 0xbf35bf80, 0x3f35a50d, 0x3f353f80
.long 0xbf0ebf80, 0x3f7b3ec4, 0xbe483f35, 0xbf55bf6d, 0x3f55a50d, 0x3e483f6d, 0xbf7bbf35, 0x3f0ebec4
.long 0xbf353f80, 0x3f35a554, 0x3f35bf80, 0xbf35248d, 0xbf358000, 0xbf353f80, 0x3f35a50d, 0x3f35bf80
.long 0x3f55bf80, 0xbe48bec4, 0xbf7b3f35, 0xbf0e3f6d, 0x3f0ea50d, 0x3f7bbf6d, 0x3e48bf35, 0xbf553ec4
.long 0x3ec43f80, 0xbf6dbf35, 0x3f6da554, 0xbec43f35, 0xbf6d8000, 0x3ec4bf35, 0x3ec43f80, 0xbf6dbf35
.long 0xbe48bf80, 0x3f0e3f6d, 0xbf55bf35, 0x3f7b3ec4, 0x3f7ba50d, 0xbf553ec4, 0x3f0ebf35, 0xbe483f6d
.long 0xbf6d3f80, 0xbec43f35, 0x3ec4a554, 0x3f6dbf35, 0xbec48000, 0xbf6d3f35, 0xbf6d3f80, 0xbec43f35
.long 0x3f7bbf80, 0x3f55bf6d, 0x3f0ebf35, 0x3e48bec4, 0x3e48a50d, 0x3f0ebec4, 0x3f55bf35, 0x3f7bbf6d
.long 0x3f803f80, 0x3f803f80, 0x3f803f80, 0x3f803f80, 0x80008000, 0x80008000, 0x80008000, 0x80008000
.long 0x3e48a554, 0x3f0e3ec4, 0x3f553f35, 0x3f7b3f6d, 0x3f7b3f80, 0x3f553f6d, 0x3f0e3f35, 0x3e483ec4
.long 0x248d3f80, 0xa554bf80, 0x248d3f80, 0xa554bf80, 0xbf808000, 0x3f80a50d, 0xbf808000, 0x3f80a50d
.long 0x3f7ba554, 0xbf55bec4, 0x3f0e3f35, 0xbe48bf6d, 0xbe483f80, 0x3f0ebf6d, 0xbf553f35, 0x3f7bbec4
.long 0xbf6dbf80, 0xbec4bf35, 0x3ec4a554, 0x3f6d3f35, 0x3ec4a50d, 0x3f6d3f35, 0x3f6d3f80, 0x3ec43f35
.long 0xbf0e248d, 0xbf7bbf6d, 0xbe48bf35, 0x3f553ec4, 0xbf55bf80, 0x3e48bec4, 0x3f7b3f35, 0x3f0e3f6d
.long 0x3ec4bf80, 0xbf6d3f35, 0x3f6da554, 0xbec4bf35, 0x3f6da50d, 0xbec4bf35, 0xbec43f80, 0x3f6dbf35
.long 0xbf55248d, 0xbe483f6d, 0x3f7bbf35, 0xbf0ebec4, 0x3f0ebf80, 0xbf7b3ec4, 0x3e483f35, 0x3f55bf6d
.long 0x3f353f80, 0xbf35248d, 0xbf35bf80, 0x3f35a554, 0xbf358000, 0xbf35bf80, 0x3f35a50d, 0x3f353f80
.long 0x3f55a554, 0x3e483f6d, 0xbf7bbf35, 0x3f0ebec4, 0x3f0e3f80, 0xbf7bbec4, 0x3e48bf35, 0x3f553f6d
.long 0xbf353f80, 0x3f35a554, 0x3f35bf80, 0xbf35248d, 0xbf358000, 0xbf353f80, 0x3f35a50d, 0x3f35bf80
.long 0x3f0ea554, 0x3f7bbf6d, 0x3e48bf35, 0xbf553ec4, 0xbf553f80, 0x3e483ec4, 0x3f7bbf35, 0x3f0ebf6d
.long 0xbec4bf80, 0x3f6d3f35, 0xbf6d248d, 0x3ec4bf35, 0x3f6da50d, 0xbec43f35, 0xbec4bf80, 0x3f6d3f35
.long 0xbf7b248d, 0x3f55bec4, 0xbf0e3f35, 0x3e48bf6d, 0xbe48bf80, 0x3f0e3f6d, 0xbf55bf35, 0x3f7b3ec4
.long 0x3f6dbf80, 0x3ec4bf35, 0xbec4248d, 0xbf6d3f35, 0x3ec4a50d, 0x3f6dbf35, 0x3f6dbf80, 0x3ec4bf35
.long 0xbe48248d, 0xbf0e3ec4, 0xbf553f35, 0xbf7b3f6d, 0x3f7bbf80, 0x3f55bf6d, 0x3f0ebf35, 0x3e48bec4
.long 0xbf803f80, 0xbf803f80, 0xbf803f80, 0xbf803f80, 0xa50d8000, 0xa50d8000, 0xa50d8000, 0xa50d8000
.long 0xbf7b3f80, 0xbf553f6d, 0xbf0e3f35, 0xbe483ec4, 0x3e488000, 0x3f0ebec4, 0x3f55bf35, 0x3f7bbf6d
.long 0xa5543f80, 0x248dbf80, 0xa5543f80, 0x248dbf80, 0x3f808000, 0xbf80a50d, 0x3f808000, 0xbf80a50d
.long 0x3e483f80, 0xbf0ebf6d, 0x3f553f35, 0xbf7bbec4, 0x3f7b8000, 0xbf553ec4, 0x3f0ebf35, 0xbe483f6d
.long 0xbf6d3f80, 0xbec43f35, 0x3ec4248d, 0x3f6dbf35, 0x3ec48000, 0x3f6dbf35, 0x3f6dbf80, 0x3ec4bf35
.long 0xbf553f80, 0x3e483ec4, 0x3f7bbf35, 0x3f0ebf6d, 0x3f0e8000, 0x3f7bbf6d, 0x3e48bf35, 0xbf553ec4
.long 0x3ec43f80, 0xbf6dbf35, 0x3f6d248d, 0xbec43f35, 0x3f6d8000, 0xbec43f35, 0xbec4bf80, 0x3f6d3f35
.long 0x3f0e3f80, 0xbf7bbec4, 0x3e48bf35, 0x3f553f6d, 0x3f558000, 0x3e483f6d, 0xbf7bbf35, 0x3f0ebec4
.long 0xbf353f80, 0x3f35248d, 0x3f35bf80, 0xbf35a554, 0x3f358000, 0x3f35bf80, 0xbf35a50d, 0xbf353f80
.long 0xbf0e3f80, 0x3f7bbec4, 0xbe48bf35, 0xbf553f6d, 0x3f558000, 0x3e48bf6d, 0xbf7b3f35, 0x3f0e3ec4
.long 0x3f353f80, 0xbf35a554, 0xbf35bf80, 0x3f35248d, 0x3f358000, 0x3f353f80, 0xbf35a50d, 0xbf35bf80
.long 0x3f553f80, 0xbe483ec4, 0xbf7bbf35, 0xbf0ebf6d, 0x3f0e8000, 0x3f7b3f6d, 0x3e483f35, 0xbf55bec4
.long 0xbec43f80, 0x3f6dbf35, 0xbf6da554, 0x3ec43f35, 0x3f6d8000, 0xbec4bf35, 0xbec43f80, 0x3f6dbf35
.long 0xbe483f80, 0x3f0ebf6d, 0xbf553f35, 0x3f7bbec4, 0x3f7b8000, 0xbf55bec4, 0x3f0e3f35, 0xbe48bf6d
.long 0x3f6d3f80, 0x3ec43f35, 0xbec4a554, 0xbf6dbf35, 0x3ec48000, 0x3f6d3f35, 0x3f6d3f80, 0x3ec43f35
.long 0x3f7b3f80, 0x3f553f6d, 0x3f0e3f35, 0x3e483ec4, 0x3e488000, 0x3f0e3ec4, 0x3f553f35, 0x3f7b3f6d
.long 0xbf803f80, 0xbf803f80, 0xbf803f80, 0xbf803f80, 0xa50d8000, 0xa50d8000, 0xa50d8000, 0xa50d8000
.long 0x3e48248d, 0x3f0ebec4, 0x3f55bf35, 0x3f7bbf6d, 0x3f7bbf80, 0x3f55bf6d, 0x3f0ebf35, 0x3e48bec4
.long 0xa5543f80, 0x248dbf80, 0xa5543f80, 0x248dbf80, 0x3f808000, 0xbf80a50d, 0x3f808000, 0xbf80a50d
.long 0x3f7b248d, 0xbf553ec4, 0x3f0ebf35, 0xbe483f6d, 0xbe48bf80, 0x3f0e3f6d, 0xbf55bf35, 0x3f7b3ec4
.long 0x3f6dbf80, 0x3ec4bf35, 0xbec4a554, 0xbf6d3f35, 0xbec4a50d, 0xbf6d3f35, 0xbf6d3f80, 0xbec43f35
.long 0xbf0ea554, 0xbf7b3f6d, 0xbe483f35, 0x3f55bec4, 0xbf553f80, 0x3e483ec4, 0x3f7bbf35, 0x3f0ebf6d
.long 0xbec4bf80, 0x3f6d3f35, 0xbf6da554, 0x3ec4bf35, 0xbf6da50d, 0x3ec4bf35, 0x3ec43f80, 0xbf6dbf35
.long 0xbf55a554, 0xbe48bf6d, 0x3f7b3f35, 0xbf0e3ec4, 0x3f0e3f80, 0xbf7bbec4, 0x3e48bf35, 0x3f553f6d
.long 0xbf353f80, 0x3f35248d, 0x3f35bf80, 0xbf35a554, 0x3f358000, 0x3f35bf80, 0xbf35a50d, 0xbf353f80
.long 0x3f55248d, 0x3e48bf6d, 0xbf7b3f35, 0x3f0e3ec4, 0x3f0ebf80, 0xbf7b3ec4, 0x3e483f35, 0x3f55bf6d
.long 0x3f353f80, 0xbf35a554, 0xbf35bf80, 0x3f35248d, 0x3f358000, 0x3f353f80, 0xbf35a50d, 0xbf35bf80
.long 0x3f0e248d, 0x3f7b3f6d, 0x3e483f35, 0xbf55bec4, 0xbf55bf80, 0x3e48bec4, 0x3f7b3f35, 0x3f0e3f6d
.long 0x3ec4bf80, 0xbf6d3f35, 0x3f6d248d, 0xbec4bf35, 0xbf6da50d, 0x3ec43f35, 0x3ec4bf80, 0xbf6d3f35
.long 0xbf7ba554, 0x3f553ec4, 0xbf0ebf35, 0x3e483f6d, 0xbe483f80, 0x3f0ebf6d, 0xbf553f35, 0x3f7bbec4
.long 0xbf6dbf80, 0xbec4bf35, 0x3ec4248d, 0x3f6d3f35, 0xbec4a50d, 0xbf6dbf35, 0xbf6dbf80, 0xbec4bf35
.long 0xbe48a554, 0xbf0ebec4, 0xbf55bf35, 0xbf7bbf6d, 0x3f7b3f80, 0x3f553f6d, 0x3f0e3f35, 0x3e483ec4
.long 0xbf803f80, 0xbf803f80, 0xbf803f80, 0xbf803f80, 0xa50d8000, 0xa50d8000, 0xa50d8000, 0xa50d8000
.long 0x3f7bbf80, 0x3f55bf6d, 0x3f0ebf35, 0x3e48bec4, 0xbe48a50d, 0xbf0e3ec4, 0xbf553f35, 0xbf7b3f6d
.long 0xa5543f80, 0x248dbf80, 0xa5543f80, 0x248dbf80, 0x3f808000, 0xbf80a50d, 0x3f808000, 0xbf80a50d
.long 0xbe48bf80, 0x3f0e3f6d, 0xbf55bf35, 0x3f7b3ec4, 0xbf7ba50d, 0x3f55bec4, 0xbf0e3f35, 0x3e48bf6d
.long 0xbf6d3f80, 0xbec43f35, 0x3ec4248d, 0x3f6dbf35, 0x3ec48000, 0x3f6dbf35, 0x3f6dbf80, 0x3ec4bf35
.long 0x3f55bf80, 0xbe48bec4, 0xbf7b3f35, 0xbf0e3f6d, 0xbf0ea50d, 0xbf7b3f6d, 0xbe483f35, 0x3f55bec4
.long 0x3ec43f80, 0xbf6dbf35, 0x3f6d248d, 0xbec43f35, 0x3f6d8000, 0xbec43f35, 0xbec4bf80, 0x3f6d3f35
.long 0xbf0ebf80, 0x3f7b3ec4, 0xbe483f35, 0xbf55bf6d, 0xbf55a50d, 0xbe48bf6d, 0x3f7b3f35, 0xbf0e3ec4
.long 0xbf353f80, 0x3f35248d, 0x3f35bf80, 0xbf35a554, 0x3f358000, 0x3f35bf80, 0xbf35a50d, 0xbf353f80
.long 0x3f0ebf80, 0xbf7b3ec4, 0x3e483f35, 0x3f55bf6d, 0xbf55a50d, 0xbe483f6d, 0x3f7bbf35, 0xbf0ebec4
.long 0x3f353f80, 0xbf35a554, 0xbf35bf80, 0x3f35248d, 0x3f358000, 0x3f353f80, 0xbf35a50d, 0xbf35bf80
.long 0xbf55bf80, 0x3e48bec4, 0x3f7b3f35, 0x3f0e3f6d, 0xbf0ea50d, 0xbf7bbf6d, 0xbe48bf35, 0x3f553ec4
.long 0xbec43f80, 0x3f6dbf35, 0xbf6da554, 0x3ec43f35, 0x3f6d8000, 0xbec4bf35, 0xbec43f80, 0x3f6dbf35
.long 0x3e48bf80, 0xbf0e3f6d, 0x3f55bf35, 0xbf7b3ec4, 0xbf7ba50d, 0x3f553ec4, 0xbf0ebf35, 0x3e483f6d
.long 0x3f6d3f80, 0x3ec43f35, 0xbec4a554, 0xbf6dbf35, 0x3ec48000, 0x3f6d3f35, 0x3f6d3f80, 0x3ec43f35
.long 0xbf7bbf80, 0xbf55bf6d, 0xbf0ebf35, 0xbe48bec4, 0xbe48a50d, 0xbf0ebec4, 0xbf55bf35, 0xbf7bbf6d
.long 0xbf803f80, 0xbf803f80, 0xbf803f80, 0xbf803f80, 0xa50d8000, 0xa50d8000, 0xa50d8000, 0xa50d8000
.long 0xbe48a554, 0xbf0e3ec4, 0xbf553f35, 0xbf7b3f6d, 0xbf7b3f80, 0xbf553f6d, 0xbf0e3f35, 0xbe483ec4
.long 0xa5543f80, 0x248dbf80, 0xa5543f80, 0x248dbf80, 0x3f808000, 0xbf80a50d, 0x3f808000, 0xbf80a50d
.long 0xbf7ba554, 0x3f55bec4, 0xbf0e3f35, 0x3e48bf6d, 0x3e483f80, 0xbf0ebf6d, 0x3f553f35, 0xbf7bbec4
.long 0x3f6dbf80, 0x3ec4bf35, 0xbec4a554, 0xbf6d3f35, 0xbec4a50d, 0xbf6d3f35, 0xbf6d3f80, 0xbec43f35
.long 0x3f0e248d, 0x3f7bbf6d, 0x3e48bf35, 0xbf553ec4, 0x3f55bf80, 0xbe48bec4, 0xbf7b3f35, 0xbf0e3f6d
.long 0xbec4bf80, 0x3f6d3f35, 0xbf6da554, 0x3ec4bf35, 0xbf6da50d, 0x3ec4bf35, 0x3ec43f80, 0xbf6dbf35
.long 0x3f55248d, 0x3e483f6d, 0xbf7bbf35, 0x3f0ebec4, 0xbf0ebf80, 0x3f7b3ec4, 0xbe483f35, 0xbf55bf6d
.long 0xbf353f80, 0x3f35248d, 0x3f35bf80, 0xbf35a554, 0x3f358000, 0x3f35bf80, 0xbf35a50d, 0xbf353f80
.long 0xbf55a554, 0xbe483f6d, 0x3f7bbf35, 0xbf0ebec4, 0xbf0e3f80, 0x3f7bbec4, 0xbe48bf35, 0xbf553f6d
.long 0x3f353f80, 0xbf35a554, 0xbf35bf80, 0x3f35248d, 0x3f358000, 0x3f353f80, 0xbf35a50d, 0xbf35bf80
.long 0xbf0ea554, 0xbf7bbf6d, 0xbe48bf35, 0x3f553ec4, 0x3f553f80, 0xbe483ec4, 0xbf7bbf35, 0xbf0ebf6d
.long 0x3ec4bf80, 0xbf6d3f35, 0x3f6d248d, 0xbec4bf35, 0xbf6da50d, 0x3ec43f35, 0x3ec4bf80, 0xbf6d3f35
.long 0x3f7b248d, 0xbf55bec4, 0x3f0e3f35, 0xbe48bf6d, 0x3e48bf80, 0xbf0e3f6d, 0x3f55bf35, 0xbf7b3ec4
.long 0xbf6dbf80, 0xbec4bf35, 0x3ec4248d, 0x3f6d3f35, 0xbec4a50d, 0xbf6dbf35, 0xbf6dbf80, 0xbec4bf35
.long 0x3e48248d, 0x3f0e3ec4, 0x3f553f35, 0x3f7b3f6d, 0xbf7bbf80, 0xbf55bf6d, 0xbf0ebf35, 0xbe48bec4
.long 0x00003f80, 0x00003f80, 0x00003f80, 0x00003f80, 0x00003f80, 0x3dc93f7f, 0x3e483f7b, 0x3e953f75
.long 0x00003f80, 0x3e483f7b, 0x3ec43f6d, 0x3f0e3f55, 0x00003f80, 0x3e953f75, 0x3f0e3f55, 0x3f463f22
.long 0x00003f80, 0x3ec43f6d, 0x3f353f35, 0x3f6d3ec4, 0x00003f80, 0x3ef13f62, 0x3f553f0e, 0x3f7f3dc9
.long 0x00003f80, 0x3f0e3f55, 0x3f6d3ec4, 0x3f7bbe48, 0x00003f80, 0x3f223f46, 0x3f7b3e48, 0x3f62bef1
.long 0x00003f80, 0x3f353f35, 0x3f80248d, 0x3f35bf35, 0x00003f80, 0x3f463f22, 0x3f7bbe48, 0x3ef1bf62
.long 0x00003f80, 0x3f553f0e, 0x3f6dbec4, 0x3e48bf7b, 0x00003f80, 0x3f623ef1, 0x3f55bf0e, 0xbdc9bf7f
.long 0x00003f80, 0x3f6d3ec4, 0x3f35bf35, 0xbec4bf6d, 0x00003f80, 0x3f753e95, 0x3f0ebf55, 0xbf22bf46
.long 0x00003f80, 0x3f7b3e48, 0x3ec4bf6d, 0xbf55bf0e, 0x00003f80, 0x3f7f3dc9, 0x3e48bf7b, 0xbf75be95
.long 0x3f808000, 0x3f808000, 0x3f808000, 0x3f808000, 0x3f808000, 0x3f7fbdc9, 0x3f7bbe48, 0x3f75be95
.long 0x3f808000, 0x3f7bbe48, 0x3f6dbec4, 0x3f55bf0e, 0x3f808000, 0x3f75be95, 0x3f55bf0e, 0x3f22bf46
.long 0x3f808000, 0x3f6dbec4, 0x3f35bf35, 0x3ec4bf6d, 0x3f808000, 0x3f62bef1, 0x3f0ebf55, 0x3dc9bf7f
.long 0x3f808000, 0x3f55bf0e, 0x3ec4bf6d, 0xbe48bf7b, 0x3f808000, 0x3f46bf22, 0x3e48bf7b, 0xbef1bf62
.long 0x3f808000, 0x3f35bf35, 0x248dbf80, 0xbf35bf35, 0x3f808000, 0x3f22bf46, 0xbe48bf7b, 0xbf62bef1
.long 0x3f808000, 0x3f0ebf55, 0xbec4bf6d, 0xbf7bbe48, 0x3f808000, 0x3ef1bf62, 0xbf0ebf55, 0xbf7f3dc9
.long 0x3f808000, 0x3ec4bf6d, 0xbf35bf35, 0xbf6d3ec4, 0x3f808000, 0x3e95bf75, 0xbf55bf0e, 0xbf463f22
.long 0x3f808000, 0x3e48bf7b, 0xbf6dbec4, 0xbf0e3f55, 0x3f808000, 0x3dc9bf7f, 0xbf7bbe48, 0xbe953f75
.long 0x00003f80, 0x00003f80, 0x00003f80, 0x00003f80, 0x3ec43f6d, 0x3ef13f62, 0x3f0e3f55, 0x3f223f46
.long 0x3f353f35, 0x3f553f0e, 0x3f6d3ec4, 0x3f7b3e48, 0x3f6d3ec4, 0x3f7f3dc9, 0x3f7bbe48, 0x3f62bef1
.long 0x3f80248d, 0x3f6dbec4, 0x3f35bf35, 0x3ec4bf6d, 0x3f6dbec4, 0x3f22bf46, 0x3e48bf7b, 0xbe95bf75
.long 0x3f35bf35, 0x3e48bf7b, 0xbec4bf6d, 0xbf55bf0e, 0x3ec4bf6d, 0xbe95bf75, 0xbf55bf0e, 0xbf7f3dc9
.long 0x250dbf80, 0xbf35bf35, 0xbf80a554, 0xbf353f35, 0xbec4bf6d, 0xbf75be95, 0xbf553f0e, 0xbdc93f7f
.long 0xbf35bf35, 0xbf7b3e48, 0xbec43f6d, 0x3f0e3f55, 0xbf6dbec4, 0xbf463f22, 0x3e483f7b, 0x3f753e95
.long 0xbf80a554, 0xbec43f6d, 0x3f353f35, 0x3f6dbec4, 0xbf6d3ec4, 0x3dc93f7f, 0x3f7b3e48, 0x3ef1bf62
.long 0xbf353f35, 0x3f0e3f55, 0x3f6dbec4, 0xbe48bf7b, 0xbec43f6d, 0x3f623ef1, 0x3f0ebf55, 0xbf46bf22
.long 0x3f808000, 0x3f808000, 0x3f808000, 0x3f808000, 0x3f6dbec4, 0x3f62bef1, 0x3f55bf0e, 0x3f46bf22
.long 0x3f35bf35, 0x3f0ebf55, 0x3ec4bf6d, 0x3e48bf7b, 0x3ec4bf6d, 0x3dc9bf7f, 0xbe48bf7b, 0xbef1bf62
.long 0x248dbf80, 0xbec4bf6d, 0xbf35bf35, 0xbf6dbec4, 0xbec4bf6d, 0xbf46bf22, 0xbf7bbe48, 0xbf753e95
.long 0xbf35bf35, 0xbf7bbe48, 0xbf6d3ec4, 0xbf0e3f55, 0xbf6dbec4, 0xbf753e95, 0xbf0e3f55, 0x3dc93f7f
.long 0xbf80a50d, 0xbf353f35, 0xa5543f80, 0x3f353f35, 0xbf6d3ec4, 0xbe953f75, 0x3f0e3f55, 0x3f7f3dc9
.long 0xbf353f35, 0x3e483f7b, 0x3f6d3ec4, 0x3f55bf0e, 0xbec43f6d, 0x3f223f46, 0x3f7bbe48, 0x3e95bf75
.long 0xa5543f80, 0x3f6d3ec4, 0x3f35bf35, 0xbec4bf6d, 0x3ec43f6d, 0x3f7fbdc9, 0x3e48bf7b, 0xbf62bef1
.long 0x3f353f35, 0x3f55bf0e, 0xbec4bf6d, 0xbf7b3e48, 0x3f6d3ec4, 0x3ef1bf62, 0xbf55bf0e, 0xbf223f46
.long 0x00003f80, 0x00003f80, 0x00003f80, 0x00003f80, 0x3f353f35, 0x3f463f22, 0x3f553f0e, 0x3f623ef1
.long 0x3f80248d, 0x3f7bbe48, 0x3f6dbec4, 0x3f55bf0e, 0x3f35bf35, 0x3ef1bf62, 0x3e48bf7b, 0xbdc9bf7f
.long 0x250dbf80, 0xbec4bf6d, 0xbf35bf35, 0xbf6dbec4, 0xbf35bf35, 0xbf75be95, 0xbf7b3e48, 0xbf463f22
.long 0xbf80a554, 0xbf553f0e, 0xbec43f6d, 0x3e483f7b, 0xbf353f35, 0xbdc93f7f, 0x3f0e3f55, 0x3f753e95
.long 0x00003f80, 0x3f353f35, 0x3f80248d, 0x3f35bf35, 0x3f353f35, 0x3f7fbdc9, 0x3f0ebf55, 0xbe95bf75
.long 0x3f80248d, 0x3f0ebf55, 0xbec4bf6d, 0xbf7bbe48, 0x3f35bf35, 0xbe95bf75, 0xbf7bbe48, 0xbf223f46
.long 0x250dbf80, 0xbf6dbec4, 0xbf353f35, 0x3ec43f6d, 0xbf35bf35, 0xbf623ef1, 0x3e483f7b, 0x3f7f3dc9
.long 0xbf80a554, 0xbe483f7b, 0x3f6d3ec4, 0x3f0ebf55, 0xbf353f35, 0x3f223f46, 0x3f55bf0e, 0xbef1bf62
.long 0x3f808000, 0x3f808000, 0x3f808000, 0x3f808000, 0x3f35bf35, 0x3f22bf46, 0x3f0ebf55, 0x3ef1bf62
.long 0x248dbf80, 0xbe48bf7b, 0xbec4bf6d, 0xbf0ebf55, 0xbf35bf35, 0xbf62bef1, 0xbf7bbe48, 0xbf7f3dc9
.long 0xbf80a50d, 0xbf6d3ec4, 0xbf353f35, 0xbec43f6d, 0xbf353f35, 0xbe953f75, 0x3e483f7b, 0x3f223f46
.long 0xa5543f80, 0x3f0e3f55, 0x3f6d3ec4, 0x3f7bbe48, 0x3f353f35, 0x3f7f3dc9, 0x3f55bf0e, 0x3e95bf75
.long 0x3f808000, 0x3f35bf35, 0x248dbf80, 0xbf35bf35, 0x3f35bf35, 0xbdc9bf7f, 0xbf55bf0e, 0xbf753e95
.long 0x248dbf80, 0xbf55bf0e, 0xbf6d3ec4, 0xbe483f7b, 0xbf35bf35, 0xbf753e95, 0xbe483f7b, 0x3f463f22
.long 0xbf80a50d, 0xbec43f6d, 0x3f353f35, 0x3f6dbec4, 0xbf353f35, 0x3ef13f62, 0x3f7bbe48, 0x3dc9bf7f
.long 0xa5543f80, 0x3f7b3e48, 0x3ec4bf6d, 0xbf55bf0e, 0x3f353f35, 0x3f46bf22, 0xbf0ebf55, 0xbf623ef1
.long 0x00003f80, 0x00003f80, 0x00003f80, 0x00003f80, 0x3f6d3ec4, 0x3f753e95, 0x3f7b3e48, 0x3f7f3dc9
.long 0x3f35bf35, 0x3f0ebf55, 0x3ec4bf6d, 0x3e48bf7b, 0xbec4bf6d, 0xbf22bf46, 0xbf55bf0e, 0xbf75be95
.long 0xbf80a554, 0xbf6d3ec4, 0xbf353f35, 0xbec43f6d, 0xbec43f6d, 0x3dc93f7f, 0x3f0e3f55, 0x3f623ef1
.long 0x3f353f35, 0x3f7b3e48, 0x3f6dbec4, 0x3f0ebf55, 0x3f6dbec4, 0x3ef1bf62, 0xbe48bf7b, 0xbf46bf22
.long 0x250dbf80, 0xbf35bf35, 0xbf80a554, 0xbf353f35, 0xbf6dbec4, 0xbf623ef1, 0xbe483f7b, 0x3f223f46
.long 0xbf353f35, 0x3e483f7b, 0x3f6d3ec4, 0x3f55bf0e, 0x3ec43f6d, 0x3f7f3dc9, 0x3f0ebf55, 0xbef1bf62
.long 0x3f80248d, 0x3ec4bf6d, 0xbf35bf35, 0xbf6d3ec4, 0x3ec4bf6d, 0xbf46bf22, 0xbf553f0e, 0x3e953f75
.long 0xbf35bf35, 0xbf553f0e, 0x3ec43f6d, 0x3f7bbe48, 0xbf6d3ec4, 0x3e953f75, 0x3f7bbe48, 0xbdc9bf7f
.long 0x3f808000, 0x3f808000, 0x3f808000, 0x3f808000, 0x3ec4bf6d, 0x3e95bf75, 0x3e48bf7b, 0x3dc9bf7f
.long 0xbf35bf35, 0xbf55bf0e, 0xbf6dbec4, 0xbf7bbe48, 0xbf6d3ec4, 0xbf463f22, 0xbf0e3f55, 0xbe953f75
.long 0xa5543f80, 0x3ec43f6d, 0x3f353f35, 0x3f6d3ec4, 0x3f6d3ec4, 0x3f7fbdc9, 0x3f55bf0e, 0x3ef1bf62
.long 0x3f35bf35, 0x3e48bf7b, 0xbec4bf6d, 0xbf55bf0e, 0xbec4bf6d, 0xbf62bef1, 0xbf7b3e48, 0xbf223f46
.long 0xbf80a50d, 0xbf353f35, 0xa5543f80, 0x3f353f35, 0xbec43f6d, 0x3ef13f62, 0x3f7b3e48, 0x3f46bf22
.long 0x3f353f35, 0x3f7bbe48, 0x3ec4bf6d, 0xbf0ebf55, 0x3f6dbec4, 0x3dc9bf7f, 0xbf55bf0e, 0xbf623ef1
.long 0x248dbf80, 0xbf6dbec4, 0xbf353f35, 0x3ec43f6d, 0xbf6dbec4, 0xbf223f46, 0x3f0e3f55, 0x3f75be95
.long 0xbf353f35, 0x3f0e3f55, 0x3f6dbec4, 0xbe48bf7b, 0x3ec43f6d, 0x3f75be95, 0xbe48bf7b, 0xbf7f3dc9
.long 0x00003f80, 0x00003f80, 0x00003f80, 0x00003f80, 0x3f80248d, 0x3f7fbdc9, 0x3f7bbe48, 0x3f75be95
.long 0x250dbf80, 0xbe48bf7b, 0xbec4bf6d, 0xbf0ebf55, 0xbf80a554, 0xbf753e95, 0xbf553f0e, 0xbf223f46
.long 0x00003f80, 0x3ec43f6d, 0x3f353f35, 0x3f6d3ec4, 0x3f80248d, 0x3f62bef1, 0x3f0ebf55, 0x3dc9bf7f
.long 0x250dbf80, 0xbf0ebf55, 0xbf6dbec4, 0xbf7b3e48, 0xbf80a554, 0xbf463f22, 0xbe483f7b, 0x3ef13f62
.long 0x00003f80, 0x3f353f35, 0x3f80248d, 0x3f35bf35, 0x3f80248d, 0x3f22bf46, 0xbe48bf7b, 0xbf62bef1
.long 0x250dbf80, 0xbf55bf0e, 0xbf6d3ec4, 0xbe483f7b, 0xbf80a554, 0xbef13f62, 0x3f0e3f55, 0x3f7fbdc9
.long 0x00003f80, 0x3f6d3ec4, 0x3f35bf35, 0xbec4bf6d, 0x3f80248d, 0x3e95bf75, 0xbf55bf0e, 0xbf463f22
.long 0x250dbf80, 0xbf7bbe48, 0xbec43f6d, 0x3f553f0e, 0xbf80a554, 0xbdc93f7f, 0x3f7b3e48, 0x3e95bf75
.long 0x3f808000, 0x3f808000, 0x3f808000, 0x3f808000, 0x248dbf80, 0xbdc9bf7f, 0xbe48bf7b, 0xbe95bf75
.long 0xbf80a50d, 0xbf7b3e48, 0xbf6d3ec4, 0xbf553f0e, 0xa5543f80, 0x3e953f75, 0x3f0e3f55, 0x3f463f22
.long 0x3f808000, 0x3f6dbec4, 0x3f35bf35, 0x3ec4bf6d, 0x248dbf80, 0xbef1bf62, 0xbf55bf0e, 0xbf7fbdc9
.long 0xbf80a50d, 0xbf553f0e, 0xbec43f6d, 0x3e483f7b, 0xa5543f80, 0x3f223f46, 0x3f7b3e48, 0x3f62bef1
.long 0x3f808000, 0x3f35bf35, 0x248dbf80, 0xbf35bf35, 0x248dbf80, 0xbf46bf22, 0xbf7b3e48, 0xbef13f62
.long 0xbf80a50d, 0xbf0e3f55, 0x3ec43f6d, 0x3f7b3e48, 0xa5543f80, 0x3f623ef1, 0x3f55bf0e, 0xbdc9bf7f
.long 0x3f808000, 0x3ec4bf6d, 0xbf35bf35, 0xbf6d3ec4, 0x248dbf80, 0xbf75be95, 0xbf0e3f55, 0x3f223f46
.long 0xbf80a50d, 0xbe483f7b, 0x3f6d3ec4, 0x3f0ebf55, 0xa5543f80, 0x3f7f3dc9, 0x3e48bf7b, 0xbf75be95
.long 0x00003f80, 0x00003f80, 0x00003f80, 0x00003f80, 0x3f6dbec4, 0x3f62bef1, 0x3f55bf0e, 0x3f46bf22
.long 0xbf35bf35, 0xbf55bf0e, 0xbf6dbec4, 0xbf7bbe48, 0xbec43f6d, 0xbdc93f7f, 0x3e483f7b, 0x3ef13f62
.long 0x3f80248d, 0x3f6dbec4, 0x3f35bf35, 0x3ec4bf6d, 0xbec4bf6d, 0xbf46bf22, 0xbf7bbe48, 0xbf753e95
.long 0xbf353f35, 0xbe483f7b, 0x3ec43f6d, 0x3f553f0e, 0x3f6d3ec4, 0x3f75be95, 0x3f0ebf55, 0xbdc9bf7f
.long 0x250dbf80, 0xbf35bf35, 0xbf80a554, 0xbf353f35, 0xbf6d3ec4, 0xbe953f75, 0x3f0e3f55, 0x3f7f3dc9
.long 0x3f353f35, 0x3f7bbe48, 0x3ec4bf6d, 0xbf0ebf55, 0x3ec4bf6d, 0xbf22bf46, 0xbf7b3e48, 0xbe953f75
.long 0xbf80a554, 0xbec43f6d, 0x3f353f35, 0x3f6dbec4, 0x3ec43f6d, 0x3f7fbdc9, 0x3e48bf7b, 0xbf62bef1
.long 0x3f35bf35, 0xbf0ebf55, 0xbf6d3ec4, 0x3e483f7b, 0xbf6dbec4, 0xbef13f62, 0x3f553f0e, 0x3f22bf46
.long 0x3f808000, 0x3f808000, 0x3f808000, 0x3f808000, 0xbec4bf6d, 0xbef1bf62, 0xbf0ebf55, 0xbf22bf46
.long 0xbf353f35, 0xbf0e3f55, 0xbec43f6d, 0xbe483f7b, 0x3f6d3ec4, 0x3f7f3dc9, 0x3f7bbe48, 0x3f62bef1
.long 0x248dbf80, 0xbec4bf6d, 0xbf35bf35, 0xbf6dbec4, 0xbf6d3ec4, 0xbf223f46, 0xbe483f7b, 0x3e953f75
.long 0x3f353f35, 0x3f7b3e48, 0x3f6dbec4, 0x3f0ebf55, 0x3ec4bf6d, 0xbe95bf75, 0xbf55bf0e, 0xbf7f3dc9
.long 0xbf80a50d, 0xbf353f35, 0xa5543f80, 0x3f353f35, 0x3ec43f6d, 0x3f753e95, 0x3f55bf0e, 0x3dc9bf7f
.long 0x3f35bf35, 0xbe48bf7b, 0xbf6dbec4, 0xbf553f0e, 0xbf6dbec4, 0xbf463f22, 0x3e483f7b, 0x3f753e95
.long 0xa5543f80, 0x3f6d3ec4, 0x3f35bf35, 0xbec4bf6d, 0x3f6dbec4, 0xbdc9bf7f, 0xbf7bbe48, 0xbef13f62
.long 0xbf35bf35, 0xbf553f0e, 0x3ec43f6d, 0x3f7bbe48, 0xbec43f6d, 0x3f623ef1, 0x3f0ebf55, 0xbf46bf22
.long 0x00003f80, 0x00003f80, 0x00003f80, 0x00003f80, 0x3f35bf35, 0x3f22bf46, 0x3f0ebf55, 0x3ef1bf62
.long 0xbf80a554, 0xbf7b3e48, 0xbf6d3ec4, 0xbf553f0e, 0x3f353f35, 0x3f623ef1, 0x3f7b3e48, 0x3f7fbdc9
.long 0x250dbf80, 0xbec4bf6d, 0xbf35bf35, 0xbf6dbec4, 0xbf353f35, 0xbe953f75, 0x3e483f7b, 0x3f223f46
.long 0x3f80248d, 0x3f55bf0e, 0x3ec4bf6d, 0xbe48bf7b, 0xbf35bf35, 0xbf7fbdc9, 0xbf553f0e, 0xbe953f75
.long 0x00003f80, 0x3f353f35, 0x3f80248d, 0x3f35bf35, 0x3f35bf35, 0xbdc9bf7f, 0xbf55bf0e, 0xbf753e95
.long 0xbf80a554, 0xbf0e3f55, 0x3ec43f6d, 0x3f7b3e48, 0x3f353f35, 0x3f75be95, 0x3e48bf7b, 0xbf46bf22
.long 0x250dbf80, 0xbf6dbec4, 0xbf353f35, 0x3ec43f6d, 0xbf353f35, 0x3ef13f62, 0x3f7bbe48, 0x3dc9bf7f
.long 0x3f80248d, 0x3e48bf7b, 0xbf6dbec4, 0xbf0e3f55, 0xbf35bf35, 0xbf463f22, 0x3f0e3f55, 0x3f62bef1
.long 0x3f808000, 0x3f808000, 0x3f808000, 0x3f808000, 0xbf35bf35, 0xbf46bf22, 0xbf55bf0e, 0xbf62bef1
.long 0xa5543f80, 0x3e483f7b, 0x3ec43f6d, 0x3f0e3f55, 0x3f35bf35, 0x3ef1bf62, 0x3e48bf7b, 0xbdc9bf7f
.long 0xbf80a50d, 0xbf6d3ec4, 0xbf353f35, 0xbec43f6d, 0x3f353f35, 0x3f753e95, 0x3f7bbe48, 0x3f46bf22
.long 0x248dbf80, 0xbf0ebf55, 0xbf6dbec4, 0xbf7b3e48, 0xbf353f35, 0xbdc93f7f, 0x3f0e3f55, 0x3f753e95
.long 0x3f808000, 0x3f35bf35, 0x248dbf80, 0xbf35bf35, 0xbf35bf35, 0xbf7f3dc9, 0xbf0e3f55, 0x3e953f75
.long 0xa5543f80, 0x3f553f0e, 0x3f6dbec4, 0x3e48bf7b, 0x3f35bf35, 0xbe95bf75, 0xbf7bbe48, 0xbf223f46
.long 0xbf80a50d, 0xbec43f6d, 0x3f353f35, 0x3f6dbec4, 0x3f353f35, 0x3f62bef1, 0xbe48bf7b, 0xbf7fbdc9
.long 0x248dbf80, 0xbf7bbe48, 0xbec43f6d, 0x3f553f0e, 0xbf353f35, 0x3f223f46, 0x3f55bf0e, 0xbef1bf62
.long 0x00003f80, 0x00003f80, 0x00003f80, 0x00003f80, 0x3ec4bf6d, 0x3e95bf75, 0x3e48bf7b, 0x3dc9bf7f
.long 0xbf353f35, 0xbf0e3f55, 0xbec43f6d, 0xbe483f7b, 0x3f6dbec4, 0x3f46bf22, 0x3f0ebf55, 0x3e95bf75
.long 0xbf80a554, 0xbf6d3ec4, 0xbf353f35, 0xbec43f6d, 0x3f6d3ec4, 0x3f7fbdc9, 0x3f55bf0e, 0x3ef1bf62
.long 0xbf35bf35, 0xbf7bbe48, 0xbf6d3ec4, 0xbf0e3f55, 0x3ec43f6d, 0x3f623ef1, 0x3f7bbe48, 0x3f22bf46
.long 0x250dbf80, 0xbf35bf35, 0xbf80a554, 0xbf353f35, 0xbec43f6d, 0x3ef13f62, 0x3f7b3e48, 0x3f46bf22
.long 0x3f35bf35, 0xbe48bf7b, 0xbf6dbec4, 0xbf553f0e, 0xbf6d3ec4, 0xbdc93f7f, 0x3f553f0e, 0x3f62bef1
.long 0x3f80248d, 0x3ec4bf6d, 0xbf35bf35, 0xbf6d3ec4, 0xbf6dbec4, 0xbf223f46, 0x3f0e3f55, 0x3f75be95
.long 0x3f353f35, 0x3f55bf0e, 0xbec4bf6d, 0xbf7b3e48, 0xbec4bf6d, 0xbf753e95, 0x3e483f7b, 0x3f7fbdc9
.long 0x3f808000, 0x3f808000, 0x3f808000, 0x3f808000, 0xbf6dbec4, 0xbf75be95, 0xbf7bbe48, 0xbf7fbdc9
.long 0x3f353f35, 0x3f553f0e, 0x3f6d3ec4, 0x3f7b3e48, 0xbec4bf6d, 0xbf22bf46, 0xbf55bf0e, 0xbf75be95
.long 0xa5543f80, 0x3ec43f6d, 0x3f353f35, 0x3f6d3ec4, 0x3ec4bf6d, 0xbdc9bf7f, 0xbf0ebf55, 0xbf62bef1
.long 0xbf353f35, 0xbe483f7b, 0x3ec43f6d, 0x3f553f0e, 0x3f6dbec4, 0x3ef1bf62, 0xbe48bf7b, 0xbf46bf22
.long 0xbf80a50d, 0xbf353f35, 0xa5543f80, 0x3f353f35, 0x3f6d3ec4, 0x3f62bef1, 0x3e48bf7b, 0xbf22bf46
.long 0xbf35bf35, 0xbf7b3e48, 0xbec43f6d, 0x3f0e3f55, 0x3ec43f6d, 0x3f7f3dc9, 0x3f0ebf55, 0xbef1bf62
.long 0x248dbf80, 0xbf6dbec4, 0xbf353f35, 0x3ec43f6d, 0xbec43f6d, 0x3f463f22, 0x3f55bf0e, 0xbe95bf75
.long 0x3f35bf35, 0xbf0ebf55, 0xbf6d3ec4, 0x3e483f7b, 0xbf6d3ec4, 0x3e953f75, 0x3f7bbe48, 0xbdc9bf7f
.long 0x00003f80, 0x00003f80, 0x00003f80, 0x00003f80, 0x250dbf80, 0xbdc9bf7f, 0xbe48bf7b, 0xbe95bf75
.long 0x00003f80, 0x3e483f7b, 0x3ec43f6d, 0x3f0e3f55, 0x250dbf80, 0xbe95bf75, 0xbf0ebf55, 0xbf46bf22
.long 0x00003f80, 0x3ec43f6d, 0x3f353f35, 0x3f6d3ec4, 0x250dbf80, 0xbef1bf62, 0xbf55bf0e, 0xbf7fbdc9
.long 0x00003f80, 0x3f0e3f55, 0x3f6d3ec4, 0x3f7bbe48, 0x250dbf80, 0xbf22bf46, 0xbf7bbe48, 0xbf623ef1
.long 0x00003f80, 0x3f353f35, 0x3f80248d, 0x3f35bf35, 0x250dbf80, 0xbf46bf22, 0xbf7b3e48, 0xbef13f62
.long 0x00003f80, 0x3f553f0e, 0x3f6dbec4, 0x3e48bf7b, 0x250dbf80, 0xbf62bef1, 0xbf553f0e, 0x3dc93f7f
.long 0x00003f80, 0x3f6d3ec4, 0x3f35bf35, 0xbec4bf6d, 0x250dbf80, 0xbf75be95, 0xbf0e3f55, 0x3f223f46
.long 0x00003f80, 0x3f7b3e48, 0x3ec4bf6d, 0xbf55bf0e, 0x250dbf80, 0xbf7fbdc9, 0xbe483f7b, 0x3f753e95
.long 0x3f808000, 0x3f808000, 0x3f808000, 0x3f808000, 0xbf80a50d, 0xbf7f3dc9, 0xbf7b3e48, 0xbf753e95
.long 0x3f808000, 0x3f7bbe48, 0x3f6dbec4, 0x3f55bf0e, 0xbf80a50d, 0xbf753e95, 0xbf553f0e, 0xbf223f46
.long 0x3f808000, 0x3f6dbec4, 0x3f35bf35, 0x3ec4bf6d, 0xbf80a50d, 0xbf623ef1, 0xbf0e3f55, 0xbdc93f7f
.long 0x3f808000, 0x3f55bf0e, 0x3ec4bf6d, 0xbe48bf7b, 0xbf80a50d, 0xbf463f22, 0xbe483f7b, 0x3ef13f62
.long 0x3f808000, 0x3f35bf35, 0x248dbf80, 0xbf35bf35, 0xbf80a50d, 0xbf223f46, 0x3e483f7b, 0x3f623ef1
.long 0x3f808000, 0x3f0ebf55, 0xbec4bf6d, 0xbf7bbe48, 0xbf80a50d, 0xbef13f62, 0x3f0e3f55, 0x3f7fbdc9
.long 0x3f808000, 0x3ec4bf6d, 0xbf35bf35, 0xbf6d3ec4, 0xbf80a50d, 0xbe953f75, 0x3f553f0e, 0x3f46bf22
.long 0x3f808000, 0x3e48bf7b, 0xbf6dbec4, 0xbf0e3f55, 0xbf80a50d, 0xbdc93f7f, 0x3f7b3e48, 0x3e95bf75
.long 0x00003f80, 0x00003f80, 0x00003f80, 0x00003f80, 0xbec4bf6d, 0xbef1bf62, 0xbf0ebf55, 0xbf22bf46
.long 0x3f353f35, 0x3f553f0e, 0x3f6d3ec4, 0x3f7b3e48, 0xbf6dbec4, 0xbf7fbdc9, 0xbf7b3e48, 0xbf623ef1
.long 0x3f80248d, 0x3f6dbec4, 0x3f35bf35, 0x3ec4bf6d, 0xbf6d3ec4, 0xbf223f46, 0xbe483f7b, 0x3e953f75
.long 0x3f35bf35, 0x3e48bf7b, 0xbec4bf6d, 0xbf55bf0e, 0xbec43f6d, 0x3e953f75, 0x3f553f0e, 0x3f7fbdc9
.long 0x250dbf80, 0xbf35bf35, 0xbf80a554, 0xbf353f35, 0x3ec43f6d, 0x3f753e95, 0x3f55bf0e, 0x3dc9bf7f
.long 0xbf35bf35, 0xbf7b3e48, 0xbec43f6d, 0x3f0e3f55, 0x3f6d3ec4, 0x3f46bf22, 0xbe48bf7b, 0xbf75be95
.long 0xbf80a554, 0xbec43f6d, 0x3f353f35, 0x3f6dbec4, 0x3f6dbec4, 0xbdc9bf7f, 0xbf7bbe48, 0xbef13f62
.long 0xbf353f35, 0x3f0e3f55, 0x3f6dbec4, 0xbe48bf7b, 0x3ec4bf6d, 0xbf62bef1, 0xbf0e3f55, 0x3f463f22
.long 0x3f808000, 0x3f808000, 0x3f808000, 0x3f808000, 0xbf6d3ec4, 0xbf623ef1, 0xbf553f0e, 0xbf463f22
.long 0x3f35bf35, 0x3f0ebf55, 0x3ec4bf6d, 0x3e48bf7b, 0xbec43f6d, 0xbdc93f7f, 0x3e483f7b, 0x3ef13f62
.long 0x248dbf80, 0xbec4bf6d, 0xbf35bf35, 0xbf6dbec4, 0x3ec43f6d, 0x3f463f22, 0x3f7b3e48, 0x3f75be95
.long 0xbf35bf35, 0xbf7bbe48, 0xbf6d3ec4, 0xbf0e3f55, 0x3f6d3ec4, 0x3f75be95, 0x3f0ebf55, 0xbdc9bf7f
.long 0xbf80a50d, 0xbf353f35, 0xa5543f80, 0x3f353f35, 0x3f6dbec4, 0x3e95bf75, 0xbf0ebf55, 0xbf7fbdc9
.long 0xbf353f35, 0x3e483f7b, 0x3f6d3ec4, 0x3f55bf0e, 0x3ec4bf6d, 0xbf22bf46, 0xbf7b3e48, 0xbe953f75
.long 0xa5543f80, 0x3f6d3ec4, 0x3f35bf35, 0xbec4bf6d, 0xbec4bf6d, 0xbf7f3dc9, 0xbe483f7b, 0x3f623ef1
.long 0x3f353f35, 0x3f55bf0e, 0xbec4bf6d, 0xbf7b3e48, 0xbf6dbec4, 0xbef13f62, 0x3f553f0e, 0x3f22bf46
.long 0x00003f80, 0x00003f80, 0x00003f80, 0x00003f80, 0xbf35bf35, 0xbf46bf22, 0xbf55bf0e, 0xbf62bef1
.long 0x3f80248d, 0x3f7bbe48, 0x3f6dbec4, 0x3f55bf0e, 0xbf353f35, 0xbef13f62, 0xbe483f7b, 0x3dc93f7f
.long 0x250dbf80, 0xbec4bf6d, 0xbf35bf35, 0xbf6dbec4, 0x3f353f35, 0x3f753e95, 0x3f7bbe48, 0x3f46bf22
.long 0xbf80a554, 0xbf553f0e, 0xbec43f6d, 0x3e483f7b, 0x3f35bf35, 0x3dc9bf7f, 0xbf0ebf55, 0xbf75be95
.long 0x00003f80, 0x3f353f35, 0x3f80248d, 0x3f35bf35, 0xbf35bf35, 0xbf7f3dc9, 0xbf0e3f55, 0x3e953f75
.long 0x3f80248d, 0x3f0ebf55, 0xbec4bf6d, 0xbf7bbe48, 0xbf353f35, 0x3e953f75, 0x3f7b3e48, 0x3f22bf46
.long 0x250dbf80, 0xbf6dbec4, 0xbf353f35, 0x3ec43f6d, 0x3f353f35, 0x3f62bef1, 0xbe48bf7b, 0xbf7fbdc9
.long 0xbf80a554, 0xbe483f7b, 0x3f6d3ec4, 0x3f0ebf55, 0x3f35bf35, 0xbf22bf46, 0xbf553f0e, 0x3ef13f62
.long 0x3f808000, 0x3f808000, 0x3f808000, 0x3f808000, 0xbf353f35, 0xbf223f46, 0xbf0e3f55, 0xbef13f62
.long 0x248dbf80, 0xbe48bf7b, 0xbec4bf6d, 0xbf0ebf55, 0x3f353f35, 0x3f623ef1, 0x3f7b3e48, 0x3f7fbdc9
.long 0xbf80a50d, 0xbf6d3ec4, 0xbf353f35, 0xbec43f6d, 0x3f35bf35, 0x3e95bf75, 0xbe48bf7b, 0xbf22bf46
.long 0xa5543f80, 0x3f0e3f55, 0x3f6d3ec4, 0x3f7bbe48, 0xbf35bf35, 0xbf7fbdc9, 0xbf553f0e, 0xbe953f75
.long 0x3f808000, 0x3f35bf35, 0x248dbf80, 0xbf35bf35, 0xbf353f35, 0x3dc93f7f, 0x3f553f0e, 0x3f75be95
.long 0x248dbf80, 0xbf55bf0e, 0xbf6d3ec4, 0xbe483f7b, 0x3f353f35, 0x3f75be95, 0x3e48bf7b, 0xbf46bf22
.long 0xbf80a50d, 0xbec43f6d, 0x3f353f35, 0x3f6dbec4, 0x3f35bf35, 0xbef1bf62, 0xbf7b3e48, 0xbdc93f7f
.long 0xa5543f80, 0x3f7b3e48, 0x3ec4bf6d, 0xbf55bf0e, 0xbf35bf35, 0xbf463f22, 0x3f0e3f55, 0x3f62bef1
.long 0x00003f80, 0x00003f80, 0x00003f80, 0x00003f80, 0xbf6dbec4, 0xbf75be95, 0xbf7bbe48, 0xbf7fbdc9
.long 0x3f35bf35, 0x3f0ebf55, 0x3ec4bf6d, 0x3e48bf7b, 0x3ec43f6d, 0x3f223f46, 0x3f553f0e, 0x3f753e95
.long 0xbf80a554, 0xbf6d3ec4, 0xbf353f35, 0xbec43f6d, 0x3ec4bf6d, 0xbdc9bf7f, 0xbf0ebf55, 0xbf62bef1
.long 0x3f353f35, 0x3f7b3e48, 0x3f6dbec4, 0x3f0ebf55, 0xbf6d3ec4, 0xbef13f62, 0x3e483f7b, 0x3f463f22
.long 0x250dbf80, 0xbf35bf35, 0xbf80a554, 0xbf353f35, 0x3f6d3ec4, 0x3f62bef1, 0x3e48bf7b, 0xbf22bf46
.long 0xbf353f35, 0x3e483f7b, 0x3f6d3ec4, 0x3f55bf0e, 0xbec4bf6d, 0xbf7fbdc9, 0xbf0e3f55, 0x3ef13f62
.long 0x3f80248d, 0x3ec4bf6d, 0xbf35bf35, 0xbf6d3ec4, 0xbec43f6d, 0x3f463f22, 0x3f55bf0e, 0xbe95bf75
.long 0xbf35bf35, 0xbf553f0e, 0x3ec43f6d, 0x3f7bbe48, 0x3f6dbec4, 0xbe95bf75, 0xbf7b3e48, 0x3dc93f7f
.long 0x3f808000, 0x3f808000, 0x3f808000, 0x3f808000, 0xbec43f6d, 0xbe953f75, 0xbe483f7b, 0xbdc93f7f
.long 0xbf35bf35, 0xbf55bf0e, 0xbf6dbec4, 0xbf7bbe48, 0x3f6dbec4, 0x3f46bf22, 0x3f0ebf55, 0x3e95bf75
.long 0xa5543f80, 0x3ec43f6d, 0x3f353f35, 0x3f6d3ec4, 0xbf6dbec4, 0xbf7f3dc9, 0xbf553f0e, 0xbef13f62
.long 0x3f35bf35, 0x3e48bf7b, 0xbec4bf6d, 0xbf55bf0e, 0x3ec43f6d, 0x3f623ef1, 0x3f7bbe48, 0x3f22bf46
.long 0xbf80a50d, 0xbf353f35, 0xa5543f80, 0x3f353f35, 0x3ec4bf6d, 0xbef1bf62, 0xbf7bbe48, 0xbf463f22
.long 0x3f353f35, 0x3f7bbe48, 0x3ec4bf6d, 0xbf0ebf55, 0xbf6d3ec4, 0xbdc93f7f, 0x3f553f0e, 0x3f62bef1
.long 0x248dbf80, 0xbf6dbec4, 0xbf353f35, 0x3ec43f6d, 0x3f6d3ec4, 0x3f22bf46, 0xbf0ebf55, 0xbf753e95
.long 0xbf353f35, 0x3f0e3f55, 0x3f6dbec4, 0xbe48bf7b, 0xbec4bf6d, 0xbf753e95, 0x3e483f7b, 0x3f7fbdc9
.long 0x00003f80, 0x00003f80, 0x00003f80, 0x00003f80, 0xbf80a554, 0xbf7f3dc9, 0xbf7b3e48, 0xbf753e95
.long 0x250dbf80, 0xbe48bf7b, 0xbec4bf6d, 0xbf0ebf55, 0x3f80248d, 0x3f75be95, 0x3f55bf0e, 0x3f22bf46
.long 0x00003f80, 0x3ec43f6d, 0x3f353f35, 0x3f6d3ec4, 0xbf80a554, 0xbf623ef1, 0xbf0e3f55, 0xbdc93f7f
.long 0x250dbf80, 0xbf0ebf55, 0xbf6dbec4, 0xbf7b3e48, 0x3f80248d, 0x3f46bf22, 0x3e48bf7b, 0xbef1bf62
.long 0x00003f80, 0x3f353f35, 0x3f80248d, 0x3f35bf35, 0xbf80a554, 0xbf223f46, 0x3e483f7b, 0x3f623ef1
.long 0x250dbf80, 0xbf55bf0e, 0xbf6d3ec4, 0xbe483f7b, 0x3f80248d, 0x3ef1bf62, 0xbf0ebf55, 0xbf7f3dc9
.long 0x00003f80, 0x3f6d3ec4, 0x3f35bf35, 0xbec4bf6d, 0xbf80a554, 0xbe953f75, 0x3f553f0e, 0x3f46bf22
.long 0x250dbf80, 0xbf7bbe48, 0xbec43f6d, 0x3f553f0e, 0x3f80248d, 0x3dc9bf7f, 0xbf7bbe48, 0xbe953f75
.long 0x3f808000, 0x3f808000, 0x3f808000, 0x3f808000, 0xa5543f80, 0x3dc93f7f, 0x3e483f7b, 0x3e953f75
.long 0xbf80a50d, 0xbf7b3e48, 0xbf6d3ec4, 0xbf553f0e, 0x248dbf80, 0xbe95bf75, 0xbf0ebf55, 0xbf46bf22
.long 0x3f808000, 0x3f6dbec4, 0x3f35bf35, 0x3ec4bf6d, 0xa5543f80, 0x3ef13f62, 0x3f553f0e, 0x3f7f3dc9
.long 0xbf80a50d, 0xbf553f0e, 0xbec43f6d, 0x3e483f7b, 0x248dbf80, 0xbf22bf46, 0xbf7bbe48, 0xbf623ef1
.long 0x3f808000, 0x3f35bf35, 0x248dbf80, 0xbf35bf35, 0xa5543f80, 0x3f463f22, 0x3f7bbe48, 0x3ef1bf62
.long 0xbf80a50d, 0xbf0e3f55, 0x3ec43f6d, 0x3f7b3e48, 0x248dbf80, 0xbf62bef1, 0xbf553f0e, 0x3dc93f7f
.long 0x3f808000, 0x3ec4bf6d, 0xbf35bf35, 0xbf6d3ec4, 0xa5543f80, 0x3f753e95, 0x3f0ebf55, 0xbf22bf46
.long 0xbf80a50d, 0xbe483f7b, 0x3f6d3ec4, 0x3f0ebf55, 0x248dbf80, 0xbf7fbdc9, 0xbe483f7b, 0x3f753e95
.long 0x00003f80, 0x00003f80, 0x00003f80, 0x00003f80, 0xbf6d3ec4, 0xbf623ef1, 0xbf553f0e, 0xbf463f22
.long 0xbf35bf35, 0xbf55bf0e, 0xbf6dbec4, 0xbf7bbe48, 0x3ec4bf6d, 0x3dc9bf7f, 0xbe48bf7b, 0xbef1bf62
.long 0x3f80248d, 0x3f6dbec4, 0x3f35bf35, 0x3ec4bf6d, 0x3ec43f6d, 0x3f463f22, 0x3f7b3e48, 0x3f75be95
.long 0xbf353f35, 0xbe483f7b, 0x3ec43f6d, 0x3f553f0e, 0xbf6dbec4, 0xbf753e95, 0xbf0e3f55, 0x3dc93f7f
.long 0x250dbf80, 0xbf35bf35, 0xbf80a554, 0xbf353f35, 0x3f6dbec4, 0x3e95bf75, 0xbf0ebf55, 0xbf7fbdc9
.long 0x3f353f35, 0x3f7bbe48, 0x3ec4bf6d, 0xbf0ebf55, 0xbec43f6d, 0x3f223f46, 0x3f7bbe48, 0x3e95bf75
.long 0xbf80a554, 0xbec43f6d, 0x3f353f35, 0x3f6dbec4, 0xbec4bf6d, 0xbf7f3dc9, 0xbe483f7b, 0x3f623ef1
.long 0x3f35bf35, 0xbf0ebf55, 0xbf6d3ec4, 0x3e483f7b, 0x3f6d3ec4, 0x3ef1bf62, 0xbf55bf0e, 0xbf223f46
.long 0x3f808000, 0x3f808000, 0x3f808000, 0x3f808000, 0x3ec43f6d, 0x3ef13f62, 0x3f0e3f55, 0x3f223f46
.long 0xbf353f35, 0xbf0e3f55, 0xbec43f6d, 0xbe483f7b, 0xbf6dbec4, 0xbf7fbdc9, 0xbf7b3e48, 0xbf623ef1
.long 0x248dbf80, 0xbec4bf6d, 0xbf35bf35, 0xbf6dbec4, 0x3f6dbec4, 0x3f22bf46, 0x3e48bf7b, 0xbe95bf75
.long 0x3f353f35, 0x3f7b3e48, 0x3f6dbec4, 0x3f0ebf55, 0xbec43f6d, 0x3e953f75, 0x3f553f0e, 0x3f7fbdc9
.long 0xbf80a50d, 0xbf353f35, 0xa5543f80, 0x3f353f35, 0xbec4bf6d, 0xbf75be95, 0xbf553f0e, 0xbdc93f7f
.long 0x3f35bf35, 0xbe48bf7b, 0xbf6dbec4, 0xbf553f0e, 0x3f6d3ec4, 0x3f46bf22, 0xbe48bf7b, 0xbf75be95
.long 0xa5543f80, 0x3f6d3ec4, 0x3f35bf35, 0xbec4bf6d, 0xbf6d3ec4, 0x3dc93f7f, 0x3f7b3e48, 0x3ef1bf62
.long 0xbf35bf35, 0xbf553f0e, 0x3ec43f6d, 0x3f7bbe48, 0x3ec4bf6d, 0xbf62bef1, 0xbf0e3f55, 0x3f463f22
.long 0x00003f80, 0x00003f80, 0x00003f80, 0x00003f80, 0xbf353f35, 0xbf223f46, 0xbf0e3f55, 0xbef13f62
.long 0xbf80a554, 0xbf7b3e48, 0xbf6d3ec4, 0xbf553f0e, 0xbf35bf35, 0xbf62bef1, 0xbf7bbe48, 0xbf7f3dc9
.long 0x250dbf80, 0xbec4bf6d, 0xbf35bf35, 0xbf6dbec4, 0x3f35bf35, 0x3e95bf75, 0xbe48bf7b, 0xbf22bf46
.long 0x3f80248d, 0x3f55bf0e, 0x3ec4bf6d, 0xbe48bf7b, 0x3f353f35, 0x3f7f3dc9, 0x3f55bf0e, 0x3e95bf75
.long 0x00003f80, 0x3f353f35, 0x3f80248d, 0x3f35bf35, 0xbf353f35, 0x3dc93f7f, 0x3f553f0e, 0x3f75be95
.long 0xbf80a554, 0xbf0e3f55, 0x3ec43f6d, 0x3f7b3e48, 0xbf35bf35, 0xbf753e95, 0xbe483f7b, 0x3f463f22
.long 0x250dbf80, 0xbf6dbec4, 0xbf353f35, 0x3ec43f6d, 0x3f35bf35, 0xbef1bf62, 0xbf7b3e48, 0xbdc93f7f
.long 0x3f80248d, 0x3e48bf7b, 0xbf6dbec4, 0xbf0e3f55, 0x3f353f35, 0x3f46bf22, 0xbf0ebf55, 0xbf623ef1
.long 0x3f808000, 0x3f808000, 0x3f808000, 0x3f808000, 0x3f353f35, 0x3f463f22, 0x3f553f0e, 0x3f623ef1
.long 0xa5543f80, 0x3e483f7b, 0x3ec43f6d, 0x3f0e3f55, 0xbf353f35, 0xbef13f62, 0xbe483f7b, 0x3dc93f7f
.long 0xbf80a50d, 0xbf6d3ec4, 0xbf353f35, 0xbec43f6d, 0xbf35bf35, 0xbf75be95, 0xbf7b3e48, 0xbf463f22
.long 0x248dbf80, 0xbf0ebf55, 0xbf6dbec4, 0xbf7b3e48, 0x3f35bf35, 0x3dc9bf7f, 0xbf0ebf55, 0xbf75be95
.long 0x3f808000, 0x3f35bf35, 0x248dbf80, 0xbf35bf35, 0x3f353f35, 0x3f7fbdc9, 0x3f0ebf55, 0xbe95bf75
.long 0xa5543f80, 0x3f553f0e, 0x3f6dbec4, 0x3e48bf7b, 0xbf353f35, 0x3e953f75, 0x3f7b3e48, 0x3f22bf46
.long 0xbf80a50d, 0xbec43f6d, 0x3f353f35, 0x3f6dbec4, 0xbf35bf35, 0xbf623ef1, 0x3e483f7b, 0x3f7f3dc9
.long 0x248dbf80, 0xbf7bbe48, 0xbec43f6d, 0x3f553f0e, 0x3f35bf35, 0xbf22bf46, 0xbf553f0e, 0x3ef13f62
.long 0x00003f80, 0x00003f80, 0x00003f80, 0x00003f80, 0xbec43f6d, 0xbe953f75, 0xbe483f7b, 0xbdc93f7f
.long 0xbf353f35, 0xbf0e3f55, 0xbec43f6d, 0xbe483f7b, 0xbf6d3ec4, 0xbf463f22, 0xbf0e3f55, 0xbe953f75
.long 0xbf80a554, 0xbf6d3ec4, 0xbf353f35, 0xbec43f6d, 0xbf6dbec4, 0xbf7f3dc9, 0xbf553f0e, 0xbef13f62
.long 0xbf35bf35, 0xbf7bbe48, 0xbf6d3ec4, 0xbf0e3f55, 0xbec4bf6d, 0xbf62bef1, 0xbf7b3e48, 0xbf223f46
.long 0x250dbf80, 0xbf35bf35, 0xbf80a554, 0xbf353f35, 0x3ec4bf6d, 0xbef1bf62, 0xbf7bbe48, 0xbf463f22
.long 0x3f35bf35, 0xbe48bf7b, 0xbf6dbec4, 0xbf553f0e, 0x3f6dbec4, 0x3dc9bf7f, 0xbf55bf0e, 0xbf623ef1
.long 0x3f80248d, 0x3ec4bf6d, 0xbf35bf35, 0xbf6d3ec4, 0x3f6d3ec4, 0x3f22bf46, 0xbf0ebf55, 0xbf753e95
.long 0x3f353f35, 0x3f55bf0e, 0xbec4bf6d, 0xbf7b3e48, 0x3ec43f6d, 0x3f75be95, 0xbe48bf7b, 0xbf7f3dc9
.long 0x3f808000, 0x3f808000, 0x3f808000, 0x3f808000, 0x3f6d3ec4, 0x3f753e95, 0x3f7b3e48, 0x3f7f3dc9
.long 0x3f353f35, 0x3f553f0e, 0x3f6d3ec4, 0x3f7b3e48, 0x3ec43f6d, 0x3f223f46, 0x3f553f0e, 0x3f753e95
.long 0xa5543f80, 0x3ec43f6d, 0x3f353f35, 0x3f6d3ec4, 0xbec43f6d, 0x3dc93f7f, 0x3f0e3f55, 0x3f623ef1
.long 0xbf353f35, 0xbe483f7b, 0x3ec43f6d, 0x3f553f0e, 0xbf6d3ec4, 0xbef13f62, 0x3e483f7b, 0x3f463f22
.long 0xbf80a50d, 0xbf353f35, 0xa5543f80, 0x3f353f35, 0xbf6dbec4, 0xbf623ef1, 0xbe483f7b, 0x3f223f46
.long 0xbf35bf35, 0xbf7b3e48, 0xbec43f6d, 0x3f0e3f55, 0xbec4bf6d, 0xbf7fbdc9, 0xbf0e3f55, 0x3ef13f62
.long 0x248dbf80, 0xbf6dbec4, 0xbf353f35, 0x3ec43f6d, 0x3ec4bf6d, 0xbf46bf22, 0xbf553f0e, 0x3e953f75
.long 0x3f35bf35, 0xbf0ebf55, 0xbf6d3ec4, 0x3e483f7b, 0x3f6dbec4, 0xbe95bf75, 0xbf7b3e48, 0x3dc93f7f
.long 0x00003f80, 0x3f80248d, 0x250dbf80, 0xbf80a554, 0x00003f80, 0x3f7fbdc9, 0xbe48bf7b, 0xbf753e95
.long 0x00003f80, 0x3f7bbe48, 0xbec4bf6d, 0xbf553f0e, 0x00003f80, 0x3f75be95, 0xbf0ebf55, 0xbf223f46
.long 0x00003f80, 0x3f6dbec4, 0xbf35bf35, 0xbec43f6d, 0x00003f80, 0x3f62bef1, 0xbf55bf0e, 0xbdc93f7f
.long 0x00003f80, 0x3f55bf0e, 0xbf6dbec4, 0x3e483f7b, 0x00003f80, 0x3f46bf22, 0xbf7bbe48, 0x3ef13f62
.long 0x00003f80, 0x3f35bf35, 0xbf80a554, 0x3f353f35, 0x00003f80, 0x3f22bf46, 0xbf7b3e48, 0x3f623ef1
.long 0x00003f80, 0x3f0ebf55, 0xbf6d3ec4, 0x3f7b3e48, 0x00003f80, 0x3ef1bf62, 0xbf553f0e, 0x3f7fbdc9
.long 0x00003f80, 0x3ec4bf6d, 0xbf353f35, 0x3f6dbec4, 0x00003f80, 0x3e95bf75, 0xbf0e3f55, 0x3f46bf22
.long 0x00003f80, 0x3e48bf7b, 0xbec43f6d, 0x3f0ebf55, 0x00003f80, 0x3dc9bf7f, 0xbe483f7b, 0x3e95bf75
.long 0x3f808000, 0x248dbf80, 0xbf80a50d, 0xa5543f80, 0x3f808000, 0xbdc9bf7f, 0xbf7b3e48, 0x3e953f75
.long 0x3f808000, 0xbe48bf7b, 0xbf6d3ec4, 0x3f0e3f55, 0x3f808000, 0xbe95bf75, 0xbf553f0e, 0x3f463f22
.long 0x3f808000, 0xbec4bf6d, 0xbf353f35, 0x3f6d3ec4, 0x3f808000, 0xbef1bf62, 0xbf0e3f55, 0x3f7f3dc9
.long 0x3f808000, 0xbf0ebf55, 0xbec43f6d, 0x3f7bbe48, 0x3f808000, 0xbf22bf46, 0xbe483f7b, 0x3f62bef1
.long 0x3f808000, 0xbf35bf35, 0xa5543f80, 0x3f35bf35, 0x3f808000, 0xbf46bf22, 0x3e483f7b, 0x3ef1bf62
.long 0x3f808000, 0xbf55bf0e, 0x3ec43f6d, 0x3e48bf7b, 0x3f808000, 0xbf62bef1, 0x3f0e3f55, 0xbdc9bf7f
.long 0x3f808000, 0xbf6dbec4, 0x3f353f35, 0xbec4bf6d, 0x3f808000, 0xbf75be95, 0x3f553f0e, 0xbf22bf46
.long 0x3f808000, 0xbf7bbe48, 0x3f6d3ec4, 0xbf55bf0e, 0x3f808000, 0xbf7fbdc9, 0x3f7b3e48, 0xbf75be95
.long 0x00003f80, 0x3f80248d, 0x250dbf80, 0xbf80a554, 0x3ec43f6d, 0x3f62bef1, 0xbf0ebf55, 0xbf463f22
.long 0x3f353f35, 0x3f0ebf55, 0xbf6dbec4, 0xbe483f7b, 0x3f6d3ec4, 0x3dc9bf7f, 0xbf7b3e48, 0x3ef13f62
.long 0x3f80248d, 0xbec4bf6d, 0xbf353f35, 0x3f6d3ec4, 0x3f6dbec4, 0xbf46bf22, 0xbe483f7b, 0x3f75be95
.long 0x3f35bf35, 0xbf7bbe48, 0x3ec43f6d, 0x3f0ebf55, 0x3ec4bf6d, 0xbf753e95, 0x3f553f0e, 0xbdc9bf7f
.long 0x250dbf80, 0xbf353f35, 0x3f80248d, 0xbf35bf35, 0xbec4bf6d, 0xbe953f75, 0x3f55bf0e, 0xbf7fbdc9
.long 0xbf35bf35, 0x3e483f7b, 0x3ec4bf6d, 0xbf553f0e, 0xbf6dbec4, 0x3f223f46, 0xbe48bf7b, 0xbe953f75
.long 0xbf80a554, 0x3f6d3ec4, 0xbf35bf35, 0x3ec43f6d, 0xbf6d3ec4, 0x3f7fbdc9, 0xbf7bbe48, 0x3f623ef1
.long 0xbf353f35, 0x3f55bf0e, 0xbf6d3ec4, 0x3f7bbe48, 0xbec43f6d, 0x3ef1bf62, 0xbf0e3f55, 0x3f22bf46
.long 0x3f808000, 0x248dbf80, 0xbf80a50d, 0xa5543f80, 0x3f6dbec4, 0xbef1bf62, 0xbf553f0e, 0x3f223f46
.long 0x3f35bf35, 0xbf55bf0e, 0xbec43f6d, 0x3f7b3e48, 0x3ec4bf6d, 0xbf7fbdc9, 0x3e483f7b, 0x3f62bef1
.long 0x248dbf80, 0xbf6d3ec4, 0x3f353f35, 0x3ec4bf6d, 0xbec4bf6d, 0xbf223f46, 0x3f7b3e48, 0xbe95bf75
.long 0xbf35bf35, 0xbe483f7b, 0x3f6dbec4, 0xbf55bf0e, 0xbf6dbec4, 0x3e953f75, 0x3f0ebf55, 0xbf7f3dc9
.long 0xbf80a50d, 0x3f353f35, 0x248dbf80, 0xbf353f35, 0xbf6d3ec4, 0x3f753e95, 0xbf0ebf55, 0xbdc93f7f
.long 0xbf353f35, 0x3f7bbe48, 0xbf6dbec4, 0x3f0e3f55, 0xbec43f6d, 0x3f46bf22, 0xbf7b3e48, 0x3f753e95
.long 0xa5543f80, 0x3ec4bf6d, 0xbf353f35, 0x3f6dbec4, 0x3ec43f6d, 0xbdc9bf7f, 0xbe483f7b, 0x3ef1bf62
.long 0x3f353f35, 0xbf0ebf55, 0x3ec43f6d, 0xbe48bf7b, 0x3f6d3ec4, 0xbf62bef1, 0x3f553f0e, 0xbf46bf22
.long 0x00003f80, 0x3f80248d, 0x250dbf80, 0xbf80a554, 0x3f353f35, 0x3f22bf46, 0xbf55bf0e, 0xbef13f62
.long 0x3f80248d, 0xbe48bf7b, 0xbf6d3ec4, 0x3f0e3f55, 0x3f35bf35, 0xbf62bef1, 0xbe483f7b, 0x3f7fbdc9
.long 0x250dbf80, 0xbf6d3ec4, 0x3f353f35, 0x3ec4bf6d, 0xbf35bf35, 0xbe953f75, 0x3f7bbe48, 0xbf22bf46
.long 0xbf80a554, 0x3f0e3f55, 0x3ec4bf6d, 0xbf7b3e48, 0xbf353f35, 0x3f7f3dc9, 0xbf0ebf55, 0xbe953f75
.long 0x00003f80, 0x3f35bf35, 0xbf80a554, 0x3f353f35, 0x3f353f35, 0xbdc9bf7f, 0xbf0e3f55, 0x3f75be95
.long 0x3f80248d, 0xbf55bf0e, 0x3ec43f6d, 0x3e48bf7b, 0x3f35bf35, 0xbf753e95, 0x3f7b3e48, 0xbf46bf22
.long 0x250dbf80, 0xbec43f6d, 0x3f35bf35, 0xbf6d3ec4, 0xbf35bf35, 0x3ef13f62, 0xbe48bf7b, 0xbdc93f7f
.long 0xbf80a554, 0x3f7b3e48, 0xbf6dbec4, 0x3f553f0e, 0xbf353f35, 0x3f46bf22, 0xbf553f0e, 0x3f62bef1
.long 0x3f808000, 0x248dbf80, 0xbf80a50d, 0xa5543f80, 0x3f35bf35, 0xbf46bf22, 0xbf0e3f55, 0x3f623ef1
.long 0x248dbf80, 0xbf7b3e48, 0x3ec43f6d, 0x3f55bf0e, 0xbf35bf35, 0xbef13f62, 0x3f7b3e48, 0xbdc9bf7f
.long 0xbf80a50d, 0x3ec43f6d, 0x3f35bf35, 0xbf6dbec4, 0xbf353f35, 0x3f753e95, 0xbe48bf7b, 0xbf463f22
.long 0xa5543f80, 0x3f55bf0e, 0xbf6dbec4, 0x3e483f7b, 0x3f353f35, 0x3dc9bf7f, 0xbf553f0e, 0x3f753e95
.long 0x3f808000, 0xbf35bf35, 0xa5543f80, 0x3f35bf35, 0x3f35bf35, 0xbf7f3dc9, 0x3f553f0e, 0xbe95bf75
.long 0x248dbf80, 0xbf0e3f55, 0x3f6dbec4, 0xbf7bbe48, 0xbf35bf35, 0x3e953f75, 0x3e48bf7b, 0xbf223f46
.long 0xbf80a50d, 0x3f6d3ec4, 0xbf35bf35, 0x3ec43f6d, 0xbf353f35, 0x3f62bef1, 0xbf7b3e48, 0x3f7f3dc9
.long 0xa5543f80, 0x3e48bf7b, 0xbec43f6d, 0x3f0ebf55, 0x3f353f35, 0xbf22bf46, 0x3f0e3f55, 0xbef1bf62
.long 0x00003f80, 0x3f80248d, 0x250dbf80, 0xbf80a554, 0x3f6d3ec4, 0x3e95bf75, 0xbf7bbe48, 0xbdc93f7f
.long 0x3f35bf35, 0xbf55bf0e, 0xbec43f6d, 0x3f7b3e48, 0xbec4bf6d, 0xbf463f22, 0x3f553f0e, 0x3e95bf75
.long 0xbf80a554, 0x3ec43f6d, 0x3f35bf35, 0xbf6dbec4, 0xbec43f6d, 0x3f7fbdc9, 0xbf0ebf55, 0xbef13f62
.long 0x3f353f35, 0x3e48bf7b, 0xbf6d3ec4, 0x3f553f0e, 0x3f6dbec4, 0xbf62bef1, 0x3e483f7b, 0x3f22bf46
.long 0x250dbf80, 0xbf353f35, 0x3f80248d, 0xbf35bf35, 0xbf6dbec4, 0x3ef13f62, 0x3e48bf7b, 0xbf463f22
.long 0xbf353f35, 0x3f7bbe48, 0xbf6dbec4, 0x3f0e3f55, 0x3ec43f6d, 0x3dc9bf7f, 0xbf0e3f55, 0x3f62bef1
.long 0x3f80248d, 0xbf6dbec4, 0x3f353f35, 0xbec4bf6d, 0x3ec4bf6d, 0xbf223f46, 0x3f55bf0e, 0xbf753e95
.long 0xbf35bf35, 0x3f0e3f55, 0xbec4bf6d, 0x3e483f7b, 0xbf6d3ec4, 0x3f75be95, 0xbf7b3e48, 0x3f7fbdc9
.long 0x3f808000, 0x248dbf80, 0xbf80a50d, 0xa5543f80, 0x3ec4bf6d, 0xbf75be95, 0xbe483f7b, 0x3f7f3dc9
.long 0xbf35bf35, 0xbf0e3f55, 0x3f6d3ec4, 0x3e48bf7b, 0xbf6d3ec4, 0x3f223f46, 0x3f0ebf55, 0xbf75be95
.long 0xa5543f80, 0x3f6dbec4, 0xbf35bf35, 0xbec43f6d, 0x3f6d3ec4, 0xbdc9bf7f, 0xbf553f0e, 0x3f623ef1
.long 0x3f35bf35, 0xbf7bbe48, 0x3ec43f6d, 0x3f0ebf55, 0xbec4bf6d, 0xbef13f62, 0x3f7bbe48, 0xbf46bf22
.long 0xbf80a50d, 0x3f353f35, 0x248dbf80, 0xbf353f35, 0xbec43f6d, 0x3f62bef1, 0xbf7bbe48, 0x3f223f46
.long 0x3f353f35, 0xbe48bf7b, 0xbec43f6d, 0x3f55bf0e, 0x3f6dbec4, 0xbf7fbdc9, 0x3f553f0e, 0xbef1bf62
.long 0x248dbf80, 0xbec43f6d, 0x3f35bf35, 0xbf6d3ec4, 0xbf6dbec4, 0x3f463f22, 0xbf0ebf55, 0x3e953f75
.long 0xbf353f35, 0x3f55bf0e, 0xbf6d3ec4, 0x3f7bbe48, 0x3ec43f6d, 0xbe95bf75, 0x3e483f7b, 0xbdc9bf7f
.long 0x00003f80, 0x3f80248d, 0x250dbf80, 0xbf80a554, 0x3f80248d, 0xbdc9bf7f, 0xbf7b3e48, 0x3e953f75
.long 0x250dbf80, 0xbf7b3e48, 0x3ec43f6d, 0x3f55bf0e, 0xbf80a554, 0x3e953f75, 0x3f55bf0e, 0xbf46bf22
.long 0x00003f80, 0x3f6dbec4, 0xbf35bf35, 0xbec43f6d, 0x3f80248d, 0xbef1bf62, 0xbf0e3f55, 0x3f7f3dc9
.long 0x250dbf80, 0xbf553f0e, 0x3f6d3ec4, 0xbe48bf7b, 0xbf80a554, 0x3f223f46, 0x3e48bf7b, 0xbf623ef1
.long 0x00003f80, 0x3f35bf35, 0xbf80a554, 0x3f353f35, 0x3f80248d, 0xbf46bf22, 0x3e483f7b, 0x3ef1bf62
.long 0x250dbf80, 0xbf0e3f55, 0x3f6dbec4, 0xbf7bbe48, 0xbf80a554, 0x3f623ef1, 0xbf0ebf55, 0x3dc93f7f
.long 0x00003f80, 0x3ec4bf6d, 0xbf353f35, 0x3f6dbec4, 0x3f80248d, 0xbf75be95, 0x3f553f0e, 0xbf22bf46
.long 0x250dbf80, 0xbe483f7b, 0x3ec4bf6d, 0xbf0e3f55, 0xbf80a554, 0x3f7f3dc9, 0xbf7bbe48, 0x3f753e95
.long 0x3f808000, 0x248dbf80, 0xbf80a50d, 0xa5543f80, 0x248dbf80, 0xbf7f3dc9, 0x3e483f7b, 0x3f75be95
.long 0xbf80a50d, 0x3e483f7b, 0x3f6dbec4, 0xbf0ebf55, 0xa5543f80, 0x3f75be95, 0xbf0ebf55, 0xbf223f46
.long 0x3f808000, 0xbec4bf6d, 0xbf353f35, 0x3f6d3ec4, 0x248dbf80, 0xbf623ef1, 0x3f553f0e, 0x3dc9bf7f
.long 0xbf80a50d, 0x3f0e3f55, 0x3ec4bf6d, 0xbf7b3e48, 0xa5543f80, 0x3f46bf22, 0xbf7bbe48, 0x3ef13f62
.long 0x3f808000, 0xbf35bf35, 0xa5543f80, 0x3f35bf35, 0x248dbf80, 0xbf223f46, 0x3f7bbe48, 0xbf62bef1
.long 0xbf80a50d, 0x3f553f0e, 0xbec4bf6d, 0xbe483f7b, 0xa5543f80, 0x3ef1bf62, 0xbf553f0e, 0x3f7fbdc9
.long 0x3f808000, 0xbf6dbec4, 0x3f353f35, 0xbec4bf6d, 0x248dbf80, 0xbe953f75, 0x3f0ebf55, 0xbf463f22
.long 0xbf80a50d, 0x3f7b3e48, 0xbf6dbec4, 0x3f553f0e, 0xa5543f80, 0x3dc9bf7f, 0xbe483f7b, 0x3e95bf75
.long 0x00003f80, 0x3f80248d, 0x250dbf80, 0xbf80a554, 0x3f6dbec4, 0xbef1bf62, 0xbf553f0e, 0x3f223f46
.long 0xbf35bf35, 0xbf0e3f55, 0x3f6d3ec4, 0x3e48bf7b, 0xbec43f6d, 0x3f7f3dc9, 0xbe48bf7b, 0xbf623ef1
.long 0x3f80248d, 0xbec4bf6d, 0xbf353f35, 0x3f6d3ec4, 0xbec4bf6d, 0xbf223f46, 0x3f7b3e48, 0xbe95bf75
.long 0xbf353f35, 0x3f7b3e48, 0xbec4bf6d, 0xbf0e3f55, 0x3f6d3ec4, 0xbe95bf75, 0xbf0e3f55, 0x3f7fbdc9
.long 0x250dbf80, 0xbf353f35, 0x3f80248d, 0xbf35bf35, 0xbf6d3ec4, 0x3f753e95, 0xbf0ebf55, 0xbdc93f7f
.long 0x3f353f35, 0xbe48bf7b, 0xbec43f6d, 0x3f55bf0e, 0x3ec4bf6d, 0xbf463f22, 0x3f7bbe48, 0xbf75be95
.long 0xbf80a554, 0x3f6d3ec4, 0xbf35bf35, 0x3ec43f6d, 0x3ec43f6d, 0xbdc9bf7f, 0xbe483f7b, 0x3ef1bf62
.long 0x3f35bf35, 0xbf553f0e, 0x3f6dbec4, 0xbf7b3e48, 0xbf6dbec4, 0x3f623ef1, 0xbf55bf0e, 0x3f463f22
.long 0x3f808000, 0x248dbf80, 0xbf80a50d, 0xa5543f80, 0xbec4bf6d, 0xbf623ef1, 0x3f0e3f55, 0x3f46bf22
.long 0xbf353f35, 0x3f553f0e, 0x3ec4bf6d, 0xbf7bbe48, 0x3f6d3ec4, 0x3dc9bf7f, 0xbf7b3e48, 0x3ef13f62
.long 0x248dbf80, 0xbf6d3ec4, 0x3f353f35, 0x3ec4bf6d, 0xbf6d3ec4, 0x3f463f22, 0x3e48bf7b, 0xbf753e95
.long 0x3f353f35, 0x3e48bf7b, 0xbf6d3ec4, 0x3f553f0e, 0x3ec4bf6d, 0xbf753e95, 0x3f553f0e, 0xbdc9bf7f
.long 0xbf80a50d, 0x3f353f35, 0x248dbf80, 0xbf353f35, 0x3ec43f6d, 0x3e95bf75, 0xbf553f0e, 0x3f7f3dc9
.long 0x3f35bf35, 0xbf7b3e48, 0x3f6d3ec4, 0xbf0ebf55, 0xbf6dbec4, 0x3f223f46, 0xbe48bf7b, 0xbe953f75
.long 0xa5543f80, 0x3ec4bf6d, 0xbf353f35, 0x3f6dbec4, 0x3f6dbec4, 0xbf7f3dc9, 0x3f7b3e48, 0xbf62bef1
.long 0xbf35bf35, 0x3f0e3f55, 0xbec4bf6d, 0x3e483f7b, 0xbec43f6d, 0x3ef1bf62, 0xbf0e3f55, 0x3f22bf46
.long 0x00003f80, 0x3f80248d, 0x250dbf80, 0xbf80a554, 0x3f35bf35, 0xbf46bf22, 0xbf0e3f55, 0x3f623ef1
.long 0xbf80a554, 0x3e483f7b, 0x3f6dbec4, 0xbf0ebf55, 0x3f353f35, 0x3ef1bf62, 0xbf7bbe48, 0x3dc93f7f
.long 0x250dbf80, 0xbf6d3ec4, 0x3f353f35, 0x3ec4bf6d, 0xbf353f35, 0x3f753e95, 0xbe48bf7b, 0xbf463f22
.long 0x3f80248d, 0xbf0ebf55, 0xbec43f6d, 0x3f7bbe48, 0xbf35bf35, 0xbdc93f7f, 0x3f55bf0e, 0xbf75be95
.long 0x00003f80, 0x3f35bf35, 0xbf80a554, 0x3f353f35, 0x3f35bf35, 0xbf7f3dc9, 0x3f553f0e, 0xbe95bf75
.long 0xbf80a554, 0x3f553f0e, 0xbec4bf6d, 0xbe483f7b, 0x3f353f35, 0xbe95bf75, 0xbe483f7b, 0x3f22bf46
.long 0x250dbf80, 0xbec43f6d, 0x3f35bf35, 0xbf6d3ec4, 0xbf353f35, 0x3f62bef1, 0xbf7b3e48, 0x3f7f3dc9
.long 0x3f80248d, 0xbf7bbe48, 0x3f6d3ec4, 0xbf55bf0e, 0xbf35bf35, 0x3f223f46, 0xbf0ebf55, 0x3ef13f62
.long 0x3f808000, 0x248dbf80, 0xbf80a50d, 0xa5543f80, 0xbf35bf35, 0xbf223f46, 0x3f553f0e, 0x3ef1bf62
.long 0xa5543f80, 0x3f7bbe48, 0xbec4bf6d, 0xbf553f0e, 0x3f35bf35, 0xbf62bef1, 0xbe483f7b, 0x3f7fbdc9
.long 0xbf80a50d, 0x3ec43f6d, 0x3f35bf35, 0xbf6dbec4, 0x3f353f35, 0x3e95bf75, 0xbf7b3e48, 0x3f223f46
.long 0x248dbf80, 0xbf553f0e, 0x3f6d3ec4, 0xbe48bf7b, 0xbf353f35, 0x3f7f3dc9, 0xbf0ebf55, 0xbe953f75
.long 0x3f808000, 0xbf35bf35, 0xa5543f80, 0x3f35bf35, 0xbf35bf35, 0x3dc93f7f, 0x3f0ebf55, 0xbf753e95
.long 0xa5543f80, 0x3f0ebf55, 0xbf6d3ec4, 0x3f7b3e48, 0x3f35bf35, 0xbf753e95, 0x3f7b3e48, 0xbf46bf22
.long 0xbf80a50d, 0x3f6d3ec4, 0xbf35bf35, 0x3ec43f6d, 0x3f353f35, 0xbef1bf62, 0x3e483f7b, 0x3dc9bf7f
.long 0x248dbf80, 0xbe483f7b, 0x3ec4bf6d, 0xbf0e3f55, 0xbf353f35, 0x3f46bf22, 0xbf553f0e, 0x3f62bef1
.long 0x00003f80, 0x3f80248d, 0x250dbf80, 0xbf80a554, 0x3ec4bf6d, 0xbf75be95, 0xbe483f7b, 0x3f7f3dc9
.long 0xbf353f35, 0x3f553f0e, 0x3ec4bf6d, 0xbf7bbe48, 0x3f6dbec4, 0xbf22bf46, 0xbf0e3f55, 0x3f753e95
.long 0xbf80a554, 0x3ec43f6d, 0x3f35bf35, 0xbf6dbec4, 0x3f6d3ec4, 0xbdc9bf7f, 0xbf553f0e, 0x3f623ef1
.long 0xbf35bf35, 0xbe483f7b, 0x3f6dbec4, 0xbf55bf0e, 0x3ec43f6d, 0x3ef1bf62, 0xbf7b3e48, 0x3f463f22
.long 0x250dbf80, 0xbf353f35, 0x3f80248d, 0xbf35bf35, 0xbec43f6d, 0x3f62bef1, 0xbf7bbe48, 0x3f223f46
.long 0x3f35bf35, 0xbf7b3e48, 0x3f6d3ec4, 0xbf0ebf55, 0xbf6d3ec4, 0x3f7f3dc9, 0xbf55bf0e, 0x3ef13f62
.long 0x3f80248d, 0xbf6dbec4, 0x3f353f35, 0xbec4bf6d, 0xbf6dbec4, 0x3f463f22, 0xbf0ebf55, 0x3e953f75
.long 0x3f353f35, 0xbf0ebf55, 0x3ec43f6d, 0xbe48bf7b, 0xbec4bf6d, 0x3e953f75, 0xbe48bf7b, 0x3dc93f7f
.long 0x3f808000, 0x248dbf80, 0xbf80a50d, 0xa5543f80, 0xbf6dbec4, 0xbe953f75, 0x3f7b3e48, 0x3dc9bf7f
.long 0x3f353f35, 0x3f0ebf55, 0xbf6dbec4, 0xbe483f7b, 0xbec4bf6d, 0xbf463f22, 0x3f553f0e, 0x3e95bf75
.long 0xa5543f80, 0x3f6dbec4, 0xbf35bf35, 0xbec43f6d, 0x3ec4bf6d, 0xbf7f3dc9, 0x3f0e3f55, 0x3ef1bf62
.long 0xbf353f35, 0x3f7b3e48, 0xbec4bf6d, 0xbf0e3f55, 0x3f6dbec4, 0xbf62bef1, 0x3e483f7b, 0x3f22bf46
.long 0xbf80a50d, 0x3f353f35, 0x248dbf80, 0xbf353f35, 0x3f6d3ec4, 0xbef1bf62, 0xbe483f7b, 0x3f46bf22
.long 0xbf35bf35, 0x3e483f7b, 0x3ec4bf6d, 0xbf553f0e, 0x3ec43f6d, 0x3dc9bf7f, 0xbf0e3f55, 0x3f62bef1
.long 0x248dbf80, 0xbec43f6d, 0x3f35bf35, 0xbf6d3ec4, 0xbec43f6d, 0x3f22bf46, 0xbf553f0e, 0x3f75be95
.long 0x3f35bf35, 0xbf553f0e, 0x3f6dbec4, 0xbf7b3e48, 0xbf6d3ec4, 0x3f75be95, 0xbf7b3e48, 0x3f7fbdc9
.long 0x00003f80, 0x3f80248d, 0x250dbf80, 0xbf80a554, 0x250dbf80, 0xbf7f3dc9, 0x3e483f7b, 0x3f75be95
.long 0x00003f80, 0x3f7bbe48, 0xbec4bf6d, 0xbf553f0e, 0x250dbf80, 0xbf753e95, 0x3f0e3f55, 0x3f22bf46
.long 0x00003f80, 0x3f6dbec4, 0xbf35bf35, 0xbec43f6d, 0x250dbf80, 0xbf623ef1, 0x3f553f0e, 0x3dc9bf7f
.long 0x00003f80, 0x3f55bf0e, 0xbf6dbec4, 0x3e483f7b, 0x250dbf80, 0xbf463f22, 0x3f7b3e48, 0xbef1bf62
.long 0x00003f80, 0x3f35bf35, 0xbf80a554, 0x3f353f35, 0x250dbf80, 0xbf223f46, 0x3f7bbe48, 0xbf62bef1
.long 0x00003f80, 0x3f0ebf55, 0xbf6d3ec4, 0x3f7b3e48, 0x250dbf80, 0xbef13f62, 0x3f55bf0e, 0xbf7f3dc9
.long 0x00003f80, 0x3ec4bf6d, 0xbf353f35, 0x3f6dbec4, 0x250dbf80, 0xbe953f75, 0x3f0ebf55, 0xbf463f22
.long 0x00003f80, 0x3e48bf7b, 0xbec43f6d, 0x3f0ebf55, 0x250dbf80, 0xbdc93f7f, 0x3e48bf7b, 0xbe953f75
.long 0x3f808000, 0x248dbf80, 0xbf80a50d, 0xa5543f80, 0xbf80a50d, 0x3dc93f7f, 0x3f7bbe48, 0xbe95bf75
.long 0x3f808000, 0xbe48bf7b, 0xbf6d3ec4, 0x3f0e3f55, 0xbf80a50d, 0x3e953f75, 0x3f55bf0e, 0xbf46bf22
.long 0x3f808000, 0xbec4bf6d, 0xbf353f35, 0x3f6d3ec4, 0xbf80a50d, 0x3ef13f62, 0x3f0ebf55, 0xbf7fbdc9
.long 0x3f808000, 0xbf0ebf55, 0xbec43f6d, 0x3f7bbe48, 0xbf80a50d, 0x3f223f46, 0x3e48bf7b, 0xbf623ef1
.long 0x3f808000, 0xbf35bf35, 0xa5543f80, 0x3f35bf35, 0xbf80a50d, 0x3f463f22, 0xbe48bf7b, 0xbef13f62
.long 0x3f808000, 0xbf55bf0e, 0x3ec43f6d, 0x3e48bf7b, 0xbf80a50d, 0x3f623ef1, 0xbf0ebf55, 0x3dc93f7f
.long 0x3f808000, 0xbf6dbec4, 0x3f353f35, 0xbec4bf6d, 0xbf80a50d, 0x3f753e95, 0xbf55bf0e, 0x3f223f46
.long 0x3f808000, 0xbf7bbe48, 0x3f6d3ec4, 0xbf55bf0e, 0xbf80a50d, 0x3f7f3dc9, 0xbf7bbe48, 0x3f753e95
.long 0x00003f80, 0x3f80248d, 0x250dbf80, 0xbf80a554, 0xbec4bf6d, 0xbf623ef1, 0x3f0e3f55, 0x3f46bf22
.long 0x3f353f35, 0x3f0ebf55, 0xbf6dbec4, 0xbe483f7b, 0xbf6dbec4, 0xbdc93f7f, 0x3f7bbe48, 0xbef1bf62
.long 0x3f80248d, 0xbec4bf6d, 0xbf353f35, 0x3f6d3ec4, 0xbf6d3ec4, 0x3f463f22, 0x3e48bf7b, 0xbf753e95
.long 0x3f35bf35, 0xbf7bbe48, 0x3ec43f6d, 0x3f0ebf55, 0xbec43f6d, 0x3f75be95, 0xbf55bf0e, 0x3dc93f7f
.long 0x250dbf80, 0xbf353f35, 0x3f80248d, 0xbf35bf35, 0x3ec43f6d, 0x3e95bf75, 0xbf553f0e, 0x3f7f3dc9
.long 0xbf35bf35, 0x3e483f7b, 0x3ec4bf6d, 0xbf553f0e, 0x3f6d3ec4, 0xbf22bf46, 0x3e483f7b, 0x3e95bf75
.long 0xbf80a554, 0x3f6d3ec4, 0xbf35bf35, 0x3ec43f6d, 0x3f6dbec4, 0xbf7f3dc9, 0x3f7b3e48, 0xbf62bef1
.long 0xbf353f35, 0x3f55bf0e, 0xbf6d3ec4, 0x3f7bbe48, 0x3ec4bf6d, 0xbef13f62, 0x3f0ebf55, 0xbf223f46
.long 0x3f808000, 0x248dbf80, 0xbf80a50d, 0xa5543f80, 0xbf6d3ec4, 0x3ef13f62, 0x3f55bf0e, 0xbf22bf46
.long 0x3f35bf35, 0xbf55bf0e, 0xbec43f6d, 0x3f7b3e48, 0xbec43f6d, 0x3f7f3dc9, 0xbe48bf7b, 0xbf623ef1
.long 0x248dbf80, 0xbf6d3ec4, 0x3f353f35, 0x3ec4bf6d, 0x3ec43f6d, 0x3f22bf46, 0xbf7bbe48, 0x3e953f75
.long 0xbf35bf35, 0xbe483f7b, 0x3f6dbec4, 0xbf55bf0e, 0x3f6d3ec4, 0xbe95bf75, 0xbf0e3f55, 0x3f7fbdc9
.long 0xbf80a50d, 0x3f353f35, 0x248dbf80, 0xbf353f35, 0x3f6dbec4, 0xbf75be95, 0x3f0e3f55, 0x3dc9bf7f
.long 0xbf353f35, 0x3f7bbe48, 0xbf6dbec4, 0x3f0e3f55, 0x3ec4bf6d, 0xbf463f22, 0x3f7bbe48, 0xbf75be95
.long 0xa5543f80, 0x3ec4bf6d, 0xbf353f35, 0x3f6dbec4, 0xbec4bf6d, 0x3dc93f7f, 0x3e48bf7b, 0xbef13f62
.long 0x3f353f35, 0xbf0ebf55, 0x3ec43f6d, 0xbe48bf7b, 0xbf6dbec4, 0x3f623ef1, 0xbf55bf0e, 0x3f463f22
.long 0x00003f80, 0x3f80248d, 0x250dbf80, 0xbf80a554, 0xbf35bf35, 0xbf223f46, 0x3f553f0e, 0x3ef1bf62
.long 0x3f80248d, 0xbe48bf7b, 0xbf6d3ec4, 0x3f0e3f55, 0xbf353f35, 0x3f623ef1, 0x3e48bf7b, 0xbf7f3dc9
.long 0x250dbf80, 0xbf6d3ec4, 0x3f353f35, 0x3ec4bf6d, 0x3f353f35, 0x3e95bf75, 0xbf7b3e48, 0x3f223f46
.long 0xbf80a554, 0x3f0e3f55, 0x3ec4bf6d, 0xbf7b3e48, 0x3f35bf35, 0xbf7fbdc9, 0x3f0e3f55, 0x3e95bf75
.long 0x00003f80, 0x3f35bf35, 0xbf80a554, 0x3f353f35, 0xbf35bf35, 0x3dc93f7f, 0x3f0ebf55, 0xbf753e95
.long 0x3f80248d, 0xbf55bf0e, 0x3ec43f6d, 0x3e48bf7b, 0xbf353f35, 0x3f75be95, 0xbf7bbe48, 0x3f463f22
.long 0x250dbf80, 0xbec43f6d, 0x3f35bf35, 0xbf6d3ec4, 0x3f353f35, 0xbef1bf62, 0x3e483f7b, 0x3dc9bf7f
.long 0xbf80a554, 0x3f7b3e48, 0xbf6dbec4, 0x3f553f0e, 0x3f35bf35, 0xbf463f22, 0x3f55bf0e, 0xbf623ef1
.long 0x3f808000, 0x248dbf80, 0xbf80a50d, 0xa5543f80, 0xbf353f35, 0x3f463f22, 0x3f0ebf55, 0xbf62bef1
.long 0x248dbf80, 0xbf7b3e48, 0x3ec43f6d, 0x3f55bf0e, 0x3f353f35, 0x3ef1bf62, 0xbf7bbe48, 0x3dc93f7f
.long 0xbf80a50d, 0x3ec43f6d, 0x3f35bf35, 0xbf6dbec4, 0x3f35bf35, 0xbf75be95, 0x3e483f7b, 0x3f46bf22
.long 0xa5543f80, 0x3f55bf0e, 0xbf6dbec4, 0x3e483f7b, 0xbf35bf35, 0xbdc93f7f, 0x3f55bf0e, 0xbf75be95
.long 0x3f808000, 0xbf35bf35, 0xa5543f80, 0x3f35bf35, 0xbf353f35, 0x3f7fbdc9, 0xbf55bf0e, 0x3e953f75
.long 0x248dbf80, 0xbf0e3f55, 0x3f6dbec4, 0xbf7bbe48, 0x3f353f35, 0xbe95bf75, 0xbe483f7b, 0x3f22bf46
.long 0xbf80a50d, 0x3f6d3ec4, 0xbf35bf35, 0x3ec43f6d, 0x3f35bf35, 0xbf623ef1, 0x3f7bbe48, 0xbf7fbdc9
.long 0xa5543f80, 0x3e48bf7b, 0xbec43f6d, 0x3f0ebf55, 0xbf35bf35, 0x3f223f46, 0xbf0ebf55, 0x3ef13f62
.long 0x00003f80, 0x3f80248d, 0x250dbf80, 0xbf80a554, 0xbf6dbec4, 0xbe953f75, 0x3f7b3e48, 0x3dc9bf7f
.long 0x3f35bf35, 0xbf55bf0e, 0xbec43f6d, 0x3f7b3e48, 0x3ec43f6d, 0x3f46bf22, 0xbf55bf0e, 0xbe953f75
.long 0xbf80a554, 0x3ec43f6d, 0x3f35bf35, 0xbf6dbec4, 0x3ec4bf6d, 0xbf7f3dc9, 0x3f0e3f55, 0x3ef1bf62
.long 0x3f353f35, 0x3e48bf7b, 0xbf6d3ec4, 0x3f553f0e, 0xbf6d3ec4, 0x3f623ef1, 0xbe48bf7b, 0xbf223f46
.long 0x250dbf80, 0xbf353f35, 0x3f80248d, 0xbf35bf35, 0x3f6d3ec4, 0xbef1bf62, 0xbe483f7b, 0x3f46bf22
.long 0xbf353f35, 0x3f7bbe48, 0xbf6dbec4, 0x3f0e3f55, 0xbec4bf6d, 0xbdc93f7f, 0x3f0ebf55, 0xbf623ef1
.long 0x3f80248d, 0xbf6dbec4, 0x3f353f35, 0xbec4bf6d, 0xbec43f6d, 0x3f22bf46, 0xbf553f0e, 0x3f75be95
.long 0xbf35bf35, 0x3f0e3f55, 0xbec4bf6d, 0x3e483f7b, 0x3f6dbec4, 0xbf753e95, 0x3f7bbe48, 0xbf7f3dc9
.long 0x3f808000, 0x248dbf80, 0xbf80a50d, 0xa5543f80, 0xbec43f6d, 0x3f753e95, 0x3e48bf7b, 0xbf7fbdc9
.long 0xbf35bf35, 0xbf0e3f55, 0x3f6d3ec4, 0x3e48bf7b, 0x3f6dbec4, 0xbf22bf46, 0xbf0e3f55, 0x3f753e95
.long 0xa5543f80, 0x3f6dbec4, 0xbf35bf35, 0xbec43f6d, 0xbf6dbec4, 0x3dc93f7f, 0x3f55bf0e, 0xbf62bef1
.long 0x3f35bf35, 0xbf7bbe48, 0x3ec43f6d, 0x3f0ebf55, 0x3ec43f6d, 0x3ef1bf62, 0xbf7b3e48, 0x3f463f22
.long 0xbf80a50d, 0x3f353f35, 0x248dbf80, 0xbf353f35, 0x3ec4bf6d, 0xbf623ef1, 0x3f7b3e48, 0xbf22bf46
.long 0x3f353f35, 0xbe48bf7b, 0xbec43f6d, 0x3f55bf0e, 0xbf6d3ec4, 0x3f7f3dc9, 0xbf55bf0e, 0x3ef13f62
.long 0x248dbf80, 0xbec43f6d, 0x3f35bf35, 0xbf6d3ec4, 0x3f6d3ec4, 0xbf46bf22, 0x3f0e3f55, 0xbe95bf75
.long 0xbf353f35, 0x3f55bf0e, 0xbf6d3ec4, 0x3f7bbe48, 0xbec4bf6d, 0x3e953f75, 0xbe48bf7b, 0x3dc93f7f
.long 0x00003f80, 0x3f80248d, 0x250dbf80, 0xbf80a554, 0xbf80a554, 0x3dc93f7f, 0x3f7bbe48, 0xbe95bf75
.long 0x250dbf80, 0xbf7b3e48, 0x3ec43f6d, 0x3f55bf0e, 0x3f80248d, 0xbe95bf75, 0xbf553f0e, 0x3f463f22
.long 0x00003f80, 0x3f6dbec4, 0xbf35bf35, 0xbec43f6d, 0xbf80a554, 0x3ef13f62, 0x3f0ebf55, 0xbf7fbdc9
.long 0x250dbf80, 0xbf553f0e, 0x3f6d3ec4, 0xbe48bf7b, 0x3f80248d, 0xbf22bf46, 0xbe483f7b, 0x3f62bef1
.long 0x00003f80, 0x3f35bf35, 0xbf80a554, 0x3f353f35, 0xbf80a554, 0x3f463f22, 0xbe48bf7b, 0xbef13f62
.long 0x250dbf80, 0xbf0e3f55, 0x3f6dbec4, 0xbf7bbe48, 0x3f80248d, 0xbf62bef1, 0x3f0e3f55, 0xbdc9bf7f
.long 0x00003f80, 0x3ec4bf6d, 0xbf353f35, 0x3f6dbec4, 0xbf80a554, 0x3f753e95, 0xbf55bf0e, 0x3f223f46
.long 0x250dbf80, 0xbe483f7b, 0x3ec4bf6d, 0xbf0e3f55, 0x3f80248d, 0xbf7fbdc9, 0x3f7b3e48, 0xbf75be95
.long 0x3f808000, 0x248dbf80, 0xbf80a50d, 0xa5543f80, 0xa5543f80, 0x3f7fbdc9, 0xbe48bf7b, 0xbf753e95
.long 0xbf80a50d, 0x3e483f7b, 0x3f6dbec4, 0xbf0ebf55, 0x248dbf80, 0xbf753e95, 0x3f0e3f55, 0x3f22bf46
.long 0x3f808000, 0xbec4bf6d, 0xbf353f35, 0x3f6d3ec4, 0xa5543f80, 0x3f62bef1, 0xbf55bf0e, 0xbdc93f7f
.long 0xbf80a50d, 0x3f0e3f55, 0x3ec4bf6d, 0xbf7b3e48, 0x248dbf80, 0xbf463f22, 0x3f7b3e48, 0xbef1bf62
.long 0x3f808000, 0xbf35bf35, 0xa5543f80, 0x3f35bf35, 0xa5543f80, 0x3f22bf46, 0xbf7b3e48, 0x3f623ef1
.long 0xbf80a50d, 0x3f553f0e, 0xbec4bf6d, 0xbe483f7b, 0x248dbf80, 0xbef13f62, 0x3f55bf0e, 0xbf7f3dc9
.long 0x3f808000, 0xbf6dbec4, 0x3f353f35, 0xbec4bf6d, 0xa5543f80, 0x3e95bf75, 0xbf0e3f55, 0x3f46bf22
.long 0xbf80a50d, 0x3f7b3e48, 0xbf6dbec4, 0x3f553f0e, 0x248dbf80, 0xbdc93f7f, 0x3e48bf7b, 0xbe953f75
.long 0x00003f80, 0x3f80248d, 0x250dbf80, 0xbf80a554, 0xbf6d3ec4, 0x3ef13f62, 0x3f55bf0e, 0xbf22bf46
.long 0xbf35bf35, 0xbf0e3f55, 0x3f6d3ec4, 0x3e48bf7b, 0x3ec4bf6d, 0xbf7fbdc9, 0x3e483f7b, 0x3f62bef1
.long 0x3f80248d, 0xbec4bf6d, 0xbf353f35, 0x3f6d3ec4, 0x3ec43f6d, 0x3f22bf46, 0xbf7bbe48, 0x3e953f75
.long 0xbf353f35, 0x3f7b3e48, 0xbec4bf6d, 0xbf0e3f55, 0xbf6dbec4, 0x3e953f75, 0x3f0ebf55, 0xbf7f3dc9
.long 0x250dbf80, 0xbf353f35, 0x3f80248d, 0xbf35bf35, 0x3f6dbec4, 0xbf75be95, 0x3f0e3f55, 0x3dc9bf7f
.long 0x3f353f35, 0xbe48bf7b, 0xbec43f6d, 0x3f55bf0e, 0xbec43f6d, 0x3f46bf22, 0xbf7b3e48, 0x3f753e95
.long 0xbf80a554, 0x3f6d3ec4, 0xbf35bf35, 0x3ec43f6d, 0xbec4bf6d, 0x3dc93f7f, 0x3e48bf7b, 0xbef13f62
.long 0x3f35bf35, 0xbf553f0e, 0x3f6dbec4, 0xbf7b3e48, 0x3f6d3ec4, 0xbf62bef1, 0x3f553f0e, 0xbf46bf22
.long 0x3f808000, 0x248dbf80, 0xbf80a50d, 0xa5543f80, 0x3ec43f6d, 0x3f62bef1, 0xbf0ebf55, 0xbf463f22
.long 0xbf353f35, 0x3f553f0e, 0x3ec4bf6d, 0xbf7bbe48, 0xbf6dbec4, 0xbdc93f7f, 0x3f7bbe48, 0xbef1bf62
.long 0x248dbf80, 0xbf6d3ec4, 0x3f353f35, 0x3ec4bf6d, 0x3f6dbec4, 0xbf46bf22, 0xbe483f7b, 0x3f75be95
.long 0x3f353f35, 0x3e48bf7b, 0xbf6d3ec4, 0x3f553f0e, 0xbec43f6d, 0x3f75be95, 0xbf55bf0e, 0x3dc93f7f
.long 0xbf80a50d, 0x3f353f35, 0x248dbf80, 0xbf353f35, 0xbec4bf6d, 0xbe953f75, 0x3f55bf0e, 0xbf7fbdc9
.long 0x3f35bf35, 0xbf7b3e48, 0x3f6d3ec4, 0xbf0ebf55, 0x3f6d3ec4, 0xbf22bf46, 0x3e483f7b, 0x3e95bf75
.long 0xa5543f80, 0x3ec4bf6d, 0xbf353f35, 0x3f6dbec4, 0xbf6d3ec4, 0x3f7fbdc9, 0xbf7bbe48, 0x3f623ef1
.long 0xbf35bf35, 0x3f0e3f55, 0xbec4bf6d, 0x3e483f7b, 0x3ec4bf6d, 0xbef13f62, 0x3f0ebf55, 0xbf223f46
.long 0x00003f80, 0x3f80248d, 0x250dbf80, 0xbf80a554, 0xbf353f35, 0x3f463f22, 0x3f0ebf55, 0xbf62bef1
.long 0xbf80a554, 0x3e483f7b, 0x3f6dbec4, 0xbf0ebf55, 0xbf35bf35, 0xbef13f62, 0x3f7b3e48, 0xbdc9bf7f
.long 0x250dbf80, 0xbf6d3ec4, 0x3f353f35, 0x3ec4bf6d, 0x3f35bf35, 0xbf75be95, 0x3e483f7b, 0x3f46bf22
.long 0x3f80248d, 0xbf0ebf55, 0xbec43f6d, 0x3f7bbe48, 0x3f353f35, 0x3dc9bf7f, 0xbf553f0e, 0x3f753e95
.long 0x00003f80, 0x3f35bf35, 0xbf80a554, 0x3f353f35, 0xbf353f35, 0x3f7fbdc9, 0xbf55bf0e, 0x3e953f75
.long 0xbf80a554, 0x3f553f0e, 0xbec4bf6d, 0xbe483f7b, 0xbf35bf35, 0x3e953f75, 0x3e48bf7b, 0xbf223f46
.long 0x250dbf80, 0xbec43f6d, 0x3f35bf35, 0xbf6d3ec4, 0x3f35bf35, 0xbf623ef1, 0x3f7bbe48, 0xbf7fbdc9
.long 0x3f80248d, 0xbf7bbe48, 0x3f6d3ec4, 0xbf55bf0e, 0x3f353f35, 0xbf22bf46, 0x3f0e3f55, 0xbef1bf62
.long 0x3f808000, 0x248dbf80, 0xbf80a50d, 0xa5543f80, 0x3f353f35, 0x3f22bf46, 0xbf55bf0e, 0xbef13f62
.long 0xa5543f80, 0x3f7bbe48, 0xbec4bf6d, 0xbf553f0e, 0xbf353f35, 0x3f623ef1, 0x3e48bf7b, 0xbf7f3dc9
.long 0xbf80a50d, 0x3ec43f6d, 0x3f35bf35, 0xbf6dbec4, 0xbf35bf35, 0xbe953f75, 0x3f7bbe48, 0xbf22bf46
.long 0x248dbf80, 0xbf553f0e, 0x3f6d3ec4, 0xbe48bf7b, 0x3f35bf35, 0xbf7fbdc9, 0x3f0e3f55, 0x3e95bf75
.long 0x3f808000, 0xbf35bf35, 0xa5543f80, 0x3f35bf35, 0x3f353f35, 0xbdc9bf7f, 0xbf0e3f55, 0x3f75be95
.long 0xa5543f80, 0x3f0ebf55, 0xbf6d3ec4, 0x3f7b3e48, 0xbf353f35, 0x3f75be95, 0xbf7bbe48, 0x3f463f22
.long 0xbf80a50d, 0x3f6d3ec4, 0xbf35bf35, 0x3ec43f6d, 0xbf35bf35, 0x3ef13f62, 0xbe48bf7b, 0xbdc93f7f
.long 0x248dbf80, 0xbe483f7b, 0x3ec4bf6d, 0xbf0e3f55, 0x3f35bf35, 0xbf463f22, 0x3f55bf0e, 0xbf623ef1
.long 0x00003f80, 0x3f80248d, 0x250dbf80, 0xbf80a554, 0xbec43f6d, 0x3f753e95, 0x3e48bf7b, 0xbf7fbdc9
.long 0xbf353f35, 0x3f553f0e, 0x3ec4bf6d, 0xbf7bbe48, 0xbf6d3ec4, 0x3f223f46, 0x3f0ebf55, 0xbf75be95
.long 0xbf80a554, 0x3ec43f6d, 0x3f35bf35, 0xbf6dbec4, 0xbf6dbec4, 0x3dc93f7f, 0x3f55bf0e, 0xbf62bef1
.long 0xbf35bf35, 0xbe483f7b, 0x3f6dbec4, 0xbf55bf0e, 0xbec4bf6d, 0xbef13f62, 0x3f7bbe48, 0xbf46bf22
.long 0x250dbf80, 0xbf353f35, 0x3f80248d, 0xbf35bf35, 0x3ec4bf6d, 0xbf623ef1, 0x3f7b3e48, 0xbf22bf46
.long 0x3f35bf35, 0xbf7b3e48, 0x3f6d3ec4, 0xbf0ebf55, 0x3f6dbec4, 0xbf7fbdc9, 0x3f553f0e, 0xbef1bf62
.long 0x3f80248d, 0xbf6dbec4, 0x3f353f35, 0xbec4bf6d, 0x3f6d3ec4, 0xbf46bf22, 0x3f0e3f55, 0xbe95bf75
.long 0x3f353f35, 0xbf0ebf55, 0x3ec43f6d, 0xbe48bf7b, 0x3ec43f6d, 0xbe95bf75, 0x3e483f7b, 0xbdc9bf7f
.long 0x3f808000, 0x248dbf80, 0xbf80a50d, 0xa5543f80, 0x3f6d3ec4, 0x3e95bf75, 0xbf7bbe48, 0xbdc93f7f
.long 0x3f353f35, 0x3f0ebf55, 0xbf6dbec4, 0xbe483f7b, 0x3ec43f6d, 0x3f46bf22, 0xbf55bf0e, 0xbe953f75
.long 0xa5543f80, 0x3f6dbec4, 0xbf35bf35, 0xbec43f6d, 0xbec43f6d, 0x3f7fbdc9, 0xbf0ebf55, 0xbef13f62
.long 0xbf353f35, 0x3f7b3e48, 0xbec4bf6d, 0xbf0e3f55, 0xbf6d3ec4, 0x3f623ef1, 0xbe48bf7b, 0xbf223f46
.long 0xbf80a50d, 0x3f353f35, 0x248dbf80, 0xbf353f35, 0xbf6dbec4, 0x3ef13f62, 0x3e48bf7b, 0xbf463f22
.long 0xbf35bf35, 0x3e483f7b, 0x3ec4bf6d, 0xbf553f0e, 0xbec4bf6d, 0xbdc93f7f, 0x3f0ebf55, 0xbf623ef1
.long 0x248dbf80, 0xbec43f6d, 0x3f35bf35, 0xbf6d3ec4, 0x3ec4bf6d, 0xbf223f46, 0x3f55bf0e, 0xbf753e95
.long 0x3f35bf35, 0xbf553f0e, 0x3f6dbec4, 0xbf7b3e48, 0x3f6dbec4, 0xbf753e95, 0x3f7bbe48, 0xbf7f3dc9
.type tab_W4,@object
.p2align 8
tab_W4:
.long 0x3f803f80, 0x3f803f80, 0x00000000, 0x00000000, 0x80008000, 0x80008000, 0x3f803f80, 0x3f803f80
.long 0x3f7b3f80, 0x3f553f6d, 0x3e480000, 0x3f0e3ec4, 0xbe488000, 0xbf0ebec4, 0x3f7b3f80, 0x3f553f6d
.long 0x248d3f80, 0xa554bf80, 0x3f800000, 0xbf80250d, 0xbf808000, 0x3f80a50d, 0x248d3f80, 0xa554bf80
.long 0xbe483f80, 0x3f0ebf6d, 0x3f7b0000, 0xbf55bec4, 0xbf7b8000, 0x3f553ec4, 0xbe483f80, 0x3f0ebf6d
.long 0x3f6d3f80, 0x3ec43f35, 0x3ec40000, 0x3f6d3f35, 0xbec48000, 0xbf6dbf35, 0x3f6d3f80, 0x3ec43f35
.long 0x3f553f80, 0xbe483ec4, 0x3f0e0000, 0x3f7b3f6d, 0xbf0e8000, 0xbf7bbf6d, 0x3f553f80, 0xbe483ec4
.long 0xbec43f80, 0x3f6dbf35, 0x3f6d0000, 0xbec4bf35, 0xbf6d8000, 0x3ec43f35, 0xbec43f80, 0x3f6dbf35
.long 0xbf0e3f80, 0x3f7bbec4, 0x3f550000, 0x3e48bf6d, 0xbf558000, 0xbe483f6d, 0xbf0e3f80, 0x3f7bbec4
.long 0x3f353f80, 0xbf35248d, 0x3f350000, 0x3f353f80, 0xbf358000, 0xbf35bf80, 0x3f353f80, 0xbf35248d
.long 0x3f0e3f80, 0xbf7bbec4, 0x3f550000, 0x3e483f6d, 0xbf558000, 0xbe48bf6d, 0x3f0e3f80, 0xbf7bbec4
.long 0xbf353f80, 0x3f35a554, 0x3f350000, 0x3f35bf80, 0xbf358000, 0xbf353f80, 0xbf353f80, 0x3f35a554
.long 0xbf553f80, 0x3e483ec4, 0x3f0e0000, 0x3f7bbf6d, 0xbf0e8000, 0xbf7b3f6d, 0xbf553f80, 0x3e483ec4
.long 0x3ec43f80, 0xbf6dbf35, 0x3f6d0000, 0xbec43f35, 0xbf6d8000, 0x3ec4bf35, 0x3ec43f80, 0xbf6dbf35
.long 0x3e483f80, 0xbf0ebf6d, 0x3f7b0000, 0xbf553ec4, 0xbf7b8000, 0x3f55bec4, 0x3e483f80, 0xbf0ebf6d
.long 0xbf6d3f80, 0xbec43f35, 0x3ec40000, 0x3f6dbf35, 0xbec48000, 0xbf6d3f35, 0xbf6d3f80, 0xbec43f35
.long 0xbf7b3f80, 0xbf553f6d, 0x3e480000, 0x3f0ebec4, 0xbe488000, 0xbf0e3ec4, 0xbf7b3f80, 0xbf553f6d
.long 0x3f803f80, 0x3f803f80, 0x00000000, 0x00000000, 0x80008000, 0x80008000, 0x3f803f80, 0x3f803f80
.long 0x3f0e3f35, 0x3e483ec4, 0x3f553f35, 0x3f7b3f6d, 0xbf55bf35, 0xbf7bbf6d, 0x3f0e3f35, 0x3e483ec4
.long 0x248d3f80, 0xa554bf80, 0x3f800000, 0xbf80250d, 0xbf808000, 0x3f80a50d, 0x248d3f80, 0xa554bf80
.long 0xbf553f35, 0x3f7bbec4, 0x3f0e3f35, 0xbe48bf6d, 0xbf0ebf35, 0x3e483f6d, 0xbf553f35, 0x3f7bbec4
.long 0xbec4248d, 0xbf6dbf35, 0x3f6d3f80, 0x3ec43f35, 0xbf6dbf80, 0xbec4bf35, 0xbec4248d, 0xbf6dbf35
.long 0xbf7bbf35, 0xbf0ebf6d, 0x3e483f35, 0xbf55bec4, 0xbe48bf35, 0x3f553ec4, 0xbf7bbf35, 0xbf0ebf6d
.long 0xbf6d248d, 0x3ec43f35, 0xbec43f80, 0x3f6dbf35, 0x3ec4bf80, 0xbf6d3f35, 0xbf6d248d, 0x3ec43f35
.long 0xbe48bf35, 0xbf553f6d, 0xbf7b3f35, 0x3f0e3ec4, 0x3f7bbf35, 0xbf0ebec4, 0xbe48bf35, 0xbf553f6d
.long 0xbf35bf80, 0x3f35a554, 0xbf35250d, 0xbf35bf80, 0x3f35a50d, 0x3f353f80, 0xbf35bf80, 0x3f35a554
.long 0x3e48bf35, 0x3f553f6d, 0xbf7bbf35, 0x3f0ebec4, 0x3f7b3f35, 0xbf0e3ec4, 0x3e48bf35, 0x3f553f6d
.long 0x3f35bf80, 0xbf35248d, 0xbf35250d, 0xbf353f80, 0x3f35a50d, 0x3f35bf80, 0x3f35bf80, 0xbf35248d
.long 0x3f7bbf35, 0x3f0ebf6d, 0x3e48bf35, 0xbf553ec4, 0xbe483f35, 0x3f55bec4, 0x3f7bbf35, 0x3f0ebf6d
.long 0x3f6da554, 0xbec43f35, 0xbec4bf80, 0x3f6d3f35, 0x3ec43f80, 0xbf6dbf35, 0x3f6da554, 0xbec43f35
.long 0x3f553f35, 0xbf7bbec4, 0x3f0ebf35, 0xbe483f6d, 0xbf0e3f35, 0x3e48bf6d, 0x3f553f35, 0xbf7bbec4
.long 0x3ec4a554, 0x3f6dbf35, 0x3f6dbf80, 0x3ec4bf35, 0xbf6d3f80, 0xbec43f35, 0x3ec4a554, 0x3f6dbf35
.long 0xbf0e3f35, 0xbe483ec4, 0x3f55bf35, 0x3f7bbf6d, 0xbf553f35, 0xbf7b3f6d, 0xbf0e3f35, 0xbe483ec4
.long 0x3f803f80, 0x3f803f80, 0x00000000, 0x00000000, 0x80008000, 0x80008000, 0x3f803f80, 0x3f803f80
.long 0xbe48248d, 0xbf0ebec4, 0x3f7b3f80, 0x3f553f6d, 0xbf7bbf80, 0xbf55bf6d, 0xbe48248d, 0xbf0ebec4
.long 0x248d3f80, 0xa554bf80, 0x3f800000, 0xbf80250d, 0xbf808000, 0x3f80a50d, 0x248d3f80, 0xa554bf80
.long 0xbf7b248d, 0x3f553ec4, 0xbe483f80, 0x3f0ebf6d, 0x3e48bf80, 0xbf0e3f6d, 0xbf7b248d, 0x3f553ec4
.long 0xbf6dbf80, 0xbec4bf35, 0xbec4250d, 0xbf6dbf35, 0x3ec4a50d, 0x3f6d3f35, 0xbf6dbf80, 0xbec4bf35
.long 0x3f0ea554, 0x3f7b3f6d, 0xbf55bf80, 0x3e48bec4, 0x3f553f80, 0xbe483ec4, 0x3f0ea554, 0x3f7b3f6d
.long 0x3ec4bf80, 0xbf6d3f35, 0xbf6d250d, 0x3ec43f35, 0x3f6da50d, 0xbec4bf35, 0x3ec4bf80, 0xbf6d3f35
.long 0x3f55a554, 0x3e48bf6d, 0x3f0ebf80, 0xbf7b3ec4, 0xbf0e3f80, 0x3f7bbec4, 0x3f55a554, 0x3e48bf6d
.long 0x3f353f80, 0xbf35248d, 0x3f350000, 0x3f353f80, 0xbf358000, 0xbf35bf80, 0x3f353f80, 0xbf35248d
.long 0xbf55248d, 0xbe48bf6d, 0x3f0e3f80, 0xbf7bbec4, 0xbf0ebf80, 0x3f7b3ec4, 0xbf55248d, 0xbe48bf6d
.long 0xbf353f80, 0x3f35a554, 0x3f350000, 0x3f35bf80, 0xbf358000, 0xbf353f80, 0xbf353f80, 0x3f35a554
.long 0xbf0e248d, 0xbf7b3f6d, 0xbf553f80, 0x3e483ec4, 0x3f55bf80, 0xbe48bec4, 0xbf0e248d, 0xbf7b3f6d
.long 0xbec4bf80, 0x3f6d3f35, 0xbf6d250d, 0x3ec4bf35, 0x3f6da50d, 0xbec43f35, 0xbec4bf80, 0x3f6d3f35
.long 0x3f7ba554, 0xbf553ec4, 0xbe48bf80, 0x3f0e3f6d, 0x3e483f80, 0xbf0ebf6d, 0x3f7ba554, 0xbf553ec4
.long 0x3f6dbf80, 0x3ec4bf35, 0xbec4250d, 0xbf6d3f35, 0x3ec4a50d, 0x3f6dbf35, 0x3f6dbf80, 0x3ec4bf35
.long 0x3e48a554, 0x3f0ebec4, 0x3f7bbf80, 0x3f55bf6d, 0xbf7b3f80, 0xbf553f6d, 0x3e48a554, 0x3f0ebec4
.long 0x3f803f80, 0x3f803f80, 0x00000000, 0x00000000, 0x80008000, 0x80008000, 0x3f803f80, 0x3f803f80
.long 0xbf55bf35, 0xbf7bbf6d, 0x3f0e3f35, 0x3e483ec4, 0xbf0ebf35, 0xbe48bec4, 0xbf55bf35, 0xbf7bbf6d
.long 0x248d3f80, 0xa554bf80, 0x3f800000, 0xbf80250d, 0xbf808000, 0x3f80a50d, 0x248d3f80, 0xa554bf80
.long 0xbf0ebf35, 0x3e483f6d, 0xbf553f35, 0x3f7bbec4, 0x3f55bf35, 0xbf7b3ec4, 0xbf0ebf35, 0x3e483f6d
.long 0x3ec4a554, 0x3f6d3f35, 0xbf6dbf80, 0xbec4bf35, 0x3f6d3f80, 0x3ec43f35, 0x3ec4a554, 0x3f6d3f35
.long 0x3e483f35, 0xbf55bec4, 0x3f7b3f35, 0x3f0e3f6d, 0xbf7bbf35, 0xbf0ebf6d, 0x3e483f35, 0xbf55bec4
.long 0x3f6da554, 0xbec4bf35, 0x3ec4bf80, 0xbf6d3f35, 0xbec43f80, 0x3f6dbf35, 0x3f6da554, 0xbec4bf35
.long 0xbf7b3f35, 0x3f0e3ec4, 0x3e483f35, 0x3f55bf6d, 0xbe48bf35, 0xbf553f6d, 0xbf7b3f35, 0x3f0e3ec4
.long 0xbf35bf80, 0x3f35a554, 0xbf35250d, 0xbf35bf80, 0x3f35a50d, 0x3f353f80, 0xbf35bf80, 0x3f35a554
.long 0x3f7b3f35, 0xbf0e3ec4, 0x3e48bf35, 0x3f553f6d, 0xbe483f35, 0xbf55bf6d, 0x3f7b3f35, 0xbf0e3ec4
.long 0x3f35bf80, 0xbf35248d, 0xbf35250d, 0xbf353f80, 0x3f35a50d, 0x3f35bf80, 0x3f35bf80, 0xbf35248d
.long 0xbe483f35, 0x3f55bec4, 0x3f7bbf35, 0x3f0ebf6d, 0xbf7b3f35, 0xbf0e3f6d, 0xbe483f35, 0x3f55bec4
.long 0xbf6d248d, 0x3ec4bf35, 0x3ec43f80, 0xbf6dbf35, 0xbec4bf80, 0x3f6d3f35, 0xbf6d248d, 0x3ec4bf35
.long 0x3f0ebf35, 0xbe483f6d, 0xbf55bf35, 0x3f7b3ec4, 0x3f553f35, 0xbf7bbec4, 0x3f0ebf35, 0xbe483f6d
.long 0xbec4248d, 0xbf6d3f35, 0xbf6d3f80, 0xbec43f35, 0x3f6dbf80, 0x3ec4bf35, 0xbec4248d, 0xbf6d3f35
.long 0x3f55bf35, 0x3f7bbf6d, 0x3f0ebf35, 0x3e48bec4, 0xbf0e3f35, 0xbe483ec4, 0x3f55bf35, 0x3f7bbf6d
.long 0x3f803f80, 0x3f803f80, 0x00000000, 0x00000000, 0x80008000, 0x80008000, 0x3f803f80, 0x3f803f80
.long 0xbf7bbf80, 0xbf55bf6d, 0xbe48250d, 0xbf0ebec4, 0x3e48a50d, 0x3f0e3ec4, 0xbf7bbf80, 0xbf55bf6d
.long 0x248d3f80, 0xa554bf80, 0x3f800000, 0xbf80250d, 0xbf808000, 0x3f80a50d, 0x248d3f80, 0xa554bf80
.long 0x3e48bf80, 0xbf0e3f6d, 0xbf7b250d, 0x3f553ec4, 0x3f7ba50d, 0xbf55bec4, 0x3e48bf80, 0xbf0e3f6d
.long 0x3f6d3f80, 0x3ec43f35, 0x3ec40000, 0x3f6d3f35, 0xbec48000, 0xbf6dbf35, 0x3f6d3f80, 0x3ec43f35
.long 0xbf55bf80, 0x3e48bec4, 0xbf0e250d, 0xbf7bbf6d, 0x3f0ea50d, 0x3f7b3f6d, 0xbf55bf80, 0x3e48bec4
.long 0xbec43f80, 0x3f6dbf35, 0x3f6d0000, 0xbec4bf35, 0xbf6d8000, 0x3ec43f35, 0xbec43f80, 0x3f6dbf35
.long 0x3f0ebf80, 0xbf7b3ec4, 0xbf55250d, 0xbe483f6d, 0x3f55a50d, 0x3e48bf6d, 0x3f0ebf80, 0xbf7b3ec4
.long 0x3f353f80, 0xbf35248d, 0x3f350000, 0x3f353f80, 0xbf358000, 0xbf35bf80, 0x3f353f80, 0xbf35248d
.long 0xbf0ebf80, 0x3f7b3ec4, 0xbf55250d, 0xbe48bf6d, 0x3f55a50d, 0x3e483f6d, 0xbf0ebf80, 0x3f7b3ec4
.long 0xbf353f80, 0x3f35a554, 0x3f350000, 0x3f35bf80, 0xbf358000, 0xbf353f80, 0xbf353f80, 0x3f35a554
.long 0x3f55bf80, 0xbe48bec4, 0xbf0e250d, 0xbf7b3f6d, 0x3f0ea50d, 0x3f7bbf6d, 0x3f55bf80, 0xbe48bec4
.long 0x3ec43f80, 0xbf6dbf35, 0x3f6d0000, 0xbec43f35, 0xbf6d8000, 0x3ec4bf35, 0x3ec43f80, 0xbf6dbf35
.long 0xbe48bf80, 0x3f0e3f6d, 0xbf7b250d, 0x3f55bec4, 0x3f7ba50d, 0xbf553ec4, 0xbe48bf80, 0x3f0e3f6d
.long 0xbf6d3f80, 0xbec43f35, 0x3ec40000, 0x3f6dbf35, 0xbec48000, 0xbf6d3f35, 0xbf6d3f80, 0xbec43f35
.long 0x3f7bbf80, 0x3f55bf6d, 0xbe48250d, 0xbf0e3ec4, 0x3e48a50d, 0x3f0ebec4, 0x3f7bbf80, 0x3f55bf6d
.long 0x3f803f80, 0x3f803f80, 0x00000000, 0x00000000, 0x80008000, 0x80008000, 0x3f803f80, 0x3f803f80
.long 0xbf0ebf35, 0xbe48bec4, 0xbf55bf35, 0xbf7bbf6d, 0x3f553f35, 0x3f7b3f6d, 0xbf0ebf35, 0xbe48bec4
.long 0x248d3f80, 0xa554bf80, 0x3f800000, 0xbf80250d, 0xbf808000, 0x3f80a50d, 0x248d3f80, 0xa554bf80
.long 0x3f55bf35, 0xbf7b3ec4, 0xbf0ebf35, 0x3e483f6d, 0x3f0e3f35, 0xbe48bf6d, 0x3f55bf35, 0xbf7b3ec4
.long 0xbec4248d, 0xbf6dbf35, 0x3f6d3f80, 0x3ec43f35, 0xbf6dbf80, 0xbec4bf35, 0xbec4248d, 0xbf6dbf35
.long 0x3f7b3f35, 0x3f0e3f6d, 0xbe48bf35, 0x3f553ec4, 0x3e483f35, 0xbf55bec4, 0x3f7b3f35, 0x3f0e3f6d
.long 0xbf6d248d, 0x3ec43f35, 0xbec43f80, 0x3f6dbf35, 0x3ec4bf80, 0xbf6d3f35, 0xbf6d248d, 0x3ec43f35
.long 0x3e483f35, 0x3f55bf6d, 0x3f7bbf35, 0xbf0ebec4, 0xbf7b3f35, 0x3f0e3ec4, 0x3e483f35, 0x3f55bf6d
.long 0xbf35bf80, 0x3f35a554, 0xbf35250d, 0xbf35bf80, 0x3f35a50d, 0x3f353f80, 0xbf35bf80, 0x3f35a554
.long 0xbe483f35, 0xbf55bf6d, 0x3f7b3f35, 0xbf0e3ec4, 0xbf7bbf35, 0x3f0ebec4, 0xbe483f35, 0xbf55bf6d
.long 0x3f35bf80, 0xbf35248d, 0xbf35250d, 0xbf353f80, 0x3f35a50d, 0x3f35bf80, 0x3f35bf80, 0xbf35248d
.long 0xbf7b3f35, 0xbf0e3f6d, 0xbe483f35, 0x3f55bec4, 0x3e48bf35, 0xbf553ec4, 0xbf7b3f35, 0xbf0e3f6d
.long 0x3f6da554, 0xbec43f35, 0xbec4bf80, 0x3f6d3f35, 0x3ec43f80, 0xbf6dbf35, 0x3f6da554, 0xbec43f35
.long 0xbf55bf35, 0x3f7b3ec4, 0xbf0e3f35, 0x3e48bf6d, 0x3f0ebf35, 0xbe483f6d, 0xbf55bf35, 0x3f7b3ec4
.long 0x3ec4a554, 0x3f6dbf35, 0x3f6dbf80, 0x3ec4bf35, 0xbf6d3f80, 0xbec43f35, 0x3ec4a554, 0x3f6dbf35
.long 0x3f0ebf35, 0x3e48bec4, 0xbf553f35, 0xbf7b3f6d, 0x3f55bf35, 0x3f7bbf6d, 0x3f0ebf35, 0x3e48bec4
.long 0x3f803f80, 0x3f803f80, 0x00000000, 0x00000000, 0x80008000, 0x80008000, 0x3f803f80, 0x3f803f80
.long 0x3e48a554, 0x3f0e3ec4, 0xbf7bbf80, 0xbf55bf6d, 0x3f7b3f80, 0x3f553f6d, 0x3e48a554, 0x3f0e3ec4
.long 0x248d3f80, 0xa554bf80, 0x3f800000, 0xbf80250d, 0xbf808000, 0x3f80a50d, 0x248d3f80, 0xa554bf80
.long 0x3f7ba554, 0xbf55bec4, 0x3e48bf80, 0xbf0e3f6d, 0xbe483f80, 0x3f0ebf6d, 0x3f7ba554, 0xbf55bec4
.long 0xbf6dbf80, 0xbec4bf35, 0xbec4250d, 0xbf6dbf35, 0x3ec4a50d, 0x3f6d3f35, 0xbf6dbf80, 0xbec4bf35
.long 0xbf0e248d, 0xbf7bbf6d, 0x3f553f80, 0xbe483ec4, 0xbf55bf80, 0x3e48bec4, 0xbf0e248d, 0xbf7bbf6d
.long 0x3ec4bf80, 0xbf6d3f35, 0xbf6d250d, 0x3ec43f35, 0x3f6da50d, 0xbec4bf35, 0x3ec4bf80, 0xbf6d3f35
.long 0xbf55248d, 0xbe483f6d, 0xbf0e3f80, 0x3f7bbec4, 0x3f0ebf80, 0xbf7b3ec4, 0xbf55248d, 0xbe483f6d
.long 0x3f353f80, 0xbf35248d, 0x3f350000, 0x3f353f80, 0xbf358000, 0xbf35bf80, 0x3f353f80, 0xbf35248d
.long 0x3f55a554, 0x3e483f6d, 0xbf0ebf80, 0x3f7b3ec4, 0x3f0e3f80, 0xbf7bbec4, 0x3f55a554, 0x3e483f6d
.long 0xbf353f80, 0x3f35a554, 0x3f350000, 0x3f35bf80, 0xbf358000, 0xbf353f80, 0xbf353f80, 0x3f35a554
.long 0x3f0ea554, 0x3f7bbf6d, 0x3f55bf80, 0xbe48bec4, 0xbf553f80, 0x3e483ec4, 0x3f0ea554, 0x3f7bbf6d
.long 0xbec4bf80, 0x3f6d3f35, 0xbf6d250d, 0x3ec4bf35, 0x3f6da50d, 0xbec43f35, 0xbec4bf80, 0x3f6d3f35
.long 0xbf7b248d, 0x3f55bec4, 0x3e483f80, 0xbf0ebf6d, 0xbe48bf80, 0x3f0e3f6d, 0xbf7b248d, 0x3f55bec4
.long 0x3f6dbf80, 0x3ec4bf35, 0xbec4250d, 0xbf6d3f35, 0x3ec4a50d, 0x3f6dbf35, 0x3f6dbf80, 0x3ec4bf35
.long 0xbe48248d, 0xbf0e3ec4, 0xbf7b3f80, 0xbf553f6d, 0x3f7bbf80, 0x3f55bf6d, 0xbe48248d, 0xbf0e3ec4
.long 0x3f803f80, 0x3f803f80, 0x00000000, 0x00000000, 0x80008000, 0x80008000, 0x3f803f80, 0x3f803f80
.long 0x3f553f35, 0x3f7b3f6d, 0xbf0ebf35, 0xbe48bec4, 0x3f0e3f35, 0x3e483ec4, 0x3f553f35, 0x3f7b3f6d
.long 0x248d3f80, 0xa554bf80, 0x3f800000, 0xbf80250d, 0xbf808000, 0x3f80a50d, 0x248d3f80, 0xa554bf80
.long 0x3f0e3f35, 0xbe48bf6d, 0x3f55bf35, 0xbf7b3ec4, 0xbf553f35, 0x3f7bbec4, 0x3f0e3f35, 0xbe48bf6d
.long 0x3ec4a554, 0x3f6d3f35, 0xbf6dbf80, 0xbec4bf35, 0x3f6d3f80, 0x3ec43f35, 0x3ec4a554, 0x3f6d3f35
.long 0xbe48bf35, 0x3f553ec4, 0xbf7bbf35, 0xbf0ebf6d, 0x3f7b3f35, 0x3f0e3f6d, 0xbe48bf35, 0x3f553ec4
.long 0x3f6da554, 0xbec4bf35, 0x3ec4bf80, 0xbf6d3f35, 0xbec43f80, 0x3f6dbf35, 0x3f6da554, 0xbec4bf35
.long 0x3f7bbf35, 0xbf0ebec4, 0xbe48bf35, 0xbf553f6d, 0x3e483f35, 0x3f55bf6d, 0x3f7bbf35, 0xbf0ebec4
.long 0xbf35bf80, 0x3f35a554, 0xbf35250d, 0xbf35bf80, 0x3f35a50d, 0x3f353f80, 0xbf35bf80, 0x3f35a554
.long 0xbf7bbf35, 0x3f0ebec4, 0xbe483f35, 0xbf55bf6d, 0x3e48bf35, 0x3f553f6d, 0xbf7bbf35, 0x3f0ebec4
.long 0x3f35bf80, 0xbf35248d, 0xbf35250d, 0xbf353f80, 0x3f35a50d, 0x3f35bf80, 0x3f35bf80, 0xbf35248d
.long 0x3e48bf35, 0xbf553ec4, 0xbf7b3f35, 0xbf0e3f6d, 0x3f7bbf35, 0x3f0ebf6d, 0x3e48bf35, 0xbf553ec4
.long 0xbf6d248d, 0x3ec4bf35, 0x3ec43f80, 0xbf6dbf35, 0xbec4bf80, 0x3f6d3f35, 0xbf6d248d, 0x3ec4bf35
.long 0xbf0e3f35, 0x3e48bf6d, 0x3f553f35, 0xbf7bbec4, 0xbf55bf35, 0x3f7b3ec4, 0xbf0e3f35, 0x3e48bf6d
.long 0xbec4248d, 0xbf6d3f35, 0xbf6d3f80, 0xbec43f35, 0x3f6dbf80, 0x3ec4bf35, 0xbec4248d, 0xbf6d3f35
.long 0xbf553f35, 0xbf7b3f6d, 0xbf0e3f35, 0xbe483ec4, 0x3f0ebf35, 0x3e48bec4, 0xbf553f35, 0xbf7b3f6d
.long 0xbf803f80, 0xbf803f80, 0x250d0000, 0x250d0000, 0xa50d8000, 0xa50d8000, 0xbf803f80, 0xbf803f80
.long 0xbf7b3f80, 0xbf553f6d, 0xbe480000, 0xbf0e3ec4, 0x3e488000, 0x3f0ebec4, 0xbf7b3f80, 0xbf553f6d
.long 0xa5543f80, 0x248dbf80, 0xbf800000, 0x3f80250d, 0x3f808000, 0xbf80a50d, 0xa5543f80, 0x248dbf80
.long 0x3e483f80, 0xbf0ebf6d, 0xbf7b0000, 0x3f55bec4, 0x3f7b8000, 0xbf553ec4, 0x3e483f80, 0xbf0ebf6d
.long 0xbf6d3f80, 0xbec43f35, 0xbec40000, 0xbf6d3f35, 0x3ec48000, 0x3f6dbf35, 0xbf6d3f80, 0xbec43f35
.long 0xbf553f80, 0x3e483ec4, 0xbf0e0000, 0xbf7b3f6d, 0x3f0e8000, 0x3f7bbf6d, 0xbf553f80, 0x3e483ec4
.long 0x3ec43f80, 0xbf6dbf35, 0xbf6d0000, 0x3ec4bf35, 0x3f6d8000, 0xbec43f35, 0x3ec43f80, 0xbf6dbf35
.long 0x3f0e3f80, 0xbf7bbec4, 0xbf550000, 0xbe48bf6d, 0x3f558000, 0x3e483f6d, 0x3f0e3f80, 0xbf7bbec4
.long 0xbf353f80, 0x3f35248d, 0xbf350000, 0xbf353f80, 0x3f358000, 0x3f35bf80, 0xbf353f80, 0x3f35248d
.long 0xbf0e3f80, 0x3f7bbec4, 0xbf550000, 0xbe483f6d, 0x3f558000, 0x3e48bf6d, 0xbf0e3f80, 0x3f7bbec4
.long 0x3f353f80, 0xbf35a554, 0xbf350000, 0xbf35bf80, 0x3f358000, 0x3f353f80, 0x3f353f80, 0xbf35a554
.long 0x3f553f80, 0xbe483ec4, 0xbf0e0000, 0xbf7bbf6d, 0x3f0e8000, 0x3f7b3f6d, 0x3f553f80, 0xbe483ec4
.long 0xbec43f80, 0x3f6dbf35, 0xbf6d0000, 0x3ec43f35, 0x3f6d8000, 0xbec4bf35, 0xbec43f80, 0x3f6dbf35
.long 0xbe483f80, 0x3f0ebf6d, 0xbf7b0000, 0x3f553ec4, 0x3f7b8000, 0xbf55bec4, 0xbe483f80, 0x3f0ebf6d
.long 0x3f6d3f80, 0x3ec43f35, 0xbec40000, 0xbf6dbf35, 0x3ec48000, 0x3f6d3f35, 0x3f6d3f80, 0x3ec43f35
.long 0x3f7b3f80, 0x3f553f6d, 0xbe480000, 0xbf0ebec4, 0x3e488000, 0x3f0e3ec4, 0x3f7b3f80, 0x3f553f6d
.long 0xbf803f80, 0xbf803f80, 0x250d0000, 0x250d0000, 0xa50d8000, 0xa50d8000, 0xbf803f80, 0xbf803f80
.long 0xbf0e3f35, 0xbe483ec4, 0xbf553f35, 0xbf7b3f6d, 0x3f55bf35, 0x3f7bbf6d, 0xbf0e3f35, 0xbe483ec4
.long 0xa5543f80, 0x248dbf80, 0xbf800000, 0x3f80250d, 0x3f808000, 0xbf80a50d, 0xa5543f80, 0x248dbf80
.long 0x3f553f35, 0xbf7bbec4, 0xbf0e3f35, 0x3e48bf6d, 0x3f0ebf35, 0xbe483f6d, 0x3f553f35, 0xbf7bbec4
.long 0x3ec4248d, 0x3f6dbf35, 0xbf6d3f80, 0xbec43f35, 0x3f6dbf80, 0x3ec4bf35, 0x3ec4248d, 0x3f6dbf35
.long 0x3f7bbf35, 0x3f0ebf6d, 0xbe483f35, 0x3f55bec4, 0x3e48bf35, 0xbf553ec4, 0x3f7bbf35, 0x3f0ebf6d
.long 0x3f6d248d, 0xbec43f35, 0x3ec43f80, 0xbf6dbf35, 0xbec4bf80, 0x3f6d3f35, 0x3f6d248d, 0xbec43f35
.long 0x3e48bf35, 0x3f553f6d, 0x3f7b3f35, 0xbf0e3ec4, 0xbf7bbf35, 0x3f0ebec4, 0x3e48bf35, 0x3f553f6d
.long 0x3f35bf80, 0xbf35a554, 0x3f35250d, 0x3f35bf80, 0xbf35a50d, 0xbf353f80, 0x3f35bf80, 0xbf35a554
.long 0xbe48bf35, 0xbf553f6d, 0x3f7bbf35, 0xbf0ebec4, 0xbf7b3f35, 0x3f0e3ec4, 0xbe48bf35, 0xbf553f6d
.long 0xbf35bf80, 0x3f35248d, 0x3f35250d, 0x3f353f80, 0xbf35a50d, 0xbf35bf80, 0xbf35bf80, 0x3f35248d
.long 0xbf7bbf35, 0xbf0ebf6d, 0xbe48bf35, 0x3f553ec4, 0x3e483f35, 0xbf55bec4, 0xbf7bbf35, 0xbf0ebf6d
.long 0xbf6da554, 0x3ec43f35, 0x3ec4bf80, 0xbf6d3f35, 0xbec43f80, 0x3f6dbf35, 0xbf6da554, 0x3ec43f35
.long 0xbf553f35, 0x3f7bbec4, 0xbf0ebf35, 0x3e483f6d, 0x3f0e3f35, 0xbe48bf6d, 0xbf553f35, 0x3f7bbec4
.long 0xbec4a554, 0xbf6dbf35, 0xbf6dbf80, 0xbec4bf35, 0x3f6d3f80, 0x3ec43f35, 0xbec4a554, 0xbf6dbf35
.long 0x3f0e3f35, 0x3e483ec4, 0xbf55bf35, 0xbf7bbf6d, 0x3f553f35, 0x3f7b3f6d, 0x3f0e3f35, 0x3e483ec4
.long 0xbf803f80, 0xbf803f80, 0x250d0000, 0x250d0000, 0xa50d8000, 0xa50d8000, 0xbf803f80, 0xbf803f80
.long 0x3e48248d, 0x3f0ebec4, 0xbf7b3f80, 0xbf553f6d, 0x3f7bbf80, 0x3f55bf6d, 0x3e48248d, 0x3f0ebec4
.long 0xa5543f80, 0x248dbf80, 0xbf800000, 0x3f80250d, 0x3f808000, 0xbf80a50d, 0xa5543f80, 0x248dbf80
.long 0x3f7b248d, 0xbf553ec4, 0x3e483f80, 0xbf0ebf6d, 0xbe48bf80, 0x3f0e3f6d, 0x3f7b248d, 0xbf553ec4
.long 0x3f6dbf80, 0x3ec4bf35, 0x3ec4250d, 0x3f6dbf35, 0xbec4a50d, 0xbf6d3f35, 0x3f6dbf80, 0x3ec4bf35
.long 0xbf0ea554, 0xbf7b3f6d, 0x3f55bf80, 0xbe48bec4, 0xbf553f80, 0x3e483ec4, 0xbf0ea554, 0xbf7b3f6d
.long 0xbec4bf80, 0x3f6d3f35, 0x3f6d250d, 0xbec43f35, 0xbf6da50d, 0x3ec4bf35, 0xbec4bf80, 0x3f6d3f35
.long 0xbf55a554, 0xbe48bf6d, 0xbf0ebf80, 0x3f7b3ec4, 0x3f0e3f80, 0xbf7bbec4, 0xbf55a554, 0xbe48bf6d
.long 0xbf353f80, 0x3f35248d, 0xbf350000, 0xbf353f80, 0x3f358000, 0x3f35bf80, 0xbf353f80, 0x3f35248d
.long 0x3f55248d, 0x3e48bf6d, 0xbf0e3f80, 0x3f7bbec4, 0x3f0ebf80, 0xbf7b3ec4, 0x3f55248d, 0x3e48bf6d
.long 0x3f353f80, 0xbf35a554, 0xbf350000, 0xbf35bf80, 0x3f358000, 0x3f353f80, 0x3f353f80, 0xbf35a554
.long 0x3f0e248d, 0x3f7b3f6d, 0x3f553f80, 0xbe483ec4, 0xbf55bf80, 0x3e48bec4, 0x3f0e248d, 0x3f7b3f6d
.long 0x3ec4bf80, 0xbf6d3f35, 0x3f6d250d, 0xbec4bf35, 0xbf6da50d, 0x3ec43f35, 0x3ec4bf80, 0xbf6d3f35
.long 0xbf7ba554, 0x3f553ec4, 0x3e48bf80, 0xbf0e3f6d, 0xbe483f80, 0x3f0ebf6d, 0xbf7ba554, 0x3f553ec4
.long 0xbf6dbf80, 0xbec4bf35, 0x3ec4250d, 0x3f6d3f35, 0xbec4a50d, 0xbf6dbf35, 0xbf6dbf80, 0xbec4bf35
.long 0xbe48a554, 0xbf0ebec4, 0xbf7bbf80, 0xbf55bf6d, 0x3f7b3f80, 0x3f553f6d, 0xbe48a554, 0xbf0ebec4
.long 0xbf803f80, 0xbf803f80, 0x250d0000, 0x250d0000, 0xa50d8000, 0xa50d8000, 0xbf803f80, 0xbf803f80
.long 0x3f55bf35, 0x3f7bbf6d, 0xbf0e3f35, 0xbe483ec4, 0x3f0ebf35, 0x3e48bec4, 0x3f55bf35, 0x3f7bbf6d
.long 0xa5543f80, 0x248dbf80, 0xbf800000, 0x3f80250d, 0x3f808000, 0xbf80a50d, 0xa5543f80, 0x248dbf80
.long 0x3f0ebf35, 0xbe483f6d, 0x3f553f35, 0xbf7bbec4, 0xbf55bf35, 0x3f7b3ec4, 0x3f0ebf35, 0xbe483f6d
.long 0xbec4a554, 0xbf6d3f35, 0x3f6dbf80, 0x3ec4bf35, 0xbf6d3f80, 0xbec43f35, 0xbec4a554, 0xbf6d3f35
.long 0xbe483f35, 0x3f55bec4, 0xbf7b3f35, 0xbf0e3f6d, 0x3f7bbf35, 0x3f0ebf6d, 0xbe483f35, 0x3f55bec4
.long 0xbf6da554, 0x3ec4bf35, 0xbec4bf80, 0x3f6d3f35, 0x3ec43f80, 0xbf6dbf35, 0xbf6da554, 0x3ec4bf35
.long 0x3f7b3f35, 0xbf0e3ec4, 0xbe483f35, 0xbf55bf6d, 0x3e48bf35, 0x3f553f6d, 0x3f7b3f35, 0xbf0e3ec4
.long 0x3f35bf80, 0xbf35a554, 0x3f35250d, 0x3f35bf80, 0xbf35a50d, 0xbf353f80, 0x3f35bf80, 0xbf35a554
.long 0xbf7b3f35, 0x3f0e3ec4, 0xbe48bf35, 0xbf553f6d, 0x3e483f35, 0x3f55bf6d, 0xbf7b3f35, 0x3f0e3ec4
.long 0xbf35bf80, 0x3f35248d, 0x3f35250d, 0x3f353f80, 0xbf35a50d, 0xbf35bf80, 0xbf35bf80, 0x3f35248d
.long 0x3e483f35, 0xbf55bec4, 0xbf7bbf35, 0xbf0ebf6d, 0x3f7b3f35, 0x3f0e3f6d, 0x3e483f35, 0xbf55bec4
.long 0x3f6d248d, 0xbec4bf35, 0xbec43f80, 0x3f6dbf35, 0x3ec4bf80, 0xbf6d3f35, 0x3f6d248d, 0xbec4bf35
.long 0xbf0ebf35, 0x3e483f6d, 0x3f55bf35, 0xbf7b3ec4, 0xbf553f35, 0x3f7bbec4, 0xbf0ebf35, 0x3e483f6d
.long 0x3ec4248d, 0x3f6d3f35, 0x3f6d3f80, 0x3ec43f35, 0xbf6dbf80, 0xbec4bf35, 0x3ec4248d, 0x3f6d3f35
.long 0xbf55bf35, 0xbf7bbf6d, 0xbf0ebf35, 0xbe48bec4, 0x3f0e3f35, 0x3e483ec4, 0xbf55bf35, 0xbf7bbf6d
.long 0xbf803f80, 0xbf803f80, 0x250d0000, 0x250d0000, 0xa50d8000, 0xa50d8000, 0xbf803f80, 0xbf803f80
.long 0x3f7bbf80, 0x3f55bf6d, 0x3e48250d, 0x3f0ebec4, 0xbe48a50d, 0xbf0e3ec4, 0x3f7bbf80, 0x3f55bf6d
.long 0xa5543f80, 0x248dbf80, 0xbf800000, 0x3f80250d, 0x3f808000, 0xbf80a50d, 0xa5543f80, 0x248dbf80
.long 0xbe48bf80, 0x3f0e3f6d, 0x3f7b250d, 0xbf553ec4, 0xbf7ba50d, 0x3f55bec4, 0xbe48bf80, 0x3f0e3f6d
.long 0xbf6d3f80, 0xbec43f35, 0xbec40000, 0xbf6d3f35, 0x3ec48000, 0x3f6dbf35, 0xbf6d3f80, 0xbec43f35
.long 0x3f55bf80, 0xbe48bec4, 0x3f0e250d, 0x3f7bbf6d, 0xbf0ea50d, 0xbf7b3f6d, 0x3f55bf80, 0xbe48bec4
.long 0x3ec43f80, 0xbf6dbf35, 0xbf6d0000, 0x3ec4bf35, 0x3f6d8000, 0xbec43f35, 0x3ec43f80, 0xbf6dbf35
.long 0xbf0ebf80, 0x3f7b3ec4, 0x3f55250d, 0x3e483f6d, 0xbf55a50d, 0xbe48bf6d, 0xbf0ebf80, 0x3f7b3ec4
.long 0xbf353f80, 0x3f35248d, 0xbf350000, 0xbf353f80, 0x3f358000, 0x3f35bf80, 0xbf353f80, 0x3f35248d
.long 0x3f0ebf80, 0xbf7b3ec4, 0x3f55250d, 0x3e48bf6d, 0xbf55a50d, 0xbe483f6d, 0x3f0ebf80, 0xbf7b3ec4
.long 0x3f353f80, 0xbf35a554, 0xbf350000, 0xbf35bf80, 0x3f358000, 0x3f353f80, 0x3f353f80, 0xbf35a554
.long 0xbf55bf80, 0x3e48bec4, 0x3f0e250d, 0x3f7b3f6d, 0xbf0ea50d, 0xbf7bbf6d, 0xbf55bf80, 0x3e48bec4
.long 0xbec43f80, 0x3f6dbf35, 0xbf6d0000, 0x3ec43f35, 0x3f6d8000, 0xbec4bf35, 0xbec43f80, 0x3f6dbf35
.long 0x3e48bf80, 0xbf0e3f6d, 0x3f7b250d, 0xbf55bec4, 0xbf7ba50d, 0x3f553ec4, 0x3e48bf80, 0xbf0e3f6d
.long 0x3f6d3f80, 0x3ec43f35, 0xbec40000, 0xbf6dbf35, 0x3ec48000, 0x3f6d3f35, 0x3f6d3f80, 0x3ec43f35
.long 0xbf7bbf80, 0xbf55bf6d, 0x3e48250d, 0x3f0e3ec4, 0xbe48a50d, 0xbf0ebec4, 0xbf7bbf80, 0xbf55bf6d
.long 0xbf803f80, 0xbf803f80, 0x250d0000, 0x250d0000, 0xa50d8000, 0xa50d8000, 0xbf803f80, 0xbf803f80
.long 0x3f0ebf35, 0x3e48bec4, 0x3f55bf35, 0x3f7bbf6d, 0xbf553f35, 0xbf7b3f6d, 0x3f0ebf35, 0x3e48bec4
.long 0xa5543f80, 0x248dbf80, 0xbf800000, 0x3f80250d, 0x3f808000, 0xbf80a50d, 0xa5543f80, 0x248dbf80
.long 0xbf55bf35, 0x3f7b3ec4, 0x3f0ebf35, 0xbe483f6d, 0xbf0e3f35, 0x3e48bf6d, 0xbf55bf35, 0x3f7b3ec4
.long 0x3ec4248d, 0x3f6dbf35, 0xbf6d3f80, 0xbec43f35, 0x3f6dbf80, 0x3ec4bf35, 0x3ec4248d, 0x3f6dbf35
.long 0xbf7b3f35, 0xbf0e3f6d, 0x3e48bf35, 0xbf553ec4, 0xbe483f35, 0x3f55bec4, 0xbf7b3f35, 0xbf0e3f6d
.long 0x3f6d248d, 0xbec43f35, 0x3ec43f80, 0xbf6dbf35, 0xbec4bf80, 0x3f6d3f35, 0x3f6d248d, 0xbec43f35
.long 0xbe483f35, 0xbf55bf6d, 0xbf7bbf35, 0x3f0ebec4, 0x3f7b3f35, 0xbf0e3ec4, 0xbe483f35, 0xbf55bf6d
.long 0x3f35bf80, 0xbf35a554, 0x3f35250d, 0x3f35bf80, 0xbf35a50d, 0xbf353f80, 0x3f35bf80, 0xbf35a554
.long 0x3e483f35, 0x3f55bf6d, 0xbf7b3f35, 0x3f0e3ec4, 0x3f7bbf35, 0xbf0ebec4, 0x3e483f35, 0x3f55bf6d
.long 0xbf35bf80, 0x3f35248d, 0x3f35250d, 0x3f353f80, 0xbf35a50d, 0xbf35bf80, 0xbf35bf80, 0x3f35248d
.long 0x3f7b3f35, 0x3f0e3f6d, 0x3e483f35, 0xbf55bec4, 0xbe48bf35, 0x3f553ec4, 0x3f7b3f35, 0x3f0e3f6d
.long 0xbf6da554, 0x3ec43f35, 0x3ec4bf80, 0xbf6d3f35, 0xbec43f80, 0x3f6dbf35, 0xbf6da554, 0x3ec43f35
.long 0x3f55bf35, 0xbf7b3ec4, 0x3f0e3f35, 0xbe48bf6d, 0xbf0ebf35, 0x3e483f6d, 0x3f55bf35, 0xbf7b3ec4
.long 0xbec4a554, 0xbf6dbf35, 0xbf6dbf80, 0xbec4bf35, 0x3f6d3f80, 0x3ec43f35, 0xbec4a554, 0xbf6dbf35
.long 0xbf0ebf35, 0xbe48bec4, 0x3f553f35, 0x3f7b3f6d, 0xbf55bf35, 0xbf7bbf6d, 0xbf0ebf35, 0xbe48bec4
.long 0xbf803f80, 0xbf803f80, 0x250d0000, 0x250d0000, 0xa50d8000, 0xa50d8000, 0xbf803f80, 0xbf803f80
.long 0xbe48a554, 0xbf0e3ec4, 0x3f7bbf80, 0x3f55bf6d, 0xbf7b3f80, 0xbf553f6d, 0xbe48a554, 0xbf0e3ec4
.long 0xa5543f80, 0x248dbf80, 0xbf800000, 0x3f80250d, 0x3f808000, 0xbf80a50d, 0xa5543f80, 0x248dbf80
.long 0xbf7ba554, 0x3f55bec4, 0xbe48bf80, 0x3f0e3f6d, 0x3e483f80, 0xbf0ebf6d, 0xbf7ba554, 0x3f55bec4
.long 0x3f6dbf80, 0x3ec4bf35, 0x3ec4250d, 0x3f6dbf35, 0xbec4a50d, 0xbf6d3f35, 0x3f6dbf80, 0x3ec4bf35
.long 0x3f0e248d, 0x3f7bbf6d, 0xbf553f80, 0x3e483ec4, 0x3f55bf80, 0xbe48bec4, 0x3f0e248d, 0x3f7bbf6d
.long 0xbec4bf80, 0x3f6d3f35, 0x3f6d250d, 0xbec43f35, 0xbf6da50d, 0x3ec4bf35, 0xbec4bf80, 0x3f6d3f35
.long 0x3f55248d, 0x3e483f6d, 0x3f0e3f80, 0xbf7bbec4, 0xbf0ebf80, 0x3f7b3ec4, 0x3f55248d, 0x3e483f6d
.long 0xbf353f80, 0x3f35248d, 0xbf350000, 0xbf353f80, 0x3f358000, 0x3f35bf80, 0xbf353f80, 0x3f35248d
.long 0xbf55a554, 0xbe483f6d, 0x3f0ebf80, 0xbf7b3ec4, 0xbf0e3f80, 0x3f7bbec4, 0xbf55a554, 0xbe483f6d
.long 0x3f353f80, 0xbf35a554, 0xbf350000, 0xbf35bf80, 0x3f358000, 0x3f353f80, 0x3f353f80, 0xbf35a554
.long 0xbf0ea554, 0xbf7bbf6d, 0xbf55bf80, 0x3e48bec4, 0x3f553f80, 0xbe483ec4, 0xbf0ea554, 0xbf7bbf6d
.long 0x3ec4bf80, 0xbf6d3f35, 0x3f6d250d, 0xbec4bf35, 0xbf6da50d, 0x3ec43f35, 0x3ec4bf80, 0xbf6d3f35
.long 0x3f7b248d, 0xbf55bec4, 0xbe483f80, 0x3f0ebf6d, 0x3e48bf80, 0xbf0e3f6d, 0x3f7b248d, 0xbf55bec4
.long 0xbf6dbf80, 0xbec4bf35, 0x3ec4250d, 0x3f6d3f35, 0xbec4a50d, 0xbf6dbf35, 0xbf6dbf80, 0xbec4bf35
.long 0x3e48248d, 0x3f0e3ec4, 0x3f7b3f80, 0x3f553f6d, 0xbf7bbf80, 0xbf55bf6d, 0x3e48248d, 0x3f0e3ec4
.long 0xbf803f80, 0xbf803f80, 0x250d0000, 0x250d0000, 0xa50d8000, 0xa50d8000, 0xbf803f80, 0xbf803f80
.long 0xbf553f35, 0xbf7b3f6d, 0x3f0ebf35, 0x3e48bec4, 0xbf0e3f35, 0xbe483ec4, 0xbf553f35, 0xbf7b3f6d
.long 0xa5543f80, 0x248dbf80, 0xbf800000, 0x3f80250d, 0x3f808000, 0xbf80a50d, 0xa5543f80, 0x248dbf80
.long 0xbf0e3f35, 0x3e48bf6d, 0xbf55bf35, 0x3f7b3ec4, 0x3f553f35, 0xbf7bbec4, 0xbf0e3f35, 0x3e48bf6d
.long 0xbec4a554, 0xbf6d3f35, 0x3f6dbf80, 0x3ec4bf35, 0xbf6d3f80, 0xbec43f35, 0xbec4a554, 0xbf6d3f35
.long 0x3e48bf35, 0xbf553ec4, 0x3f7bbf35, 0x3f0ebf6d, 0xbf7b3f35, 0xbf0e3f6d, 0x3e48bf35, 0xbf553ec4
.long 0xbf6da554, 0x3ec4bf35, 0xbec4bf80, 0x3f6d3f35, 0x3ec43f80, 0xbf6dbf35, 0xbf6da554, 0x3ec4bf35
.long 0xbf7bbf35, 0x3f0ebec4, 0x3e48bf35, 0x3f553f6d, 0xbe483f35, 0xbf55bf6d, 0xbf7bbf35, 0x3f0ebec4
.long 0x3f35bf80, 0xbf35a554, 0x3f35250d, 0x3f35bf80, 0xbf35a50d, 0xbf353f80, 0x3f35bf80, 0xbf35a554
.long 0x3f7bbf35, 0xbf0ebec4, 0x3e483f35, 0x3f55bf6d, 0xbe48bf35, 0xbf553f6d, 0x3f7bbf35, 0xbf0ebec4
.long 0xbf35bf80, 0x3f35248d, 0x3f35250d, 0x3f353f80, 0xbf35a50d, 0xbf35bf80, 0xbf35bf80, 0x3f35248d
.long 0xbe48bf35, 0x3f553ec4, 0x3f7b3f35, 0x3f0e3f6d, 0xbf7bbf35, 0xbf0ebf6d, 0xbe48bf35, 0x3f553ec4
.long 0x3f6d248d, 0xbec4bf35, 0xbec43f80, 0x3f6dbf35, 0x3ec4bf80, 0xbf6d3f35, 0x3f6d248d, 0xbec4bf35
.long 0x3f0e3f35, 0xbe48bf6d, 0xbf553f35, 0x3f7bbec4, 0x3f55bf35, 0xbf7b3ec4, 0x3f0e3f35, 0xbe48bf6d
.long 0x3ec4248d, 0x3f6d3f35, 0x3f6d3f80, 0x3ec43f35, 0xbf6dbf80, 0xbec4bf35, 0x3ec4248d, 0x3f6d3f35
.long 0x3f553f35, 0x3f7b3f6d, 0x3f0e3f35, 0x3e483ec4, 0xbf0ebf35, 0xbe48bec4, 0x3f553f35, 0x3f7b3f6d
.long 0x00003f80, 0x00003f80, 0x00003f80, 0x00003f80, 0x00003f80, 0x3e483f7b, 0x3ec43f6d, 0x3f0e3f55
.long 0x00003f80, 0x3ec43f6d, 0x3f353f35, 0x3f6d3ec4, 0x00003f80, 0x3f0e3f55, 0x3f6d3ec4, 0x3f7bbe48
.long 0x00003f80, 0x3f353f35, 0x3f80248d, 0x3f35bf35, 0x00003f80, 0x3f553f0e, 0x3f6dbec4, 0x3e48bf7b
.long 0x00003f80, 0x3f6d3ec4, 0x3f35bf35, 0xbec4bf6d, 0x00003f80, 0x3f7b3e48, 0x3ec4bf6d, 0xbf55bf0e
.long 0x00003f80, 0x3f80248d, 0x250dbf80, 0xbf80a554, 0x00003f80, 0x3f7bbe48, 0xbec4bf6d, 0xbf553f0e
.long 0x00003f80, 0x3f6dbec4, 0xbf35bf35, 0xbec43f6d, 0x00003f80, 0x3f55bf0e, 0xbf6dbec4, 0x3e483f7b
.long 0x00003f80, 0x3f35bf35, 0xbf80a554, 0x3f353f35, 0x00003f80, 0x3f0ebf55, 0xbf6d3ec4, 0x3f7b3e48
.long 0x00003f80, 0x3ec4bf6d, 0xbf353f35, 0x3f6dbec4, 0x00003f80, 0x3e48bf7b, 0xbec43f6d, 0x3f0ebf55
.long 0x00003f80, 0x250dbf80, 0x00003f80, 0x250dbf80, 0x00003f80, 0xbe48bf7b, 0x3ec43f6d, 0xbf0ebf55
.long 0x00003f80, 0xbec4bf6d, 0x3f353f35, 0xbf6dbec4, 0x00003f80, 0xbf0ebf55, 0x3f6d3ec4, 0xbf7b3e48
.long 0x00003f80, 0xbf35bf35, 0x3f80248d, 0xbf353f35, 0x00003f80, 0xbf55bf0e, 0x3f6dbec4, 0xbe483f7b
.long 0x00003f80, 0xbf6dbec4, 0x3f35bf35, 0x3ec43f6d, 0x00003f80, 0xbf7bbe48, 0x3ec4bf6d, 0x3f553f0e
.long 0x00003f80, 0xbf80a554, 0x250dbf80, 0x3f80248d, 0x00003f80, 0xbf7b3e48, 0xbec4bf6d, 0x3f55bf0e
.long 0x00003f80, 0xbf6d3ec4, 0xbf35bf35, 0x3ec4bf6d, 0x00003f80, 0xbf553f0e, 0xbf6dbec4, 0xbe48bf7b
.long 0x00003f80, 0xbf353f35, 0xbf80a554, 0xbf35bf35, 0x00003f80, 0xbf0e3f55, 0xbf6d3ec4, 0xbf7bbe48
.long 0x00003f80, 0xbec43f6d, 0xbf353f35, 0xbf6d3ec4, 0x00003f80, 0xbe483f7b, 0xbec43f6d, 0xbf0e3f55
.long 0x00003f80, 0x00003f80, 0x00003f80, 0x00003f80, 0x3f353f35, 0x3f553f0e, 0x3f6d3ec4, 0x3f7b3e48
.long 0x3f80248d, 0x3f6dbec4, 0x3f35bf35, 0x3ec4bf6d, 0x3f35bf35, 0x3e48bf7b, 0xbec4bf6d, 0xbf55bf0e
.long 0x250dbf80, 0xbf35bf35, 0xbf80a554, 0xbf353f35, 0xbf35bf35, 0xbf7b3e48, 0xbec43f6d, 0x3f0e3f55
.long 0xbf80a554, 0xbec43f6d, 0x3f353f35, 0x3f6dbec4, 0xbf353f35, 0x3f0e3f55, 0x3f6dbec4, 0xbe48bf7b
.long 0x00003f80, 0x3f80248d, 0x250dbf80, 0xbf80a554, 0x3f353f35, 0x3f0ebf55, 0xbf6dbec4, 0xbe483f7b
.long 0x3f80248d, 0xbec4bf6d, 0xbf353f35, 0x3f6d3ec4, 0x3f35bf35, 0xbf7bbe48, 0x3ec43f6d, 0x3f0ebf55
.long 0x250dbf80, 0xbf353f35, 0x3f80248d, 0xbf35bf35, 0xbf35bf35, 0x3e483f7b, 0x3ec4bf6d, 0xbf553f0e
.long 0xbf80a554, 0x3f6d3ec4, 0xbf35bf35, 0x3ec43f6d, 0xbf353f35, 0x3f55bf0e, 0xbf6d3ec4, 0x3f7bbe48
.long 0x00003f80, 0x250dbf80, 0x00003f80, 0x250dbf80, 0x3f353f35, 0xbf55bf0e, 0x3f6d3ec4, 0xbf7bbe48
.long 0x3f80248d, 0xbf6d3ec4, 0x3f35bf35, 0xbec43f6d, 0x3f35bf35, 0xbe483f7b, 0xbec4bf6d, 0x3f553f0e
.long 0x250dbf80, 0x3f353f35, 0xbf80a554, 0x3f35bf35, 0xbf35bf35, 0x3f7bbe48, 0xbec43f6d, 0xbf0ebf55
.long 0xbf80a554, 0x3ec4bf6d, 0x3f353f35, 0xbf6d3ec4, 0xbf353f35, 0xbf0ebf55, 0x3f6dbec4, 0x3e483f7b
.long 0x00003f80, 0xbf80a554, 0x250dbf80, 0x3f80248d, 0x3f353f35, 0xbf0e3f55, 0xbf6dbec4, 0x3e48bf7b
.long 0x3f80248d, 0x3ec43f6d, 0xbf353f35, 0xbf6dbec4, 0x3f35bf35, 0x3f7b3e48, 0x3ec43f6d, 0xbf0e3f55
.long 0x250dbf80, 0x3f35bf35, 0x3f80248d, 0x3f353f35, 0xbf35bf35, 0xbe48bf7b, 0x3ec4bf6d, 0x3f55bf0e
.long 0xbf80a554, 0xbf6dbec4, 0xbf35bf35, 0xbec4bf6d, 0xbf353f35, 0xbf553f0e, 0xbf6d3ec4, 0xbf7b3e48
.long 0x00003f80, 0x00003f80, 0x00003f80, 0x00003f80, 0x3f80248d, 0x3f7bbe48, 0x3f6dbec4, 0x3f55bf0e
.long 0x250dbf80, 0xbec4bf6d, 0xbf35bf35, 0xbf6dbec4, 0xbf80a554, 0xbf553f0e, 0xbec43f6d, 0x3e483f7b
.long 0x00003f80, 0x3f353f35, 0x3f80248d, 0x3f35bf35, 0x3f80248d, 0x3f0ebf55, 0xbec4bf6d, 0xbf7bbe48
.long 0x250dbf80, 0xbf6dbec4, 0xbf353f35, 0x3ec43f6d, 0xbf80a554, 0xbe483f7b, 0x3f6d3ec4, 0x3f0ebf55
.long 0x00003f80, 0x3f80248d, 0x250dbf80, 0xbf80a554, 0x3f80248d, 0xbe48bf7b, 0xbf6d3ec4, 0x3f0e3f55
.long 0x250dbf80, 0xbf6d3ec4, 0x3f353f35, 0x3ec4bf6d, 0xbf80a554, 0x3f0e3f55, 0x3ec4bf6d, 0xbf7b3e48
.long 0x00003f80, 0x3f35bf35, 0xbf80a554, 0x3f353f35, 0x3f80248d, 0xbf55bf0e, 0x3ec43f6d, 0x3e48bf7b
.long 0x250dbf80, 0xbec43f6d, 0x3f35bf35, 0xbf6d3ec4, 0xbf80a554, 0x3f7b3e48, 0xbf6dbec4, 0x3f553f0e
.long 0x00003f80, 0x250dbf80, 0x00003f80, 0x250dbf80, 0x3f80248d, 0xbf7b3e48, 0x3f6dbec4, 0xbf553f0e
.long 0x250dbf80, 0x3ec43f6d, 0xbf35bf35, 0x3f6d3ec4, 0xbf80a554, 0x3f55bf0e, 0xbec43f6d, 0xbe48bf7b
.long 0x00003f80, 0xbf35bf35, 0x3f80248d, 0xbf353f35, 0x3f80248d, 0xbf0e3f55, 0xbec4bf6d, 0x3f7b3e48
.long 0x250dbf80, 0x3f6d3ec4, 0xbf353f35, 0xbec4bf6d, 0xbf80a554, 0x3e48bf7b, 0x3f6d3ec4, 0xbf0e3f55
.long 0x00003f80, 0xbf80a554, 0x250dbf80, 0x3f80248d, 0x3f80248d, 0x3e483f7b, 0xbf6d3ec4, 0xbf0ebf55
.long 0x250dbf80, 0x3f6dbec4, 0x3f353f35, 0xbec43f6d, 0xbf80a554, 0xbf0ebf55, 0x3ec4bf6d, 0x3f7bbe48
.long 0x00003f80, 0xbf353f35, 0xbf80a554, 0xbf35bf35, 0x3f80248d, 0x3f553f0e, 0x3ec43f6d, 0xbe483f7b
.long 0x250dbf80, 0x3ec4bf6d, 0x3f35bf35, 0x3f6dbec4, 0xbf80a554, 0xbf7bbe48, 0xbf6dbec4, 0xbf55bf0e
.long 0x00003f80, 0x00003f80, 0x00003f80, 0x00003f80, 0x3f35bf35, 0x3f0ebf55, 0x3ec4bf6d, 0x3e48bf7b
.long 0xbf80a554, 0xbf6d3ec4, 0xbf353f35, 0xbec43f6d, 0x3f353f35, 0x3f7b3e48, 0x3f6dbec4, 0x3f0ebf55
.long 0x250dbf80, 0xbf35bf35, 0xbf80a554, 0xbf353f35, 0xbf353f35, 0x3e483f7b, 0x3f6d3ec4, 0x3f55bf0e
.long 0x3f80248d, 0x3ec4bf6d, 0xbf35bf35, 0xbf6d3ec4, 0xbf35bf35, 0xbf553f0e, 0x3ec43f6d, 0x3f7bbe48
.long 0x00003f80, 0x3f80248d, 0x250dbf80, 0xbf80a554, 0x3f35bf35, 0xbf55bf0e, 0xbec43f6d, 0x3f7b3e48
.long 0xbf80a554, 0x3ec43f6d, 0x3f35bf35, 0xbf6dbec4, 0x3f353f35, 0x3e48bf7b, 0xbf6d3ec4, 0x3f553f0e
.long 0x250dbf80, 0xbf353f35, 0x3f80248d, 0xbf35bf35, 0xbf353f35, 0x3f7bbe48, 0xbf6dbec4, 0x3f0e3f55
.long 0x3f80248d, 0xbf6dbec4, 0x3f353f35, 0xbec4bf6d, 0xbf35bf35, 0x3f0e3f55, 0xbec4bf6d, 0x3e483f7b
.long 0x00003f80, 0x250dbf80, 0x00003f80, 0x250dbf80, 0x3f35bf35, 0xbf0e3f55, 0x3ec4bf6d, 0xbe483f7b
.long 0xbf80a554, 0x3f6dbec4, 0xbf353f35, 0x3ec4bf6d, 0x3f353f35, 0xbf7bbe48, 0x3f6dbec4, 0xbf0e3f55
.long 0x250dbf80, 0x3f353f35, 0xbf80a554, 0x3f35bf35, 0xbf353f35, 0xbe48bf7b, 0x3f6d3ec4, 0xbf553f0e
.long 0x3f80248d, 0xbec43f6d, 0xbf35bf35, 0x3f6dbec4, 0xbf35bf35, 0x3f55bf0e, 0x3ec43f6d, 0xbf7b3e48
.long 0x00003f80, 0xbf80a554, 0x250dbf80, 0x3f80248d, 0x3f35bf35, 0x3f553f0e, 0xbec43f6d, 0xbf7bbe48
.long 0xbf80a554, 0xbec4bf6d, 0x3f35bf35, 0x3f6d3ec4, 0x3f353f35, 0xbe483f7b, 0xbf6d3ec4, 0xbf55bf0e
.long 0x250dbf80, 0x3f35bf35, 0x3f80248d, 0x3f353f35, 0xbf353f35, 0xbf7b3e48, 0xbf6dbec4, 0xbf0ebf55
.long 0x3f80248d, 0x3f6d3ec4, 0x3f353f35, 0x3ec43f6d, 0xbf35bf35, 0xbf0ebf55, 0xbec4bf6d, 0xbe48bf7b
.long 0x00003f80, 0x00003f80, 0x00003f80, 0x00003f80, 0x250dbf80, 0xbe48bf7b, 0xbec4bf6d, 0xbf0ebf55
.long 0x00003f80, 0x3ec43f6d, 0x3f353f35, 0x3f6d3ec4, 0x250dbf80, 0xbf0ebf55, 0xbf6dbec4, 0xbf7b3e48
.long 0x00003f80, 0x3f353f35, 0x3f80248d, 0x3f35bf35, 0x250dbf80, 0xbf55bf0e, 0xbf6d3ec4, 0xbe483f7b
.long 0x00003f80, 0x3f6d3ec4, 0x3f35bf35, 0xbec4bf6d, 0x250dbf80, 0xbf7bbe48, 0xbec43f6d, 0x3f553f0e
.long 0x00003f80, 0x3f80248d, 0x250dbf80, 0xbf80a554, 0x250dbf80, 0xbf7b3e48, 0x3ec43f6d, 0x3f55bf0e
.long 0x00003f80, 0x3f6dbec4, 0xbf35bf35, 0xbec43f6d, 0x250dbf80, 0xbf553f0e, 0x3f6d3ec4, 0xbe48bf7b
.long 0x00003f80, 0x3f35bf35, 0xbf80a554, 0x3f353f35, 0x250dbf80, 0xbf0e3f55, 0x3f6dbec4, 0xbf7bbe48
.long 0x00003f80, 0x3ec4bf6d, 0xbf353f35, 0x3f6dbec4, 0x250dbf80, 0xbe483f7b, 0x3ec4bf6d, 0xbf0e3f55
.long 0x00003f80, 0x250dbf80, 0x00003f80, 0x250dbf80, 0x250dbf80, 0x3e483f7b, 0xbec4bf6d, 0x3f0e3f55
.long 0x00003f80, 0xbec4bf6d, 0x3f353f35, 0xbf6dbec4, 0x250dbf80, 0x3f0e3f55, 0xbf6dbec4, 0x3f7bbe48
.long 0x00003f80, 0xbf35bf35, 0x3f80248d, 0xbf353f35, 0x250dbf80, 0x3f553f0e, 0xbf6d3ec4, 0x3e48bf7b
.long 0x00003f80, 0xbf6dbec4, 0x3f35bf35, 0x3ec43f6d, 0x250dbf80, 0x3f7b3e48, 0xbec43f6d, 0xbf55bf0e
.long 0x00003f80, 0xbf80a554, 0x250dbf80, 0x3f80248d, 0x250dbf80, 0x3f7bbe48, 0x3ec43f6d, 0xbf553f0e
.long 0x00003f80, 0xbf6d3ec4, 0xbf35bf35, 0x3ec4bf6d, 0x250dbf80, 0x3f55bf0e, 0x3f6d3ec4, 0x3e483f7b
.long 0x00003f80, 0xbf353f35, 0xbf80a554, 0xbf35bf35, 0x250dbf80, 0x3f0ebf55, 0x3f6dbec4, 0x3f7b3e48
.long 0x00003f80, 0xbec43f6d, 0xbf353f35, 0xbf6d3ec4, 0x250dbf80, 0x3e48bf7b, 0x3ec4bf6d, 0x3f0ebf55
.long 0x00003f80, 0x00003f80, 0x00003f80, 0x00003f80, 0xbf35bf35, 0xbf55bf0e, 0xbf6dbec4, 0xbf7bbe48
.long 0x3f80248d, 0x3f6dbec4, 0x3f35bf35, 0x3ec4bf6d, 0xbf353f35, 0xbe483f7b, 0x3ec43f6d, 0x3f553f0e
.long 0x250dbf80, 0xbf35bf35, 0xbf80a554, 0xbf353f35, 0x3f353f35, 0x3f7bbe48, 0x3ec4bf6d, 0xbf0ebf55
.long 0xbf80a554, 0xbec43f6d, 0x3f353f35, 0x3f6dbec4, 0x3f35bf35, 0xbf0ebf55, 0xbf6d3ec4, 0x3e483f7b
.long 0x00003f80, 0x3f80248d, 0x250dbf80, 0xbf80a554, 0xbf35bf35, 0xbf0e3f55, 0x3f6d3ec4, 0x3e48bf7b
.long 0x3f80248d, 0xbec4bf6d, 0xbf353f35, 0x3f6d3ec4, 0xbf353f35, 0x3f7b3e48, 0xbec4bf6d, 0xbf0e3f55
.long 0x250dbf80, 0xbf353f35, 0x3f80248d, 0xbf35bf35, 0x3f353f35, 0xbe48bf7b, 0xbec43f6d, 0x3f55bf0e
.long 0xbf80a554, 0x3f6d3ec4, 0xbf35bf35, 0x3ec43f6d, 0x3f35bf35, 0xbf553f0e, 0x3f6dbec4, 0xbf7b3e48
.long 0x00003f80, 0x250dbf80, 0x00003f80, 0x250dbf80, 0xbf35bf35, 0x3f553f0e, 0xbf6dbec4, 0x3f7b3e48
.long 0x3f80248d, 0xbf6d3ec4, 0x3f35bf35, 0xbec43f6d, 0xbf353f35, 0x3e48bf7b, 0x3ec43f6d, 0xbf55bf0e
.long 0x250dbf80, 0x3f353f35, 0xbf80a554, 0x3f35bf35, 0x3f353f35, 0xbf7b3e48, 0x3ec4bf6d, 0x3f0e3f55
.long 0xbf80a554, 0x3ec4bf6d, 0x3f353f35, 0xbf6d3ec4, 0x3f35bf35, 0x3f0e3f55, 0xbf6d3ec4, 0xbe48bf7b
.long 0x00003f80, 0xbf80a554, 0x250dbf80, 0x3f80248d, 0xbf35bf35, 0x3f0ebf55, 0x3f6d3ec4, 0xbe483f7b
.long 0x3f80248d, 0x3ec43f6d, 0xbf353f35, 0xbf6dbec4, 0xbf353f35, 0xbf7bbe48, 0xbec4bf6d, 0x3f0ebf55
.long 0x250dbf80, 0x3f35bf35, 0x3f80248d, 0x3f353f35, 0x3f353f35, 0x3e483f7b, 0xbec43f6d, 0xbf553f0e
.long 0xbf80a554, 0xbf6dbec4, 0xbf35bf35, 0xbec4bf6d, 0x3f35bf35, 0x3f55bf0e, 0x3f6dbec4, 0x3f7bbe48
.long 0x00003f80, 0x00003f80, 0x00003f80, 0x00003f80, 0xbf80a554, 0xbf7b3e48, 0xbf6d3ec4, 0xbf553f0e
.long 0x250dbf80, 0xbec4bf6d, 0xbf35bf35, 0xbf6dbec4, 0x3f80248d, 0x3f55bf0e, 0x3ec4bf6d, 0xbe48bf7b
.long 0x00003f80, 0x3f353f35, 0x3f80248d, 0x3f35bf35, 0xbf80a554, 0xbf0e3f55, 0x3ec43f6d, 0x3f7b3e48
.long 0x250dbf80, 0xbf6dbec4, 0xbf353f35, 0x3ec43f6d, 0x3f80248d, 0x3e48bf7b, 0xbf6dbec4, 0xbf0e3f55
.long 0x00003f80, 0x3f80248d, 0x250dbf80, 0xbf80a554, 0xbf80a554, 0x3e483f7b, 0x3f6dbec4, 0xbf0ebf55
.long 0x250dbf80, 0xbf6d3ec4, 0x3f353f35, 0x3ec4bf6d, 0x3f80248d, 0xbf0ebf55, 0xbec43f6d, 0x3f7bbe48
.long 0x00003f80, 0x3f35bf35, 0xbf80a554, 0x3f353f35, 0xbf80a554, 0x3f553f0e, 0xbec4bf6d, 0xbe483f7b
.long 0x250dbf80, 0xbec43f6d, 0x3f35bf35, 0xbf6d3ec4, 0x3f80248d, 0xbf7bbe48, 0x3f6d3ec4, 0xbf55bf0e
.long 0x00003f80, 0x250dbf80, 0x00003f80, 0x250dbf80, 0xbf80a554, 0x3f7bbe48, 0xbf6d3ec4, 0x3f55bf0e
.long 0x250dbf80, 0x3ec43f6d, 0xbf35bf35, 0x3f6d3ec4, 0x3f80248d, 0xbf553f0e, 0x3ec4bf6d, 0x3e483f7b
.long 0x00003f80, 0xbf35bf35, 0x3f80248d, 0xbf353f35, 0xbf80a554, 0x3f0ebf55, 0x3ec43f6d, 0xbf7bbe48
.long 0x250dbf80, 0x3f6d3ec4, 0xbf353f35, 0xbec4bf6d, 0x3f80248d, 0xbe483f7b, 0xbf6dbec4, 0x3f0ebf55
.long 0x00003f80, 0xbf80a554, 0x250dbf80, 0x3f80248d, 0xbf80a554, 0xbe48bf7b, 0x3f6dbec4, 0x3f0e3f55
.long 0x250dbf80, 0x3f6dbec4, 0x3f353f35, 0xbec43f6d, 0x3f80248d, 0x3f0e3f55, 0xbec43f6d, 0xbf7b3e48
.long 0x00003f80, 0xbf353f35, 0xbf80a554, 0xbf35bf35, 0xbf80a554, 0xbf55bf0e, 0xbec4bf6d, 0x3e48bf7b
.long 0x250dbf80, 0x3ec4bf6d, 0x3f35bf35, 0x3f6dbec4, 0x3f80248d, 0x3f7b3e48, 0x3f6d3ec4, 0x3f553f0e
.long 0x00003f80, 0x00003f80, 0x00003f80, 0x00003f80, 0xbf353f35, 0xbf0e3f55, 0xbec43f6d, 0xbe483f7b
.long 0xbf80a554, 0xbf6d3ec4, 0xbf353f35, 0xbec43f6d, 0xbf35bf35, 0xbf7bbe48, 0xbf6d3ec4, 0xbf0e3f55
.long 0x250dbf80, 0xbf35bf35, 0xbf80a554, 0xbf353f35, 0x3f35bf35, 0xbe48bf7b, 0xbf6dbec4, 0xbf553f0e
.long 0x3f80248d, 0x3ec4bf6d, 0xbf35bf35, 0xbf6d3ec4, 0x3f353f35, 0x3f55bf0e, 0xbec4bf6d, 0xbf7b3e48
.long 0x00003f80, 0x3f80248d, 0x250dbf80, 0xbf80a554, 0xbf353f35, 0x3f553f0e, 0x3ec4bf6d, 0xbf7bbe48
.long 0xbf80a554, 0x3ec43f6d, 0x3f35bf35, 0xbf6dbec4, 0xbf35bf35, 0xbe483f7b, 0x3f6dbec4, 0xbf55bf0e
.long 0x250dbf80, 0xbf353f35, 0x3f80248d, 0xbf35bf35, 0x3f35bf35, 0xbf7b3e48, 0x3f6d3ec4, 0xbf0ebf55
.long 0x3f80248d, 0xbf6dbec4, 0x3f353f35, 0xbec4bf6d, 0x3f353f35, 0xbf0ebf55, 0x3ec43f6d, 0xbe48bf7b
.long 0x00003f80, 0x250dbf80, 0x00003f80, 0x250dbf80, 0xbf353f35, 0x3f0ebf55, 0xbec43f6d, 0x3e48bf7b
.long 0xbf80a554, 0x3f6dbec4, 0xbf353f35, 0x3ec4bf6d, 0xbf35bf35, 0x3f7b3e48, 0xbf6d3ec4, 0x3f0ebf55
.long 0x250dbf80, 0x3f353f35, 0xbf80a554, 0x3f35bf35, 0x3f35bf35, 0x3e483f7b, 0xbf6dbec4, 0x3f55bf0e
.long 0x3f80248d, 0xbec43f6d, 0xbf35bf35, 0x3f6dbec4, 0x3f353f35, 0xbf553f0e, 0xbec4bf6d, 0x3f7bbe48
.long 0x00003f80, 0xbf80a554, 0x250dbf80, 0x3f80248d, 0xbf353f35, 0xbf55bf0e, 0x3ec4bf6d, 0x3f7b3e48
.long 0xbf80a554, 0xbec4bf6d, 0x3f35bf35, 0x3f6d3ec4, 0xbf35bf35, 0x3e48bf7b, 0x3f6dbec4, 0x3f553f0e
.long 0x250dbf80, 0x3f35bf35, 0x3f80248d, 0x3f353f35, 0x3f35bf35, 0x3f7bbe48, 0x3f6d3ec4, 0x3f0e3f55
.long 0x3f80248d, 0x3f6d3ec4, 0x3f353f35, 0x3ec43f6d, 0x3f353f35, 0x3f0e3f55, 0x3ec43f6d, 0x3e483f7b
code_end:
.long 0

.section .rodata,"a"
.p2align 6
.amdhsa_kernel l1_kernel
  .amdhsa_next_free_vgpr 64
  .amdhsa_next_free_sgpr 96
  .amdhsa_accum_offset 64
  .amdhsa_group_segment_fixed_size 0
  .amdhsa_kernarg_size 112
  .amdhsa_user_sgpr_count 2
  .amdhsa_user_sgpr_kernarg_segment_ptr 1
  .amdhsa_system_sgpr_workgroup_id_x 1
  .amdhsa_float_denorm_mode_32 3
.end_amdhsa_kernel

.p2align 6
.amdhsa_kernel l2_kernel
  .amdhsa_next_free_vgpr 128
  .amdhsa_next_free_sgpr 96
  .amdhsa_accum_offset 128
  .amdhsa_group_segment_fixed_size 0
  .amdhsa_kernarg_size 112
  .amdhsa_user_sgpr_count 2
  .amdhsa_user_sgpr_kernarg_segment_ptr 1
  .amdhsa_system_sgpr_workgroup_id_x 1
  .amdhsa_float_denorm_mode_32 3
.end_amdhsa_kernel

.p2align 6
.amdhsa_kernel l3_kernel
  .amdhsa_next_free_vgpr 128
  .amdhsa_next_free_sgpr 96
  .amdhsa_accum_offset 128
  .amdhsa_group_segment_fixed_size 0
  .amdhsa_kernarg_size 112
  .amdhsa_user_sgpr_count 2
  .amdhsa_user_sgpr_kernarg_segment_ptr 1
  .amdhsa_system_sgpr_workgroup_id_x 1
  .amdhsa_float_denorm_mode_32 3
.end_amdhsa_kernel

.p2align 6
.amdhsa_kernel gemm3_kernel
  .amdhsa_next_free_vgpr 476
  .amdhsa_next_free_sgpr 102
  .amdhsa_accum_offset 256
  .amdhsa_group_segment_fixed_size 0
  .amdhsa_kernarg_size 112
  .amdhsa_user_sgpr_count 2
  .amdhsa_user_sgpr_kernarg_segment_ptr 1
  .amdhsa_system_sgpr_workgroup_id_x 1
  .amdhsa_float_denorm_mode_32 3
.end_amdhsa_kernel

.p2align 6
.amdhsa_kernel gemm4_kernel
  .amdhsa_next_free_vgpr 192
  .amdhsa_next_free_sgpr 102
  .amdhsa_accum_offset 192
  .amdhsa_group_segment_fixed_size 0
  .amdhsa_kernarg_size 112
  .amdhsa_user_sgpr_count 2
  .amdhsa_user_sgpr_kernarg_segment_ptr 1
  .amdhsa_system_sgpr_workgroup_id_x 1
  .amdhsa_float_denorm_mode_32 3
.end_amdhsa_kernel
```
